```python
import torch

def _softmax(x, axis=-1):
    return torch.softmax(x, dim=axis)
def _gelu(x):
    return torch.nn.functional.gelu(x, approximate="tanh")
def _silu(x):
    return torch.nn.functional.silu(x)
def _sigmoid(x):
    return torch.sigmoid(x)
def _layernorm(x, axis=-1, eps=1e-5):
    m = x.mean(dim=axis, keepdim=True)
    v = x.var(dim=axis, keepdim=True, unbiased=False)
    return (x - m) / torch.sqrt(v + eps)
def _scatter_add(tgt, idx, src, axis=0):
    return tgt.clone().index_add_(axis, idx, src)
def _segment_sum(src, seg, n):
    out = torch.zeros((n,) + src.shape[1:], dtype=src.dtype)
    return out.index_add_(0, seg, src)
def _pad(x, pw):
    flat = tuple(v for pair in reversed(pw) for v in pair)
    return torch.nn.functional.pad(x, flat)

kernel_name = 'interleave_layers__grouped_kv_mqa__glu_gated_reglu__prompt'

def setup_inputs():

    _w = (lambda a: (lambda t: t.to(torch.bfloat16) if t.is_floating_point() else t)(torch.as_tensor(a)))
    def _A_setup():
        B, S, D, H = 1, 2048, 512, 32
        Dh = D // H
        return {
            "x": _w((lambda *s: torch.randn(*s, dtype=torch.bfloat16) * 0.05)(B, S, D)),
            "wq": _w((lambda *s: torch.randn(*s, dtype=torch.bfloat16) * 0.05)(D, H * Dh)),
            "wk": _w((lambda *s: torch.randn(*s, dtype=torch.bfloat16) * 0.05)(D, Dh)),
            "wv": _w((lambda *s: torch.randn(*s, dtype=torch.bfloat16) * 0.05)(D, Dh)),
            "wo": _w((lambda *s: torch.randn(*s, dtype=torch.bfloat16) * 0.05)(H * Dh, D)),
        }
    _A_in = _A_setup()

    def _B_setup():
        B, S, D, F = 1, 2048, 512, 1792
        return {
            "x": _w((lambda *s: torch.randn(*s, dtype=torch.bfloat16) * 0.05)(B, S, D)),
            "W_gate": _w((lambda *s: torch.randn(*s, dtype=torch.bfloat16) * 0.4)(D, F) * (2.0 / D) ** 0.5),
            "W_up": _w((lambda *s: torch.randn(*s, dtype=torch.bfloat16) * 0.4)(D, F) * (2.0 / D) ** 0.5),
            "W_down": _w((lambda *s: torch.randn(*s, dtype=torch.bfloat16) * 0.4)(F, D) * (1.0 / F) ** 0.5),
        }
    _B_in = _B_setup()

    return {
        "A_x": _A_in["x"],
        "A_wq": _A_in["wq"],
        "A_wk": _A_in["wk"],
        "A_wv": _A_in["wv"],
        "A_wo": _A_in["wo"],
        "B_x": _B_in["x"],
        "B_W_gate": _B_in["W_gate"],
        "B_W_up": _B_in["W_up"],
        "B_W_down": _B_in["W_down"],
    }

def reference(A_x, A_wq, A_wk, A_wv, A_wo, B_x, B_W_gate, B_W_up, B_W_down):
    def _A_ref(x, wq, wk, wv, wo):
        B, S, D = x.shape
        H = 32
        Dh = D // H
        q = (lambda x, *d: x.permute(*d))((x @ wq).reshape(B, S, H, Dh), 0, 2, 1, 3)
        k = x @ wk
        v = x @ wv
        scores = torch.einsum("bhqd,bkd->bhqk", q, k) * (Dh ** -0.5)
        p = _softmax(scores, axis=-1)
        o = torch.einsum("bhqk,bkd->bhqd", p, v)
        return (lambda x, *d: x.permute(*d))(o, 0, 2, 1, 3).reshape(B, S, H * Dh) @ wo

    def _B_ref(x, W_gate, W_up, W_down):
        gate = torch.einsum("bsd,df->bsf", x, W_gate)
        up = torch.einsum("bsd,df->bsf", x, W_up)
        gate = gate * (lambda x, dt: x.to(dt))(gate > 0, gate.dtype)
        h = gate * up
        return torch.einsum("bsf,fd->bsd", h, W_down)

    x = A_x
    x = x + _A_ref(_layernorm(x, axis=-1), A_wq, A_wk, A_wv, A_wo)
    x = x + _B_ref(_layernorm(x, axis=-1), B_W_gate, B_W_up, B_W_down)
    x = x + _A_ref(_layernorm(x, axis=-1), A_wq, A_wk, A_wv, A_wo)
    x = x + _B_ref(_layernorm(x, axis=-1), B_W_gate, B_W_up, B_W_down)
    return x
```

```asm
; @launch grid=(256,1,1) block=(256,1,1) lds=163840
.amdgcn_target "amdgcn-amd-amdhsa--gfx950"
.text
.globl interleave_layers__grouped_kv_mqa__glu_gated_reglu__prompt_kernel
.p2align 8
.type interleave_layers__grouped_kv_mqa__glu_gated_reglu__prompt_kernel,@function
interleave_layers__grouped_kv_mqa__glu_gated_reglu__prompt_kernel:
L_CODE_START:
    s_cmp_ge_u32 s2, 256
    s_cbranch_scc1 L_END
    s_load_dwordx16 s[8:23], s[0:1], 0
    s_load_dwordx8 s[24:31], s[0:1], 64
    s_getpc_b64 s[84:85]
    s_and_b32 s84, s84, 0xffffffc0
    v_and_b32 v4, 63, v0
    v_lshlrev_b32 v1, 4, v4
    v_lshrrev_b32 v5, 6, v0
    s_and_b32 s4, s2, 7
    s_lshr_b32 s5, s2, 3
    v_readfirstlane_b32 s3, v5
    s_and_b32 s76, s5, 15
    s_lshl_b32 s76, s76, 12
    v_lshrrev_b32 v6, 3, v0
    v_lshlrev_b32 v6, 7, v6
    v_add_u32 v6, s76, v6
    v_min_u32 v6, L_CODE_END-L_CODE_START-64, v6
    global_load_dword v248, v6, s[84:85]
    s_lshr_b32 s76, s5, 3
    s_lshl_b32 s68, s4, 2
    s_add_u32 s68, s68, s76
    s_and_b32 s69, s5, 7
    v_and_b32 v4, 63, v0
    v_lshrrev_b32 v5, 3, v4
    v_bfe_u32 v6, v4, 4, 1
    v_lshlrev_b32 v6, 1, v6
    v_and_b32 v4, 7, v4
    v_xor_b32 v4, v4, v6
    v_lshlrev_b32 v4, 4, v4
    v_lshl_add_u32 v11, v5, 10, v4
    v_xor_b32 v155, 64, v11
    s_lshl_b32 s90, s3, 15
    s_lshl_b32 s91, s69, 7
    s_add_u32 s90, s90, s91
    s_lshl_b32 s91, s3, 12
    s_add_u32 s91, s91, 65536
    s_mov_b32 s6, 0
    s_waitcnt lgkmcnt(0)
    s_mov_b32 s36, s10
    s_mov_b32 s37, s11
    s_mov_b32 s38, 0x80000
    s_mov_b32 s39, 0x20000
    s_mov_b32 s32, s8
    s_mov_b32 s33, s9
    s_mov_b32 s34, 0x200000
    s_mov_b32 s35, 0x20000
    s_cmp_eq_u32 s69, 0
    s_cselect_b32 s40, s12, s14
    s_cselect_b32 s41, s13, s15
    s_mov_b32 s42, 16384
    s_mov_b32 s43, 0x20000
    s_mov_b32 m0, s91
    s_add_u32 s91, s91, 1024
    buffer_load_dwordx4 v11, s[36:39], s90 offen lds
    s_add_u32 s90, s90, 8192
    s_mov_b32 m0, s91
    s_add_u32 s91, s91, 1024
    buffer_load_dwordx4 v155, s[36:39], s90 offen lds
    s_add_u32 s90, s90, 8192
    s_load_dword s7, s[30:31], 0
    s_mov_b32 m0, s91
    s_add_u32 s91, s91, 1024
    buffer_load_dwordx4 v11, s[36:39], s90 offen lds
    s_add_u32 s90, s90, 8192
    s_mov_b32 m0, s91
    s_add_u32 s91, s91, 13312
    buffer_load_dwordx4 v155, s[36:39], s90 offen lds
    s_add_u32 s90, s90, 106496
    v_and_b32 v4, 63, v0
    v_lshrrev_b32 v5, 2, v4
    v_lshrrev_b32 v6, 4, v4
    v_sub_u32 v6, 0, v6
    v_xor_b32 v4, v4, v6
    v_and_b32 v4, 3, v4
    v_lshlrev_b32 v4, 4, v4
    v_lshl_add_u32 v12, v5, 10, v4
    s_lshl_b32 s76, s68, 16
    s_and_b32 s77, s3, 1
    s_lshl_b32 s77, s77, 14
    s_add_u32 s76, s76, s77
    s_lshr_b32 s77, s3, 1
    s_lshl_b32 s77, s77, 8
    s_add_u32 s76, s76, s77
    v_add_u32 v12, s76, v12
    s_and_b32 s99, s3, 1
    s_lshl_b32 s99, s99, 14
    s_lshr_b32 s95, s3, 1
    s_lshl_b32 s95, s95, 12
    s_add_u32 s99, s99, s95
    s_lshl_b32 s82, s3, 10
    s_add_u32 m0, s82, 131072
    s_add_u32 s82, s82, 0
    buffer_load_dwordx4 v1, s[40:43], s82 offen lds
    s_mov_b32 m0, s91
    s_add_u32 s91, s91, 1024
    buffer_load_dwordx4 v11, s[36:39], s90 offen lds
    s_add_u32 s90, s90, 8192
    s_mov_b32 m0, s91
    s_add_u32 s91, s91, 1024
    buffer_load_dwordx4 v155, s[36:39], s90 offen lds
    s_add_u32 s90, s90, 8192
    s_mov_b32 m0, s91
    s_add_u32 s91, s91, 1024
    buffer_load_dwordx4 v11, s[36:39], s90 offen lds
    s_add_u32 s90, s90, 8192
    s_mov_b32 m0, s91
    s_add_u32 s91, s91, 13312
    buffer_load_dwordx4 v155, s[36:39], s90 offen lds
    s_add_u32 s90, s90, 106496
    s_lshl_b32 s82, s3, 10
    s_add_u32 m0, s82, 135168
    s_add_u32 s82, s82, 4096
    buffer_load_dwordx4 v1, s[40:43], s82 offen lds
    s_add_u32 m0, s99, 0
    s_mov_b32 s95, 0
    buffer_load_dwordx4 v12, s[32:35], s95 offen lds
    s_add_u32 m0, s99, 1024
    s_mov_b32 s95, 64
    buffer_load_dwordx4 v12, s[32:35], s95 offen lds
    s_add_u32 m0, s99, 2048
    s_mov_b32 s95, 128
    buffer_load_dwordx4 v12, s[32:35], s95 offen lds
    s_add_u32 m0, s99, 3072
    s_mov_b32 s95, 192
    buffer_load_dwordx4 v12, s[32:35], s95 offen lds
    s_add_u32 m0, s99, 32768
    s_mov_b32 s95, 32768
    buffer_load_dwordx4 v12, s[32:35], s95 offen lds
    s_add_u32 m0, s99, 33792
    s_mov_b32 s95, 32832
    buffer_load_dwordx4 v12, s[32:35], s95 offen lds
    s_add_u32 m0, s99, 34816
    s_mov_b32 s95, 32896
    buffer_load_dwordx4 v12, s[32:35], s95 offen lds
    s_add_u32 m0, s99, 35840
    s_mov_b32 s95, 32960
    buffer_load_dwordx4 v12, s[32:35], s95 offen lds
    s_lshl_b32 s70, s4, 5
    s_add_u32 s70, s70, s5
    s_lshr_b32 s76, s5, 3
    s_lshr_b32 s71, s4, 1
    s_lshl_b32 s71, s71, 2
    s_add_u32 s71, s71, s76
    s_and_b32 s72, s4, 1
    s_lshl_b32 s72, s72, 3
    s_add_u32 s72, s72, s69
    s_lshl_b32 s73, s71, 4
    s_add_u32 s73, s73, s72
    s_lshl_b32 s75, s2, 2
    s_add_u32 s75, s75, s3
    s_lshl_b32 s83, s3, 15
    s_add_u32 s44, s30, 0x1000000
    s_addc_u32 s45, s31, 0
    s_mov_b32 s46, 0x1000000
    s_mov_b32 s47, 0x20000
    s_mov_b32 s48, s30
    s_mov_b32 s49, s31
    s_mov_b32 s50, 0x1000000
    s_mov_b32 s51, 0x20000
    s_add_u32 s52, s30, 0x800000
    s_addc_u32 s53, s31, 0
    s_mov_b32 s54, 0x200000
    s_mov_b32 s55, 0x20000
    v_and_b32 v4, 63, v0
    v_lshrrev_b32 v5, 3, v4
    v_and_b32 v4, 7, v4
    v_lshlrev_b32 v4, 4, v4
    v_lshl_add_u32 v251, v5, 10, v4
    v_mul_u32_u24 v5, 3584, v5
    v_add_u32 v250, v5, v4
    s_cmp_ge_u32 s2, 224
    s_cbranch_scc1 L_RAW_WO
    s_mov_b32 s56, s20
    s_mov_b32 s57, s21
    s_mov_b32 s58, 0x1c0000
    s_mov_b32 s59, 0x20000
    s_mov_b32 s60, s22
    s_mov_b32 s61, s23
    s_mov_b32 s62, 0x1c0000
    s_mov_b32 s63, 0x20000
    s_mov_b32 s64, s24
    s_mov_b32 s65, s25
    s_mov_b32 s66, 0x1c0000
    s_mov_b32 s67, 0x20000
    s_mul_i32 s76, s75, 2341
    s_lshr_b32 s76, s76, 16
    s_mul_i32 s77, s76, 28
    s_sub_u32 s77, s75, s77
    s_mul_i32 s78, s76, 57344
    s_lshl_b32 s77, s77, 7
    s_add_u32 s78, s78, s77
    s_add_u32 s79, s78, 28672
    s_mov_b32 s18, s78
    s_mov_b32 s19, s79
    s_lshr_b32 s80, s75, 3
    s_lshl_b32 s80, s80, 14
    s_and_b32 s77, s75, 7
    s_lshl_b32 s77, s77, 7
    s_add_u32 s80, s80, s77
    s_add_u32 s81, s80, 8192
    s_branch L_RAW_DONE
L_RAW_WO:
    s_mov_b32 s56, s16
    s_mov_b32 s57, s17
    s_mov_b32 s58, 0x80000
    s_mov_b32 s59, 0x20000
    s_mov_b32 s60, s16
    s_mov_b32 s61, s17
    s_mov_b32 s62, 0x80000
    s_mov_b32 s63, 0x20000
    s_mov_b32 s64, s16
    s_mov_b32 s65, s17
    s_mov_b32 s66, 0x80000
    s_mov_b32 s67, 0x20000
    v_mov_b32 v250, v251
    s_sub_u32 s76, s75, 896
    s_lshr_b32 s78, s76, 3
    s_lshl_b32 s78, s78, 15
    s_and_b32 s77, s76, 7
    s_lshl_b32 s77, s77, 7
    s_add_u32 s78, s78, s77
    s_add_u32 s79, s78, 8192
    s_add_u32 s18, s78, 16384
    s_add_u32 s19, s78, 24576
    s_mov_b32 s80, s78
    s_mov_b32 s81, s78
L_RAW_DONE:
    s_lshl_b32 s76, s2, 4
    s_add_u32 s76, s76, 4096
    s_lshl_b32 s74, s2, 7
    s_add_u32 s74, s74, 4294946816
    s_cmp_ge_u32 s2, 224
    s_cselect_b32 s74, s74, s76
    v_and_b32 v4, 7, v0
    v_min_u32 v4, 6, v4
    v_bfe_u32 v5, v0, 3, 1
    v_and_b32 v6, 1, v4
    v_cmp_eq_u32 vcc, 0, v4
    v_mov_b32 v7, s70
    v_mov_b32 v8, s73
    v_cndmask_b32 v6, v6, 1, vcc
    v_cmp_eq_u32 vcc, 1, v6
    v_lshlrev_b32 v4, 15, v4
    v_lshl_add_u32 v4, v5, 24, v4
    v_cndmask_b32 v7, v8, v7, vcc
    v_lshl_add_u32 v4, v7, 7, v4
    s_mov_b32 s50, 0x3000000
    v_add_u32 v252, 0x1280000, v4
    v_and_b32 v5, 15, v0
    v_cmp_eq_u32 vcc, 15, v5
    v_mov_b32 v4, s74
    s_nop 0
    v_cndmask_b32 v252, v252, v4, vcc
    buffer_load_dword v249, v252, s[48:51], 0 offen
    s_lshr_b32 s21, s3, 1
    s_and_b32 s22, s3, 1
    v_and_b32 v4, 63, v0
    v_and_b32 v5, 15, v4
    v_lshrrev_b32 v6, 4, v4
    v_lshrrev_b32 v7, 2, v5
    v_sub_u32 v7, 0, v7
    v_xor_b32 v7, v7, v6
    v_and_b32 v7, 3, v7
    v_lshlrev_b32 v7, 4, v7
    v_lshl_add_u32 v7, v5, 6, v7
    s_lshl_b32 s76, s22, 14
    s_lshl_b32 s77, s21, 10
    s_add_u32 s76, s76, s77
    v_add_u32 v108, s76, v7
    v_xor_b32 v109, 0x400, v108
    v_xor_b32 v110, 0x4000, v108
    v_xor_b32 v111, 0x4400, v108
    s_lshl_b32 s76, s22, 8
    s_add_u32 s76, s76, 147456
    v_lshl_add_u32 v113, v5, 4, s76
    v_xor_b32 v114, 0x100, v113
    s_lshl_b32 s77, s21, 3
    v_add_u32 v112, s77, v113
    v_lshrrev_b32 v7, 2, v5
    v_cmp_eq_u32 vcc, v6, v7
    v_lshlrev_b32 v7, 3, v4
    v_add_u32 v7, 148480, v7
    v_cndmask_b32 v112, v7, v112, vcc
    v_and_b32 v7, 3, v4
    v_cmp_eq_u32 s[84:85], 1, v7
    v_cmp_eq_u32 s[86:87], 2, v7
    v_cmp_eq_u32 s[88:89], 3, v7
    s_lshl_b32 s76, s3, 10
    s_add_u32 s76, s76, 151552
    v_add_u32 v122, s76, v1
    v_xor_b32 v119, 0x800, v122
    s_lshl_b32 s76, s3, 9
    s_add_u32 s76, s76, 155648
    v_lshl_add_u32 v117, v5, 5, s76
    v_lshl_add_u32 v117, v6, 3, v117
    v_lshrrev_b32 v7, 2, v5
    v_lshl_add_u32 v7, v6, 2, v7
    v_lshl_add_u32 v118, v7, 5, s76
    v_and_b32 v7, 1, v4
    v_lshl_add_u32 v118, v7, 4, v118
    v_bfe_u32 v7, v4, 1, 1
    v_lshl_add_u32 v118, v7, 3, v118
    s_lshl_b32 s76, s68, 11
    s_lshl_b32 s77, s21, 10
    s_add_u32 s101, s76, s77
    s_lshl_b32 s77, s22, 8
    s_add_u32 s101, s101, s77
    s_lshl_b32 s77, s3, 9
    s_add_u32 s76, s76, s77
    s_add_u32 s76, s76, 0x10000
    s_cmp_eq_u32 s69, 0
    s_cselect_b32 s101, s101, s76
    s_cselect_b32 s77, 9, 8
    s_add_u32 s101, s101, 0x200000
    v_lshrrev_b32 v7, 1, v6
    v_lshlrev_b32 v7, s77, v7
    v_lshl_add_u32 v116, v5, 4, v7
    v_and_b32 v7, 1, v6
    v_xor_b32 v7, s22, v7
    v_lshlrev_b32 v115, 14, v7
    v_lshrrev_b32 v7, 3, v5
    v_lshl_add_u32 v115, v7, 13, v115
    v_lshrrev_b32 v7, 1, v6
    v_lshl_add_u32 v115, v7, 9, v115
    v_and_b32 v7, 7, v5
    v_lshl_add_u32 v115, v7, 4, v115
    s_lshl_b32 s100, s68, 16
    s_lshl_b32 s76, s69, 10
    s_add_u32 s100, s100, s76
    s_lshl_b32 s76, s3, 7
    s_add_u32 s100, s100, s76
    v_lshrrev_b32 v7, 2, v5
    v_lshl_add_u32 v7, v6, 3, v7
    v_and_b32 v4, 3, v4
    s_lshl_b32 s76, s21, 10
    s_add_u32 s76, s76, 131072
    v_lshl_add_u32 v120, v7, 5, s76
    v_lshl_add_u32 v120, v4, 3, v120
    v_xor_b32 v121, 0x400, v120
    v_lshrrev_b32 v5, 3, v5
    v_and_b32 v6, 1, v6
    v_lshl_add_u32 v5, v6, 1, v5
    v_xor_b32 v5, s3, v5
    s_lshl_b32 s76, s21, 12
    s_add_u32 s76, s76, 65536
    v_lshl_add_u32 v8, v7, 7, s76
    v_lshl_add_u32 v8, v5, 5, v8
    v_lshl_add_u32 v8, v4, 3, v8
    v_xor_b32 v9, 0x1000, v8
    s_cmp_eq_u32 s21, 1
    s_cselect_b64 s[24:25], -1, 0
    v_mov_b32 v64, 0x3f803f80
    v_mov_b32 v65, 0x3f803f80
    v_mov_b32 v66, 0x3f803f80
    v_mov_b32 v67, 0x3f803f80
    s_waitcnt lgkmcnt(0)
    s_waitcnt vmcnt(9)
    s_barrier
    ds_read_b64_tr_b16 a[0:1], v8 offset:0
    ds_read_b64_tr_b16 a[2:3], v8 offset:512
    ds_read_b64_tr_b16 a[64:65], v120 offset:0
    s_mov_b32 m0, s91
    s_add_u32 s91, s91, 1024
    buffer_load_dwordx4 v11, s[36:39], s90 offen lds
    s_add_u32 s90, s90, 8192
    ds_read_b64_tr_b16 a[66:67], v120 offset:128
    ds_read_b64_tr_b16 a[4:5], v9 offset:0
    ds_read_b64_tr_b16 a[6:7], v9 offset:512
    s_mov_b32 m0, s91
    s_add_u32 s91, s91, 1024
    buffer_load_dwordx4 v155, s[36:39], s90 offen lds
    s_add_u32 s90, s90, 8192
    ds_read_b64_tr_b16 a[96:97], v121 offset:0
    ds_read_b64_tr_b16 a[98:99], v121 offset:128
    ds_read_b64_tr_b16 a[8:9], v8 offset:8192
    s_mov_b32 m0, s91
    s_add_u32 s91, s91, 1024
    buffer_load_dwordx4 v11, s[36:39], s90 offen lds
    s_add_u32 s90, s90, 8192
    ds_read_b64_tr_b16 a[10:11], v8 offset:8704
    ds_read_b64_tr_b16 a[68:69], v120 offset:2048
    ds_read_b64_tr_b16 a[70:71], v120 offset:2176
    s_mov_b32 m0, s91
    s_add_u32 s91, s91, 13312
    buffer_load_dwordx4 v155, s[36:39], s90 offen lds
    s_add_u32 s90, s90, 106496
    ds_read_b64_tr_b16 a[12:13], v9 offset:8192
    ds_read_b64_tr_b16 a[14:15], v9 offset:8704
    s_waitcnt lgkmcnt(12)
    ds_read_b64_tr_b16 a[100:101], v121 offset:2048
    s_lshl_b32 s82, s3, 10
    s_add_u32 m0, s82, 139264
    s_add_u32 s82, s82, 8192
    buffer_load_dwordx4 v1, s[40:43], s82 offen lds
    ds_read_b64_tr_b16 a[102:103], v121 offset:2176
    s_waitcnt lgkmcnt(12)
    v_mfma_f32_16x16x32_bf16 v[100:103], a[0:3], v[64:67], 0
    v_mfma_f32_16x16x32_bf16 v[104:107], a[64:67], v[64:67], 0
    s_waitcnt lgkmcnt(8)
    v_mfma_f32_16x16x32_bf16 v[100:103], a[4:7], v[64:67], v[100:103]
    v_mfma_f32_16x16x32_bf16 v[104:107], a[96:99], v[64:67], v[104:107]
    s_waitcnt lgkmcnt(4)
    v_mfma_f32_16x16x32_bf16 v[100:103], a[8:11], v[64:67], v[100:103]
    v_mfma_f32_16x16x32_bf16 v[104:107], a[68:71], v[64:67], v[104:107]
    s_waitcnt lgkmcnt(0)
    v_mfma_f32_16x16x32_bf16 v[100:103], a[12:15], v[64:67], v[100:103]
    v_mfma_f32_16x16x32_bf16 v[104:107], a[100:103], v[64:67], v[104:107]
    ds_read_b64_tr_b16 a[16:17], v8 offset:16384
    ds_read_b64_tr_b16 a[18:19], v8 offset:16896
    ds_read_b64_tr_b16 a[72:73], v120 offset:4096
    s_mov_b32 m0, s91
    s_add_u32 s91, s91, 1024
    buffer_load_dwordx4 v11, s[36:39], s90 offen lds
    s_add_u32 s90, s90, 8192
    ds_read_b64_tr_b16 a[74:75], v120 offset:4224
    ds_read_b64_tr_b16 a[20:21], v9 offset:16384
    ds_read_b64_tr_b16 a[22:23], v9 offset:16896
    s_mov_b32 m0, s91
    s_add_u32 s91, s91, 1024
    buffer_load_dwordx4 v155, s[36:39], s90 offen lds
    s_add_u32 s90, s90, 8192
    ds_read_b64_tr_b16 a[104:105], v121 offset:4096
    ds_read_b64_tr_b16 a[106:107], v121 offset:4224
    ds_read_b64_tr_b16 a[24:25], v8 offset:24576
    s_mov_b32 m0, s91
    s_add_u32 s91, s91, 1024
    buffer_load_dwordx4 v11, s[36:39], s90 offen lds
    s_add_u32 s90, s90, 8192
    ds_read_b64_tr_b16 a[26:27], v8 offset:25088
    ds_read_b64_tr_b16 a[76:77], v120 offset:6144
    ds_read_b64_tr_b16 a[78:79], v120 offset:6272
    s_mov_b32 m0, s91
    s_add_u32 s91, s91, 13312
    buffer_load_dwordx4 v155, s[36:39], s90 offen lds
    s_add_u32 s90, s90, 106496
    ds_read_b64_tr_b16 a[28:29], v9 offset:24576
    ds_read_b64_tr_b16 a[30:31], v9 offset:25088
    s_waitcnt lgkmcnt(12)
    ds_read_b64_tr_b16 a[108:109], v121 offset:6144
    s_lshl_b32 s82, s3, 10
    s_add_u32 m0, s82, 143360
    s_add_u32 s82, s82, 12288
    buffer_load_dwordx4 v1, s[40:43], s82 offen lds
    ds_read_b64_tr_b16 a[110:111], v121 offset:6272
    s_waitcnt lgkmcnt(12)
    v_mfma_f32_16x16x32_bf16 v[100:103], a[16:19], v[64:67], v[100:103]
    v_mfma_f32_16x16x32_bf16 v[104:107], a[72:75], v[64:67], v[104:107]
    s_waitcnt lgkmcnt(8)
    v_mfma_f32_16x16x32_bf16 v[100:103], a[20:23], v[64:67], v[100:103]
    v_mfma_f32_16x16x32_bf16 v[104:107], a[104:107], v[64:67], v[104:107]
    s_waitcnt lgkmcnt(4)
    v_mfma_f32_16x16x32_bf16 v[100:103], a[24:27], v[64:67], v[100:103]
    v_mfma_f32_16x16x32_bf16 v[104:107], a[76:79], v[64:67], v[104:107]
    s_waitcnt lgkmcnt(0)
    v_mfma_f32_16x16x32_bf16 v[100:103], a[28:31], v[64:67], v[100:103]
    v_mfma_f32_16x16x32_bf16 v[104:107], a[108:111], v[64:67], v[104:107]
    s_mul_i32 s7, s7, 1664525
    s_add_u32 s7, s7, 1013904223
    v_mov_b32 v2, s7
    s_waitcnt vmcnt(15)
    s_barrier
    ds_read_b128 v[128:131], v108 offset:0
    ds_read_b128 v[132:135], v110 offset:0
    ds_read_b128 v[136:139], v109 offset:0
    ds_read_b128 v[140:143], v111 offset:0
    ds_read_b128 v[144:147], v108 offset:2048
    ds_read_b128 v[148:151], v110 offset:2048
    ds_read_b128 v[152:155], v109 offset:2048
    ds_read_b128 v[156:159], v111 offset:2048
    s_waitcnt lgkmcnt(6)
    v_mfma_f32_16x16x32_bf16 v[16:19], a[0:3], v[128:131], 0
    ds_read_b128 v[160:163], v108 offset:4096
    v_mfma_f32_16x16x32_bf16 v[32:35], v[128:131], v[128:131], 0
    s_add_u32 m0, s99, 8192
    s_mov_b32 s95, 512
    buffer_load_dwordx4 v12, s[32:35], s95 offen lds
    v_mfma_f32_16x16x32_bf16 v[20:23], a[0:3], v[132:135], 0
    s_waitcnt lgkmcnt(5)
    ds_read_b128 v[164:167], v110 offset:4096
    v_mfma_f32_16x16x32_bf16 v[40:43], v[64:67], v[128:131], 0
    ds_read_b128 v[168:171], v109 offset:4096
    v_mfma_f32_16x16x32_bf16 v[16:19], a[4:7], v[136:139], v[16:19]
    v_mfma_f32_16x16x32_bf16 v[48:51], a[64:67], v[128:131], 0
    ds_read_b128 v[172:175], v111 offset:4096
    v_mfma_f32_16x16x32_bf16 v[20:23], a[4:7], v[140:143], v[20:23]
    s_waitcnt lgkmcnt(6)
    s_add_u32 m0, s99, 9216
    s_mov_b32 s95, 576
    buffer_load_dwordx4 v12, s[32:35], s95 offen lds
    v_mfma_f32_16x16x32_bf16 v[16:19], a[8:11], v[144:147], v[16:19]
    ds_read_b128 v[176:179], v108 offset:6144
    v_mfma_f32_16x16x32_bf16 v[32:35], v[144:147], v[144:147], v[32:35]
    s_add_u32 m0, s99, 10240
    s_mov_b32 s95, 640
    buffer_load_dwordx4 v12, s[32:35], s95 offen lds
    v_mfma_f32_16x16x32_bf16 v[20:23], a[8:11], v[148:151], v[20:23]
    s_waitcnt lgkmcnt(5)
    ds_read_b128 v[180:183], v110 offset:6144
    v_mfma_f32_16x16x32_bf16 v[40:43], v[64:67], v[144:147], v[40:43]
    ds_read_b128 v[184:187], v109 offset:6144
    v_mfma_f32_16x16x32_bf16 v[16:19], a[12:15], v[152:155], v[16:19]
    v_mfma_f32_16x16x32_bf16 v[48:51], a[68:71], v[144:147], v[48:51]
    ds_read_b128 v[188:191], v111 offset:6144
    v_mfma_f32_16x16x32_bf16 v[20:23], a[12:15], v[156:159], v[20:23]
    s_waitcnt lgkmcnt(6)
    s_add_u32 m0, s99, 11264
    s_mov_b32 s95, 704
    buffer_load_dwordx4 v12, s[32:35], s95 offen lds
    v_mfma_f32_16x16x32_bf16 v[16:19], a[16:19], v[160:163], v[16:19]
    s_waitcnt vmcnt(15)
    s_barrier
    ds_read_b128 v[128:131], v108 offset:32768
    v_mfma_f32_16x16x32_bf16 v[32:35], v[160:163], v[160:163], v[32:35]
    s_add_u32 m0, s99, 40960
    s_mov_b32 s95, 33280
    buffer_load_dwordx4 v12, s[32:35], s95 offen lds
    v_mfma_f32_16x16x32_bf16 v[20:23], a[16:19], v[164:167], v[20:23]
    s_waitcnt lgkmcnt(5)
    ds_read_b128 v[132:135], v110 offset:32768
    v_mfma_f32_16x16x32_bf16 v[40:43], v[64:67], v[160:163], v[40:43]
    ds_read_b128 v[136:139], v109 offset:32768
    v_mfma_f32_16x16x32_bf16 v[16:19], a[20:23], v[168:171], v[16:19]
    v_mfma_f32_16x16x32_bf16 v[48:51], a[72:75], v[160:163], v[48:51]
    ds_read_b128 v[140:143], v111 offset:32768
    v_mfma_f32_16x16x32_bf16 v[20:23], a[20:23], v[172:175], v[20:23]
    s_waitcnt lgkmcnt(6)
    s_add_u32 m0, s99, 41984
    s_mov_b32 s95, 33344
    buffer_load_dwordx4 v12, s[32:35], s95 offen lds
    v_mfma_f32_16x16x32_bf16 v[16:19], a[24:27], v[176:179], v[16:19]
    ds_read_b128 v[144:147], v108 offset:34816
    v_mfma_f32_16x16x32_bf16 v[32:35], v[176:179], v[176:179], v[32:35]
    s_add_u32 m0, s99, 43008
    s_mov_b32 s95, 33408
    buffer_load_dwordx4 v12, s[32:35], s95 offen lds
    v_mfma_f32_16x16x32_bf16 v[20:23], a[24:27], v[180:183], v[20:23]
    s_waitcnt lgkmcnt(5)
    ds_read_b128 v[148:151], v110 offset:34816
    v_mfma_f32_16x16x32_bf16 v[40:43], v[64:67], v[176:179], v[40:43]
    ds_read_b128 v[152:155], v109 offset:34816
    v_mfma_f32_16x16x32_bf16 v[16:19], a[28:31], v[184:187], v[16:19]
    v_mfma_f32_16x16x32_bf16 v[48:51], a[76:79], v[176:179], v[48:51]
    ds_read_b128 v[156:159], v111 offset:34816
    v_mfma_f32_16x16x32_bf16 v[20:23], a[28:31], v[188:191], v[20:23]
    s_waitcnt lgkmcnt(6)
    s_add_u32 m0, s99, 44032
    s_mov_b32 s95, 33472
    buffer_load_dwordx4 v12, s[32:35], s95 offen lds
    v_mfma_f32_16x16x32_bf16 v[24:27], a[0:3], v[128:131], 0
    ds_read_b128 v[160:163], v108 offset:36864
    v_mfma_f32_16x16x32_bf16 v[36:39], v[128:131], v[128:131], 0
    v_mfma_f32_16x16x32_bf16 v[28:31], a[0:3], v[132:135], 0
    s_waitcnt lgkmcnt(5)
    ds_read_b128 v[164:167], v110 offset:36864
    v_mfma_f32_16x16x32_bf16 v[44:47], v[64:67], v[128:131], 0
    ds_read_b128 v[168:171], v109 offset:36864
    v_mfma_f32_16x16x32_bf16 v[24:27], a[4:7], v[136:139], v[24:27]
    v_mfma_f32_16x16x32_bf16 v[52:55], a[64:67], v[128:131], 0
    ds_read_b128 v[172:175], v111 offset:36864
    v_mfma_f32_16x16x32_bf16 v[28:31], a[4:7], v[140:143], v[28:31]
    s_waitcnt lgkmcnt(6)
    v_mfma_f32_16x16x32_bf16 v[24:27], a[8:11], v[144:147], v[24:27]
    ds_read_b128 v[176:179], v108 offset:38912
    v_mfma_f32_16x16x32_bf16 v[36:39], v[144:147], v[144:147], v[36:39]
    v_mfma_f32_16x16x32_bf16 v[28:31], a[8:11], v[148:151], v[28:31]
    s_waitcnt lgkmcnt(5)
    ds_read_b128 v[180:183], v110 offset:38912
    v_mfma_f32_16x16x32_bf16 v[44:47], v[64:67], v[144:147], v[44:47]
    ds_read_b128 v[184:187], v109 offset:38912
    v_mfma_f32_16x16x32_bf16 v[24:27], a[12:15], v[152:155], v[24:27]
    v_mfma_f32_16x16x32_bf16 v[52:55], a[68:71], v[144:147], v[52:55]
    ds_read_b128 v[188:191], v111 offset:38912
    v_mfma_f32_16x16x32_bf16 v[28:31], a[12:15], v[156:159], v[28:31]
    s_waitcnt lgkmcnt(6)
    v_mfma_f32_16x16x32_bf16 v[24:27], a[16:19], v[160:163], v[24:27]
    s_waitcnt vmcnt(4)
    s_barrier
    ds_read_b128 v[128:131], v108 offset:8192
    v_mfma_f32_16x16x32_bf16 v[36:39], v[160:163], v[160:163], v[36:39]
    v_mfma_f32_16x16x32_bf16 v[28:31], a[16:19], v[164:167], v[28:31]
    s_waitcnt lgkmcnt(5)
    ds_read_b128 v[132:135], v110 offset:8192
    v_mfma_f32_16x16x32_bf16 v[44:47], v[64:67], v[160:163], v[44:47]
    ds_read_b128 v[136:139], v109 offset:8192
    v_mfma_f32_16x16x32_bf16 v[24:27], a[20:23], v[168:171], v[24:27]
    v_mfma_f32_16x16x32_bf16 v[52:55], a[72:75], v[160:163], v[52:55]
    ds_read_b128 v[140:143], v111 offset:8192
    v_mfma_f32_16x16x32_bf16 v[28:31], a[20:23], v[172:175], v[28:31]
    s_waitcnt lgkmcnt(6)
    v_mfma_f32_16x16x32_bf16 v[24:27], a[24:27], v[176:179], v[24:27]
    ds_read_b128 v[144:147], v108 offset:10240
    v_mfma_f32_16x16x32_bf16 v[36:39], v[176:179], v[176:179], v[36:39]
    v_mfma_f32_16x16x32_bf16 v[28:31], a[24:27], v[180:183], v[28:31]
    s_waitcnt lgkmcnt(5)
    ds_read_b128 v[148:151], v110 offset:10240
    v_mfma_f32_16x16x32_bf16 v[44:47], v[64:67], v[176:179], v[44:47]
    ds_read_b128 v[152:155], v109 offset:10240
    v_mfma_f32_16x16x32_bf16 v[24:27], a[28:31], v[184:187], v[24:27]
    v_mfma_f32_16x16x32_bf16 v[52:55], a[76:79], v[176:179], v[52:55]
    ds_read_b128 v[156:159], v111 offset:10240
    v_mfma_f32_16x16x32_bf16 v[28:31], a[28:31], v[188:191], v[28:31]
    s_waitcnt lgkmcnt(6)
    s_barrier
    ds_read_b64_tr_b16 a[32:33], v8 offset:32768
    ds_read_b64_tr_b16 a[34:35], v8 offset:33280
    ds_read_b64_tr_b16 a[80:81], v120 offset:8192
    buffer_load_dwordx4 v[224:227], v250, s[56:59], s78 offen nt
    ds_read_b64_tr_b16 a[82:83], v120 offset:8320
    ds_read_b64_tr_b16 a[36:37], v9 offset:32768
    ds_read_b64_tr_b16 a[38:39], v9 offset:33280
    buffer_load_dwordx4 v[228:231], v250, s[56:59], s79 offen nt
    ds_read_b64_tr_b16 a[112:113], v121 offset:8192
    ds_read_b64_tr_b16 a[114:115], v121 offset:8320
    s_waitcnt lgkmcnt(12)
    ds_read_b64_tr_b16 a[40:41], v8 offset:40960
    buffer_load_dwordx4 v[232:235], v250, s[60:63], s18 offen nt
    ds_read_b64_tr_b16 a[42:43], v8 offset:41472
    s_waitcnt lgkmcnt(12)
    ds_read_b64_tr_b16 a[84:85], v120 offset:10240
    ds_read_b64_tr_b16 a[86:87], v120 offset:10368
    buffer_load_dwordx4 v[236:239], v250, s[60:63], s19 offen nt
    s_waitcnt lgkmcnt(12)
    ds_read_b64_tr_b16 a[44:45], v9 offset:40960
    ds_read_b64_tr_b16 a[46:47], v9 offset:41472
    s_waitcnt lgkmcnt(12)
    ds_read_b64_tr_b16 a[116:117], v121 offset:10240
    buffer_load_dwordx4 v[240:243], v251, s[64:67], s80 offen nt
    ds_read_b64_tr_b16 a[118:119], v121 offset:10368
    s_waitcnt lgkmcnt(12)
    v_mfma_f32_16x16x32_bf16 v[100:103], a[32:35], v[64:67], v[100:103]
    v_mfma_f32_16x16x32_bf16 v[104:107], a[80:83], v[64:67], v[104:107]
    s_waitcnt lgkmcnt(8)
    v_mfma_f32_16x16x32_bf16 v[100:103], a[36:39], v[64:67], v[100:103]
    v_mfma_f32_16x16x32_bf16 v[104:107], a[112:115], v[64:67], v[104:107]
    s_waitcnt lgkmcnt(4)
    v_mfma_f32_16x16x32_bf16 v[100:103], a[40:43], v[64:67], v[100:103]
    v_mfma_f32_16x16x32_bf16 v[104:107], a[84:87], v[64:67], v[104:107]
    s_waitcnt lgkmcnt(0)
    v_mfma_f32_16x16x32_bf16 v[100:103], a[44:47], v[64:67], v[100:103]
    v_mfma_f32_16x16x32_bf16 v[104:107], a[116:119], v[64:67], v[104:107]
    ds_read_b64_tr_b16 a[48:49], v8 offset:49152
    ds_read_b64_tr_b16 a[50:51], v8 offset:49664
    ds_read_b64_tr_b16 a[88:89], v120 offset:12288
    buffer_load_dwordx4 v[244:247], v251, s[64:67], s81 offen nt
    ds_read_b64_tr_b16 a[90:91], v120 offset:12416
    ds_read_b64_tr_b16 a[52:53], v9 offset:49152
    ds_read_b64_tr_b16 a[54:55], v9 offset:49664
    ds_read_b64_tr_b16 a[120:121], v121 offset:12288
    ds_read_b64_tr_b16 a[122:123], v121 offset:12416
    ds_read_b64_tr_b16 a[56:57], v8 offset:57344
    ds_read_b64_tr_b16 a[58:59], v8 offset:57856
    ds_read_b64_tr_b16 a[92:93], v120 offset:14336
    ds_read_b64_tr_b16 a[94:95], v120 offset:14464
    ds_read_b64_tr_b16 a[60:61], v9 offset:57344
    ds_read_b64_tr_b16 a[62:63], v9 offset:57856
    s_waitcnt lgkmcnt(12)
    ds_read_b64_tr_b16 a[124:125], v121 offset:14336
    ds_read_b64_tr_b16 a[126:127], v121 offset:14464
    s_waitcnt lgkmcnt(12)
    v_mfma_f32_16x16x32_bf16 v[100:103], a[48:51], v[64:67], v[100:103]
    v_mfma_f32_16x16x32_bf16 v[104:107], a[88:91], v[64:67], v[104:107]
    s_waitcnt lgkmcnt(8)
    v_mfma_f32_16x16x32_bf16 v[100:103], a[52:55], v[64:67], v[100:103]
    v_mfma_f32_16x16x32_bf16 v[104:107], a[120:123], v[64:67], v[104:107]
    s_waitcnt lgkmcnt(4)
    v_mfma_f32_16x16x32_bf16 v[100:103], a[56:59], v[64:67], v[100:103]
    v_mfma_f32_16x16x32_bf16 v[104:107], a[92:95], v[64:67], v[104:107]
    s_waitcnt lgkmcnt(0)
    v_mfma_f32_16x16x32_bf16 v[100:103], a[60:63], v[64:67], v[100:103]
    v_mfma_f32_16x16x32_bf16 v[104:107], a[124:127], v[64:67], v[104:107]
    v_mfma_f32_16x16x32_bf16 v[16:19], a[32:35], v[128:131], v[16:19]
    ds_read_b128 v[160:163], v108 offset:12288
    v_mfma_f32_16x16x32_bf16 v[32:35], v[128:131], v[128:131], v[32:35]
    v_mfma_f32_16x16x32_bf16 v[20:23], a[32:35], v[132:135], v[20:23]
    ds_read_b128 v[164:167], v110 offset:12288
    v_mfma_f32_16x16x32_bf16 v[40:43], v[64:67], v[128:131], v[40:43]
    ds_read_b128 v[168:171], v109 offset:12288
    v_mfma_f32_16x16x32_bf16 v[16:19], a[36:39], v[136:139], v[16:19]
    v_mfma_f32_16x16x32_bf16 v[48:51], a[80:83], v[128:131], v[48:51]
    ds_read_b128 v[172:175], v111 offset:12288
    v_mfma_f32_16x16x32_bf16 v[20:23], a[36:39], v[140:143], v[20:23]
    v_mfma_f32_16x16x32_bf16 v[16:19], a[40:43], v[144:147], v[16:19]
    ds_read_b128 v[176:179], v108 offset:14336
    v_mfma_f32_16x16x32_bf16 v[32:35], v[144:147], v[144:147], v[32:35]
    v_mfma_f32_16x16x32_bf16 v[20:23], a[40:43], v[148:151], v[20:23]
    ds_read_b128 v[180:183], v110 offset:14336
    v_mfma_f32_16x16x32_bf16 v[40:43], v[64:67], v[144:147], v[40:43]
    ds_read_b128 v[184:187], v109 offset:14336
    v_mfma_f32_16x16x32_bf16 v[16:19], a[44:47], v[152:155], v[16:19]
    v_mfma_f32_16x16x32_bf16 v[48:51], a[84:87], v[144:147], v[48:51]
    ds_read_b128 v[188:191], v111 offset:14336
    v_mfma_f32_16x16x32_bf16 v[20:23], a[44:47], v[156:159], v[20:23]
    s_waitcnt lgkmcnt(6)
    v_mfma_f32_16x16x32_bf16 v[16:19], a[48:51], v[160:163], v[16:19]
    s_waitcnt vmcnt(6)
    s_barrier
    ds_read_b128 v[128:131], v108 offset:40960
    v_mfma_f32_16x16x32_bf16 v[32:35], v[160:163], v[160:163], v[32:35]
    v_mfma_f32_16x16x32_bf16 v[20:23], a[48:51], v[164:167], v[20:23]
    s_waitcnt lgkmcnt(5)
    ds_read_b128 v[132:135], v110 offset:40960
    v_mfma_f32_16x16x32_bf16 v[40:43], v[64:67], v[160:163], v[40:43]
    ds_read_b128 v[136:139], v109 offset:40960
    v_mfma_f32_16x16x32_bf16 v[16:19], a[52:55], v[168:171], v[16:19]
    v_mfma_f32_16x16x32_bf16 v[48:51], a[88:91], v[160:163], v[48:51]
    ds_read_b128 v[140:143], v111 offset:40960
    v_mfma_f32_16x16x32_bf16 v[20:23], a[52:55], v[172:175], v[20:23]
    s_waitcnt lgkmcnt(6)
    v_mfma_f32_16x16x32_bf16 v[16:19], a[56:59], v[176:179], v[16:19]
    ds_read_b128 v[144:147], v108 offset:43008
    v_mfma_f32_16x16x32_bf16 v[32:35], v[176:179], v[176:179], v[32:35]
    v_mfma_f32_16x16x32_bf16 v[20:23], a[56:59], v[180:183], v[20:23]
    s_waitcnt lgkmcnt(5)
    ds_read_b128 v[148:151], v110 offset:43008
    v_mfma_f32_16x16x32_bf16 v[40:43], v[64:67], v[176:179], v[40:43]
    ds_read_b128 v[152:155], v109 offset:43008
    v_mfma_f32_16x16x32_bf16 v[16:19], a[60:63], v[184:187], v[16:19]
    v_mfma_f32_16x16x32_bf16 v[48:51], a[92:95], v[176:179], v[48:51]
    ds_read_b128 v[156:159], v111 offset:43008
    v_mfma_f32_16x16x32_bf16 v[20:23], a[60:63], v[188:191], v[20:23]
    s_waitcnt lgkmcnt(6)
    v_mfma_f32_16x16x32_bf16 v[24:27], a[32:35], v[128:131], v[24:27]
    ds_read_b128 v[160:163], v108 offset:45056
    v_mfma_f32_16x16x32_bf16 v[36:39], v[128:131], v[128:131], v[36:39]
    v_mfma_f32_16x16x32_bf16 v[28:31], a[32:35], v[132:135], v[28:31]
    s_waitcnt lgkmcnt(5)
    ds_read_b128 v[164:167], v110 offset:45056
    v_mfma_f32_16x16x32_bf16 v[44:47], v[64:67], v[128:131], v[44:47]
    ds_read_b128 v[168:171], v109 offset:45056
    v_cndmask_b32 v57, v32, v33, s[84:85]
    v_mfma_f32_16x16x32_bf16 v[24:27], a[36:39], v[136:139], v[24:27]
    v_cndmask_b32 v57, v57, v34, s[86:87]
    v_mfma_f32_16x16x32_bf16 v[52:55], a[80:83], v[128:131], v[52:55]
    ds_read_b128 v[172:175], v111 offset:45056
    v_cndmask_b32 v57, v57, v35, s[88:89]
    v_mfma_f32_16x16x32_bf16 v[28:31], a[36:39], v[140:143], v[28:31]
    s_waitcnt lgkmcnt(6)
    v_mov_b32 v56, v40
    v_mfma_f32_16x16x32_bf16 v[24:27], a[40:43], v[144:147], v[24:27]
    ds_read_b128 v[176:179], v108 offset:47104
    ds_write_b64 v112, v[56:57] offset:0
    v_mfma_f32_16x16x32_bf16 v[36:39], v[144:147], v[144:147], v[36:39]
    v_mfma_f32_16x16x32_bf16 v[28:31], a[40:43], v[148:151], v[28:31]
    s_waitcnt lgkmcnt(6)
    ds_read_b128 v[180:183], v110 offset:47104
    v_mfma_f32_16x16x32_bf16 v[44:47], v[64:67], v[144:147], v[44:47]
    ds_read_b128 v[184:187], v109 offset:47104
    v_mfma_f32_16x16x32_bf16 v[24:27], a[44:47], v[152:155], v[24:27]
    v_mfma_f32_16x16x32_bf16 v[52:55], a[84:87], v[144:147], v[52:55]
    ds_read_b128 v[188:191], v111 offset:47104
    v_mfma_f32_16x16x32_bf16 v[28:31], a[44:47], v[156:159], v[28:31]
    s_waitcnt lgkmcnt(7)
    v_mfma_f32_16x16x32_bf16 v[24:27], a[48:51], v[160:163], v[24:27]
    s_waitcnt lgkmcnt(3)
    s_barrier
    ds_read_b128 v[68:71], v113 offset:0
    v_mfma_f32_16x16x32_bf16 v[36:39], v[160:163], v[160:163], v[36:39]
    ds_read_b128 v[72:75], v114 offset:0
    v_mfma_f32_16x16x32_bf16 v[28:31], a[48:51], v[164:167], v[28:31]
    v_mfma_f32_16x16x32_bf16 v[44:47], v[64:67], v[160:163], v[44:47]
    v_mfma_f32_16x16x32_bf16 v[24:27], a[52:55], v[168:171], v[24:27]
    s_waitcnt lgkmcnt(0)
    v_mfma_f32_16x16x32_bf16 v[52:55], a[88:91], v[160:163], v[52:55]
    v_add_f32 v76, v68, v70
    v_add_f32 v78, v72, v74
    v_mfma_f32_16x16x32_bf16 v[28:31], a[52:55], v[172:175], v[28:31]
    v_add_f32 v77, v69, v71
    v_mfma_f32_16x16x32_bf16 v[24:27], a[56:59], v[176:179], v[24:27]
    v_add_f32 v79, v73, v75
    v_mul_f32 v76, 0x3b000000, v76
    v_mfma_f32_16x16x32_bf16 v[36:39], v[176:179], v[176:179], v[36:39]
    v_mul_f32 v78, 0x3b000000, v78
    v_mfma_f32_16x16x32_bf16 v[28:31], a[56:59], v[180:183], v[28:31]
    v_mul_f32 v77, 0x3b000000, v77
    v_mfma_f32_16x16x32_bf16 v[44:47], v[64:67], v[176:179], v[44:47]
    v_mul_f32 v79, 0x3b000000, v79
    v_fma_f32 v77, -v76, v76, v77
    v_mfma_f32_16x16x32_bf16 v[24:27], a[60:63], v[184:187], v[24:27]
    v_fma_f32 v79, -v78, v78, v79
    v_mfma_f32_16x16x32_bf16 v[52:55], a[92:95], v[176:179], v[52:55]
    v_max_f32 v77, 0, v77
    v_max_f32 v79, 0, v79
    v_mfma_f32_16x16x32_bf16 v[28:31], a[60:63], v[188:191], v[28:31]
    v_add_f32 v77, 0x3727c5ac, v77
    v_add_f32 v79, 0x3727c5ac, v79
    v_rsq_f32 v77, v77
    v_rsq_f32 v79, v79
    v_fma_f32 v16, -v76, v100, v16
    v_fma_f32 v20, -v78, v100, v20
    v_fma_f32 v17, -v76, v101, v17
    v_fma_f32 v21, -v78, v101, v21
    v_fma_f32 v18, -v76, v102, v18
    v_fma_f32 v22, -v78, v102, v22
    v_fma_f32 v19, -v76, v103, v19
    v_fma_f32 v23, -v78, v103, v23
    v_mul_f32 v68, 0x3eb8aa3b, v77
    v_mul_f32 v72, 0x3eb8aa3b, v79
    v_mul_f32 v16, v68, v16
    v_mul_f32 v20, v72, v20
    v_mul_f32 v17, v68, v17
    v_mul_f32 v21, v72, v21
    v_mul_f32 v18, v68, v18
    v_mul_f32 v22, v72, v22
    v_mul_f32 v19, v68, v19
    v_mul_f32 v23, v72, v23
    v_cvt_pk_bf16_f32 v84, v16, v17
    v_cvt_pk_bf16_f32 v86, v20, v21
    v_cvt_pk_bf16_f32 v85, v18, v19
    v_cvt_pk_bf16_f32 v87, v22, v23
    s_nop 0
    v_permlane16_swap_b32 v84, v86
    v_permlane16_swap_b32 v85, v87
    s_add_u32 s76, s100, 0
    buffer_store_dwordx4 v[84:87], v115, s[44:47], s76 offen sc1
    s_branch L_QKV_EPI
L_QKV_X:
    s_barrier
    ds_read_b128 v[128:131], v108 offset:0
    ds_read_b128 v[132:135], v110 offset:0
    ds_read_b128 v[136:139], v109 offset:0
    ds_read_b128 v[140:143], v111 offset:0
    ds_read_b128 v[144:147], v108 offset:2048
    ds_read_b128 v[148:151], v110 offset:2048
    ds_read_b128 v[152:155], v109 offset:2048
    ds_read_b128 v[156:159], v111 offset:2048
    s_waitcnt lgkmcnt(6)
    v_mfma_f32_16x16x32_bf16 v[16:19], a[0:3], v[128:131], 0
    ds_read_b128 v[160:163], v108 offset:4096
    v_mfma_f32_16x16x32_bf16 v[32:35], v[128:131], v[128:131], 0
    v_mfma_f32_16x16x32_bf16 v[20:23], a[0:3], v[132:135], 0
    s_waitcnt lgkmcnt(5)
    ds_read_b128 v[164:167], v110 offset:4096
    v_mfma_f32_16x16x32_bf16 v[40:43], v[64:67], v[128:131], 0
    ds_read_b128 v[168:171], v109 offset:4096
    v_mfma_f32_16x16x32_bf16 v[16:19], a[4:7], v[136:139], v[16:19]
    v_mfma_f32_16x16x32_bf16 v[48:51], a[64:67], v[128:131], 0
    ds_read_b128 v[172:175], v111 offset:4096
    v_mfma_f32_16x16x32_bf16 v[20:23], a[4:7], v[140:143], v[20:23]
    s_waitcnt lgkmcnt(6)
    v_mfma_f32_16x16x32_bf16 v[16:19], a[8:11], v[144:147], v[16:19]
    ds_read_b128 v[176:179], v108 offset:6144
    v_mfma_f32_16x16x32_bf16 v[32:35], v[144:147], v[144:147], v[32:35]
    v_mfma_f32_16x16x32_bf16 v[20:23], a[8:11], v[148:151], v[20:23]
    s_waitcnt lgkmcnt(5)
    ds_read_b128 v[180:183], v110 offset:6144
    v_mfma_f32_16x16x32_bf16 v[40:43], v[64:67], v[144:147], v[40:43]
    ds_read_b128 v[184:187], v109 offset:6144
    v_mfma_f32_16x16x32_bf16 v[16:19], a[12:15], v[152:155], v[16:19]
    v_mfma_f32_16x16x32_bf16 v[48:51], a[68:71], v[144:147], v[48:51]
    ds_read_b128 v[188:191], v111 offset:6144
    v_mfma_f32_16x16x32_bf16 v[20:23], a[12:15], v[156:159], v[20:23]
    s_waitcnt lgkmcnt(6)
    v_mfma_f32_16x16x32_bf16 v[16:19], a[16:19], v[160:163], v[16:19]
    s_waitcnt vmcnt(0)
    s_cmp_lg_u32 s3, 0
    s_cbranch_scc1 L_s4f_1
    v_cmp_ne_u32 vcc, v124, v2
    s_cbranch_vccz L_s4f_1
    s_mov_b32 s82, 200000
L_poll_s4f_2:
    buffer_load_dword v124, v123, s[48:51], 0 offen sc1
    s_waitcnt vmcnt(0)
    v_cmp_ne_u32 vcc, v124, v2
    s_cbranch_vccz L_polld_s4f_3
    s_sub_u32 s82, s82, 1
    s_cmp_lg_u32 s82, 0
    s_cbranch_scc1 L_poll_s4f_2
    s_branch L_TIMEOUT
L_polld_s4f_3:
L_s4f_1:
    s_barrier
    ds_read_b128 v[128:131], v108 offset:8192
    v_mfma_f32_16x16x32_bf16 v[32:35], v[160:163], v[160:163], v[32:35]
    s_add_u32 m0, s99, 32768
    s_mov_b32 s95, 32768
    buffer_load_dwordx4 v12, s[32:35], s95 offen sc1 lds
    v_mfma_f32_16x16x32_bf16 v[20:23], a[16:19], v[164:167], v[20:23]
    s_waitcnt lgkmcnt(5)
    ds_read_b128 v[132:135], v110 offset:8192
    v_mfma_f32_16x16x32_bf16 v[40:43], v[64:67], v[160:163], v[40:43]
    ds_read_b128 v[136:139], v109 offset:8192
    v_mfma_f32_16x16x32_bf16 v[16:19], a[20:23], v[168:171], v[16:19]
    s_add_u32 m0, s99, 33792
    s_mov_b32 s95, 34816
    buffer_load_dwordx4 v12, s[32:35], s95 offen sc1 lds
    v_mfma_f32_16x16x32_bf16 v[48:51], a[72:75], v[160:163], v[48:51]
    ds_read_b128 v[140:143], v111 offset:8192
    s_add_u32 m0, s99, 34816
    s_mov_b32 s95, 36864
    buffer_load_dwordx4 v12, s[32:35], s95 offen sc1 lds
    v_mfma_f32_16x16x32_bf16 v[20:23], a[20:23], v[172:175], v[20:23]
    s_waitcnt lgkmcnt(6)
    s_add_u32 m0, s99, 35840
    s_mov_b32 s95, 38912
    buffer_load_dwordx4 v12, s[32:35], s95 offen sc1 lds
    v_mfma_f32_16x16x32_bf16 v[16:19], a[24:27], v[176:179], v[16:19]
    ds_read_b128 v[144:147], v108 offset:10240
    v_mfma_f32_16x16x32_bf16 v[32:35], v[176:179], v[176:179], v[32:35]
    s_add_u32 m0, s99, 40960
    s_mov_b32 s95, 49152
    buffer_load_dwordx4 v12, s[32:35], s95 offen sc1 lds
    v_mfma_f32_16x16x32_bf16 v[20:23], a[24:27], v[180:183], v[20:23]
    s_waitcnt lgkmcnt(5)
    ds_read_b128 v[148:151], v110 offset:10240
    v_mfma_f32_16x16x32_bf16 v[40:43], v[64:67], v[176:179], v[40:43]
    ds_read_b128 v[152:155], v109 offset:10240
    v_mfma_f32_16x16x32_bf16 v[16:19], a[28:31], v[184:187], v[16:19]
    s_add_u32 m0, s99, 41984
    s_mov_b32 s95, 51200
    buffer_load_dwordx4 v12, s[32:35], s95 offen sc1 lds
    v_mfma_f32_16x16x32_bf16 v[48:51], a[76:79], v[176:179], v[48:51]
    ds_read_b128 v[156:159], v111 offset:10240
    s_add_u32 m0, s99, 43008
    s_mov_b32 s95, 53248
    buffer_load_dwordx4 v12, s[32:35], s95 offen sc1 lds
    v_mfma_f32_16x16x32_bf16 v[20:23], a[28:31], v[188:191], v[20:23]
    s_waitcnt lgkmcnt(6)
    s_add_u32 m0, s99, 44032
    s_mov_b32 s95, 55296
    buffer_load_dwordx4 v12, s[32:35], s95 offen sc1 lds
    v_mfma_f32_16x16x32_bf16 v[16:19], a[32:35], v[128:131], v[16:19]
    ds_read_b128 v[160:163], v108 offset:12288
    v_mfma_f32_16x16x32_bf16 v[32:35], v[128:131], v[128:131], v[32:35]
    v_mfma_f32_16x16x32_bf16 v[20:23], a[32:35], v[132:135], v[20:23]
    s_waitcnt lgkmcnt(5)
    ds_read_b128 v[164:167], v110 offset:12288
    v_mfma_f32_16x16x32_bf16 v[40:43], v[64:67], v[128:131], v[40:43]
    ds_read_b128 v[168:171], v109 offset:12288
    v_mfma_f32_16x16x32_bf16 v[16:19], a[36:39], v[136:139], v[16:19]
    v_mfma_f32_16x16x32_bf16 v[48:51], a[80:83], v[128:131], v[48:51]
    ds_read_b128 v[172:175], v111 offset:12288
    v_mfma_f32_16x16x32_bf16 v[20:23], a[36:39], v[140:143], v[20:23]
    s_waitcnt lgkmcnt(6)
    v_mfma_f32_16x16x32_bf16 v[16:19], a[40:43], v[144:147], v[16:19]
    ds_read_b128 v[176:179], v108 offset:14336
    v_mfma_f32_16x16x32_bf16 v[32:35], v[144:147], v[144:147], v[32:35]
    v_mfma_f32_16x16x32_bf16 v[20:23], a[40:43], v[148:151], v[20:23]
    s_waitcnt lgkmcnt(5)
    ds_read_b128 v[180:183], v110 offset:14336
    v_mfma_f32_16x16x32_bf16 v[40:43], v[64:67], v[144:147], v[40:43]
    ds_read_b128 v[184:187], v109 offset:14336
    v_mfma_f32_16x16x32_bf16 v[16:19], a[44:47], v[152:155], v[16:19]
    v_mfma_f32_16x16x32_bf16 v[48:51], a[84:87], v[144:147], v[48:51]
    ds_read_b128 v[188:191], v111 offset:14336
    v_mfma_f32_16x16x32_bf16 v[20:23], a[44:47], v[156:159], v[20:23]
    s_waitcnt lgkmcnt(6)
    v_mfma_f32_16x16x32_bf16 v[16:19], a[48:51], v[160:163], v[16:19]
    s_waitcnt vmcnt(4)
    s_barrier
    ds_read_b128 v[128:131], v108 offset:32768
    v_mfma_f32_16x16x32_bf16 v[32:35], v[160:163], v[160:163], v[32:35]
    v_mfma_f32_16x16x32_bf16 v[20:23], a[48:51], v[164:167], v[20:23]
    s_waitcnt lgkmcnt(5)
    ds_read_b128 v[132:135], v110 offset:32768
    v_mfma_f32_16x16x32_bf16 v[40:43], v[64:67], v[160:163], v[40:43]
    ds_read_b128 v[136:139], v109 offset:32768
    v_mfma_f32_16x16x32_bf16 v[16:19], a[52:55], v[168:171], v[16:19]
    v_mfma_f32_16x16x32_bf16 v[48:51], a[88:91], v[160:163], v[48:51]
    ds_read_b128 v[140:143], v111 offset:32768
    v_mfma_f32_16x16x32_bf16 v[20:23], a[52:55], v[172:175], v[20:23]
    s_waitcnt lgkmcnt(6)
    v_mfma_f32_16x16x32_bf16 v[16:19], a[56:59], v[176:179], v[16:19]
    ds_read_b128 v[144:147], v108 offset:34816
    v_mfma_f32_16x16x32_bf16 v[32:35], v[176:179], v[176:179], v[32:35]
    v_mfma_f32_16x16x32_bf16 v[20:23], a[56:59], v[180:183], v[20:23]
    s_waitcnt lgkmcnt(5)
    ds_read_b128 v[148:151], v110 offset:34816
    v_mfma_f32_16x16x32_bf16 v[40:43], v[64:67], v[176:179], v[40:43]
    ds_read_b128 v[152:155], v109 offset:34816
    v_mfma_f32_16x16x32_bf16 v[16:19], a[60:63], v[184:187], v[16:19]
    v_mfma_f32_16x16x32_bf16 v[48:51], a[92:95], v[176:179], v[48:51]
    ds_read_b128 v[156:159], v111 offset:34816
    v_mfma_f32_16x16x32_bf16 v[20:23], a[60:63], v[188:191], v[20:23]
    s_waitcnt lgkmcnt(6)
    v_mfma_f32_16x16x32_bf16 v[24:27], a[0:3], v[128:131], 0
    ds_read_b128 v[160:163], v108 offset:36864
    v_mfma_f32_16x16x32_bf16 v[36:39], v[128:131], v[128:131], 0
    v_mfma_f32_16x16x32_bf16 v[28:31], a[0:3], v[132:135], 0
    s_waitcnt lgkmcnt(5)
    ds_read_b128 v[164:167], v110 offset:36864
    v_mfma_f32_16x16x32_bf16 v[44:47], v[64:67], v[128:131], 0
    ds_read_b128 v[168:171], v109 offset:36864
    v_cndmask_b32 v57, v32, v33, s[84:85]
    v_mfma_f32_16x16x32_bf16 v[24:27], a[4:7], v[136:139], v[24:27]
    v_cndmask_b32 v57, v57, v34, s[86:87]
    v_cndmask_b32 v57, v57, v35, s[88:89]
    v_mfma_f32_16x16x32_bf16 v[52:55], a[64:67], v[128:131], 0
    ds_read_b128 v[172:175], v111 offset:36864
    v_mov_b32 v56, v40
    ds_write_b64 v112, v[56:57] offset:0
    v_mfma_f32_16x16x32_bf16 v[28:31], a[4:7], v[140:143], v[28:31]
    s_waitcnt lgkmcnt(7)
    v_mfma_f32_16x16x32_bf16 v[24:27], a[8:11], v[144:147], v[24:27]
    ds_read_b128 v[176:179], v108 offset:38912
    v_mfma_f32_16x16x32_bf16 v[36:39], v[144:147], v[144:147], v[36:39]
    v_mfma_f32_16x16x32_bf16 v[28:31], a[8:11], v[148:151], v[28:31]
    s_waitcnt lgkmcnt(6)
    ds_read_b128 v[180:183], v110 offset:38912
    v_mfma_f32_16x16x32_bf16 v[44:47], v[64:67], v[144:147], v[44:47]
    ds_read_b128 v[184:187], v109 offset:38912
    v_mfma_f32_16x16x32_bf16 v[24:27], a[12:15], v[152:155], v[24:27]
    v_mfma_f32_16x16x32_bf16 v[52:55], a[68:71], v[144:147], v[52:55]
    ds_read_b128 v[188:191], v111 offset:38912
    v_mfma_f32_16x16x32_bf16 v[28:31], a[12:15], v[156:159], v[28:31]
    s_waitcnt lgkmcnt(7)
    v_mfma_f32_16x16x32_bf16 v[24:27], a[16:19], v[160:163], v[24:27]
    s_waitcnt lgkmcnt(4)
    s_waitcnt vmcnt(0)
    s_barrier
    ds_read_b128 v[128:131], v108 offset:40960
    ds_read_b128 v[68:71], v113 offset:0
    v_mfma_f32_16x16x32_bf16 v[36:39], v[160:163], v[160:163], v[36:39]
    ds_read_b128 v[72:75], v114 offset:0
    v_mfma_f32_16x16x32_bf16 v[28:31], a[16:19], v[164:167], v[28:31]
    ds_read_b128 v[132:135], v110 offset:40960
    v_mfma_f32_16x16x32_bf16 v[44:47], v[64:67], v[160:163], v[44:47]
    ds_read_b128 v[136:139], v109 offset:40960
    v_mfma_f32_16x16x32_bf16 v[24:27], a[20:23], v[168:171], v[24:27]
    v_mfma_f32_16x16x32_bf16 v[52:55], a[72:75], v[160:163], v[52:55]
    ds_read_b128 v[140:143], v111 offset:40960
    s_waitcnt lgkmcnt(3)
    v_add_f32 v76, v68, v70
    v_mfma_f32_16x16x32_bf16 v[28:31], a[20:23], v[172:175], v[28:31]
    v_add_f32 v78, v72, v74
    v_mfma_f32_16x16x32_bf16 v[24:27], a[24:27], v[176:179], v[24:27]
    ds_read_b128 v[144:147], v108 offset:43008
    v_add_f32 v77, v69, v71
    v_mfma_f32_16x16x32_bf16 v[36:39], v[176:179], v[176:179], v[36:39]
    v_add_f32 v79, v73, v75
    v_mfma_f32_16x16x32_bf16 v[28:31], a[24:27], v[180:183], v[28:31]
    ds_read_b128 v[148:151], v110 offset:43008
    v_mfma_f32_16x16x32_bf16 v[44:47], v[64:67], v[176:179], v[44:47]
    ds_read_b128 v[152:155], v109 offset:43008
    v_mul_f32 v76, 0x3b000000, v76
    v_mfma_f32_16x16x32_bf16 v[24:27], a[28:31], v[184:187], v[24:27]
    v_mul_f32 v78, 0x3b000000, v78
    v_mul_f32 v77, 0x3b000000, v77
    v_mfma_f32_16x16x32_bf16 v[52:55], a[76:79], v[176:179], v[52:55]
    ds_read_b128 v[156:159], v111 offset:43008
    v_mul_f32 v79, 0x3b000000, v79
    v_fma_f32 v77, -v76, v76, v77
    v_mfma_f32_16x16x32_bf16 v[28:31], a[28:31], v[188:191], v[28:31]
    s_waitcnt lgkmcnt(6)
    v_fma_f32 v79, -v78, v78, v79
    v_mfma_f32_16x16x32_bf16 v[24:27], a[32:35], v[128:131], v[24:27]
    ds_read_b128 v[160:163], v108 offset:45056
    v_max_f32 v77, 0, v77
    v_mfma_f32_16x16x32_bf16 v[36:39], v[128:131], v[128:131], v[36:39]
    v_max_f32 v79, 0, v79
    v_mfma_f32_16x16x32_bf16 v[28:31], a[32:35], v[132:135], v[28:31]
    s_waitcnt lgkmcnt(5)
    ds_read_b128 v[164:167], v110 offset:45056
    v_mfma_f32_16x16x32_bf16 v[44:47], v[64:67], v[128:131], v[44:47]
    ds_read_b128 v[168:171], v109 offset:45056
    v_add_f32 v77, 0x3727c5ac, v77
    v_mfma_f32_16x16x32_bf16 v[24:27], a[36:39], v[136:139], v[24:27]
    v_add_f32 v79, 0x3727c5ac, v79
    v_rsq_f32 v77, v77
    v_mfma_f32_16x16x32_bf16 v[52:55], a[80:83], v[128:131], v[52:55]
    ds_read_b128 v[172:175], v111 offset:45056
    v_rsq_f32 v79, v79
    v_fma_f32 v16, -v76, v100, v16
    v_mfma_f32_16x16x32_bf16 v[28:31], a[36:39], v[140:143], v[28:31]
    s_waitcnt lgkmcnt(6)
    v_fma_f32 v20, -v78, v100, v20
    v_mfma_f32_16x16x32_bf16 v[24:27], a[40:43], v[144:147], v[24:27]
    ds_read_b128 v[176:179], v108 offset:47104
    v_fma_f32 v17, -v76, v101, v17
    v_mfma_f32_16x16x32_bf16 v[36:39], v[144:147], v[144:147], v[36:39]
    v_fma_f32 v21, -v78, v101, v21
    v_mfma_f32_16x16x32_bf16 v[28:31], a[40:43], v[148:151], v[28:31]
    s_waitcnt lgkmcnt(5)
    ds_read_b128 v[180:183], v110 offset:47104
    v_mfma_f32_16x16x32_bf16 v[44:47], v[64:67], v[144:147], v[44:47]
    ds_read_b128 v[184:187], v109 offset:47104
    v_fma_f32 v18, -v76, v102, v18
    v_mfma_f32_16x16x32_bf16 v[24:27], a[44:47], v[152:155], v[24:27]
    v_fma_f32 v22, -v78, v102, v22
    v_fma_f32 v19, -v76, v103, v19
    v_mfma_f32_16x16x32_bf16 v[52:55], a[84:87], v[144:147], v[52:55]
    ds_read_b128 v[188:191], v111 offset:47104
    v_fma_f32 v23, -v78, v103, v23
    v_mul_f32 v68, 0x3eb8aa3b, v77
    v_mfma_f32_16x16x32_bf16 v[28:31], a[44:47], v[156:159], v[28:31]
    s_waitcnt lgkmcnt(6)
    v_mul_f32 v72, 0x3eb8aa3b, v79
    v_mfma_f32_16x16x32_bf16 v[24:27], a[48:51], v[160:163], v[24:27]
    v_mul_f32 v16, v68, v16
    v_mul_f32 v20, v72, v20
    v_mfma_f32_16x16x32_bf16 v[36:39], v[160:163], v[160:163], v[36:39]
    v_mul_f32 v17, v68, v17
    v_mfma_f32_16x16x32_bf16 v[28:31], a[48:51], v[164:167], v[28:31]
    s_waitcnt lgkmcnt(4)
    v_mul_f32 v21, v72, v21
    v_mfma_f32_16x16x32_bf16 v[44:47], v[64:67], v[160:163], v[44:47]
    v_mul_f32 v18, v68, v18
    v_mul_f32 v22, v72, v22
    v_mfma_f32_16x16x32_bf16 v[24:27], a[52:55], v[168:171], v[24:27]
    v_mul_f32 v19, v68, v19
    v_mul_f32 v23, v72, v23
    v_mfma_f32_16x16x32_bf16 v[52:55], a[88:91], v[160:163], v[52:55]
    v_cvt_pk_bf16_f32 v84, v16, v17
    v_cvt_pk_bf16_f32 v86, v20, v21
    v_cvt_pk_bf16_f32 v85, v18, v19
    v_mfma_f32_16x16x32_bf16 v[28:31], a[52:55], v[172:175], v[28:31]
    s_waitcnt lgkmcnt(2)
    v_cvt_pk_bf16_f32 v87, v22, v23
    v_mfma_f32_16x16x32_bf16 v[24:27], a[56:59], v[176:179], v[24:27]
    s_nop 0
    v_permlane16_swap_b32 v84, v86
    v_permlane16_swap_b32 v85, v87
    s_add_u32 s76, s100, 0
    buffer_store_dwordx4 v[84:87], v115, s[44:47], s76 offen sc1
    v_mfma_f32_16x16x32_bf16 v[36:39], v[176:179], v[176:179], v[36:39]
    v_mfma_f32_16x16x32_bf16 v[28:31], a[56:59], v[180:183], v[28:31]
    s_waitcnt lgkmcnt(0)
    v_mfma_f32_16x16x32_bf16 v[44:47], v[64:67], v[176:179], v[44:47]
    v_mfma_f32_16x16x32_bf16 v[24:27], a[60:63], v[184:187], v[24:27]
    v_mfma_f32_16x16x32_bf16 v[52:55], a[92:95], v[176:179], v[52:55]
    v_mfma_f32_16x16x32_bf16 v[28:31], a[60:63], v[188:191], v[28:31]
L_QKV_EPI:
    s_nop 6
    v_cndmask_b32 v60, v52, v48, s[24:25]
    v_cndmask_b32 v61, v53, v49, s[24:25]
    v_cndmask_b32 v62, v54, v50, s[24:25]
    v_cndmask_b32 v63, v55, v51, s[24:25]
    v_cndmask_b32 v57, v36, v37, s[84:85]
    v_cndmask_b32 v57, v57, v38, s[86:87]
    v_cndmask_b32 v57, v57, v39, s[88:89]
    v_mov_b32 v56, v44
    ds_write_b64 v112, v[56:57] offset:512
    ds_write_b128 v119, v[60:63]
    v_cndmask_b32 v48, v48, v52, s[24:25]
    v_cndmask_b32 v49, v49, v53, s[24:25]
    v_cndmask_b32 v50, v50, v54, s[24:25]
    v_cndmask_b32 v51, v51, v55, s[24:25]
    s_waitcnt lgkmcnt(0)
    s_barrier
    ds_read_b128 v[68:71], v113 offset:512
    ds_read_b128 v[72:75], v114 offset:512
    ds_read_b128 v[60:63], v122
    s_waitcnt lgkmcnt(1)
    v_add_f32 v80, v68, v70
    v_add_f32 v82, v72, v74
    v_add_f32 v81, v69, v71
    v_add_f32 v83, v73, v75
    v_mul_f32 v80, 0x3b000000, v80
    v_mul_f32 v82, 0x3b000000, v82
    v_mul_f32 v81, 0x3b000000, v81
    v_mul_f32 v83, 0x3b000000, v83
    v_fma_f32 v81, -v80, v80, v81
    v_fma_f32 v83, -v82, v82, v83
    v_max_f32 v81, 0, v81
    v_max_f32 v83, 0, v83
    v_add_f32 v81, 0x3727c5ac, v81
    v_add_f32 v83, 0x3727c5ac, v83
    v_rsq_f32 v81, v81
    v_rsq_f32 v83, v83
    v_cndmask_b32 v56, v76, v80, s[24:25]
    s_waitcnt lgkmcnt(0)
    v_add_f32 v60, v60, v48
    v_add_f32 v61, v61, v49
    v_add_f32 v62, v62, v50
    v_add_f32 v63, v63, v51
    v_cndmask_b32 v57, v77, v81, s[24:25]
    v_fma_f32 v60, -v56, v104, v60
    v_fma_f32 v61, -v56, v105, v61
    v_fma_f32 v62, -v56, v106, v62
    v_fma_f32 v63, -v56, v107, v63
    v_mul_f32 v60, v57, v60
    v_mul_f32 v61, v57, v61
    v_mul_f32 v62, v57, v62
    v_mul_f32 v63, v57, v63
    v_cvt_pk_bf16_f32 v92, v60, v61
    v_cvt_pk_bf16_f32 v93, v62, v63
    ds_write_b64 v117, v[92:93]
    v_fma_f32 v24, -v80, v100, v24
    v_fma_f32 v28, -v82, v100, v28
    v_fma_f32 v25, -v80, v101, v25
    v_fma_f32 v29, -v82, v101, v29
    v_fma_f32 v26, -v80, v102, v26
    v_fma_f32 v30, -v82, v102, v30
    v_fma_f32 v27, -v80, v103, v27
    v_fma_f32 v31, -v82, v103, v31
    v_mul_f32 v68, 0x3eb8aa3b, v81
    v_mul_f32 v72, 0x3eb8aa3b, v83
    s_waitcnt lgkmcnt(0)
    ds_read_b64_tr_b16 v[94:95], v118
    v_mul_f32 v24, v68, v24
    v_mul_f32 v28, v72, v28
    v_mul_f32 v25, v68, v25
    v_mul_f32 v29, v72, v29
    v_mul_f32 v26, v68, v26
    v_mul_f32 v30, v72, v30
    v_mul_f32 v27, v68, v27
    v_mul_f32 v31, v72, v31
    v_cvt_pk_bf16_f32 v88, v24, v25
    v_cvt_pk_bf16_f32 v90, v28, v29
    v_cvt_pk_bf16_f32 v89, v26, v27
    v_cvt_pk_bf16_f32 v91, v30, v31
    s_cmp_eq_u32 s69, 0
    s_cselect_b64 vcc, -1, 0
    s_mov_b32 s84, 0x0000ffff
    s_mov_b32 s85, 0x0000ffff
    s_waitcnt lgkmcnt(0)
    v_cndmask_b32 v92, v94, v92, vcc
    v_cndmask_b32 v93, v95, v93, vcc
    v_mov_b32 v94, v92
    v_mov_b32 v95, v93
    s_nop 0
    v_permlane16_swap_b32 v88, v90
    v_permlane16_swap_b32 v89, v91
    s_add_u32 s76, s100, 32768
    buffer_store_dwordx4 v[88:91], v115, s[44:47], s76 offen sc1
    v_permlane16_swap_b32 v92, v94
    v_permlane16_swap_b32 v93, v95
    s_cmp_ge_u32 s69, 2
    s_cbranch_scc1 L_nokvep_4
    s_mov_b64 exec, s[84:85]
    buffer_store_dwordx4 v[92:95], v116, s[44:47], s101 offen sc1
    s_mov_b64 exec, -1
L_nokvep_4:
    v_and_b32 v5, 11, v0
    v_cmp_eq_u32 vcc, 0, v5
    v_lshlrev_b32 v4, 4, v0
    v_add_u32 v4, 131072, v4
    v_cndmask_b32 v64, 0, v64, vcc
    v_cndmask_b32 v65, 0, v65, vcc
    v_cndmask_b32 v66, 0, v66, vcc
    v_cndmask_b32 v67, 0, v67, vcc
    ds_write_b128 v4, v[64:67]
    ds_write_b128 v4, v[64:67] offset:4096
    v_and_b32 v4, 63, v0
    v_and_b32 v5, 7, v4
    v_bfe_u32 v6, v4, 3, 1
    v_lshrrev_b32 v7, 4, v4
    v_lshlrev_b32 v8, 12, v6
    v_lshrrev_b32 v9, 1, v7
    v_lshl_add_u32 v8, v9, 10, v8
    v_and_b32 v9, 1, v7
    v_lshl_add_u32 v8, v9, 9, v8
    v_lshl_add_u32 v8, v5, 4, v8
    s_lshr_b32 s76, s70, 2
    s_lshl_b32 s76, s76, 15
    s_lshl_b32 s77, s3, 13
    s_add_u32 s76, s76, s77
    s_and_b32 s77, s70, 3
    s_lshl_b32 s77, s77, 7
    s_add_u32 s76, s76, s77
    v_add_u32 v122, s76, v8
    v_lshlrev_b32 v8, 10, v5
    v_lshl_add_u32 v8, v6, 7, v8
    v_lshl_add_u32 v8, v7, 4, v8
    s_lshl_b32 s76, s70, 13
    s_lshl_b32 s77, s3, 8
    s_add_u32 s76, s76, s77
    v_add_u32 v8, s76, v8
    s_cmp_eq_u32 s6, 0
    s_cselect_b64 vcc, -1, 0
    s_cselect_b32 s95, 64, 2048
    v_cndmask_b32 v125, v122, v8, vcc
    v_and_b32 v5, 15, v4
    v_lshrrev_b32 v6, 5, v4
    v_lshlrev_b32 v5, 4, v5
    v_lshl_add_u32 v5, v6, 8, v5
    v_bfe_u32 v6, v4, 4, 1
    v_cmp_eq_u32 vcc, 0, v6
    v_mov_b32 v7, 131072
    s_and_b32 s76, s3, 1
    s_lshl_b32 s76, s76, 15
    v_add_u32 v127, s76, v1
    s_add_u32 s76, s76, 65536
    v_mov_b32 v8, s76
    v_cndmask_b32 v7, v7, v8, vcc
    v_add_u32 v97, v5, v7
    v_mov_b32 v7, 0
    v_mov_b32 v8, 0x2000
    v_cndmask_b32 v98, v7, v8, vcc
    v_mov_b32 v96, 0xdddd
    s_mul_i32 s76, s3, 3072
    s_add_u32 s76, s76, 147456
    v_add_u32 v109, s76, v1
    s_xor_b32 s76, s3, 1
    s_mul_i32 s76, s76, 3072
    s_add_u32 s76, s76, 147456
    v_add_u32 v108, s76, v1
    v_bfe_u32 v5, v4, 4, 1
    v_lshlrev_b32 v5, 9, v5
    v_bfe_u32 v6, v4, 3, 1
    v_lshl_add_u32 v5, v6, 8, v5
    v_lshrrev_b32 v6, 5, v4
    v_lshl_add_u32 v5, v6, 7, v5
    v_and_b32 v6, 7, v4
    v_lshl_add_u32 v5, v6, 4, v5
    s_lshl_b32 s76, s3, 10
    s_add_u32 s76, s76, 139264
    v_add_u32 v120, s76, v5
    v_lshrrev_b32 v5, 4, v4
    v_lshlrev_b32 v5, 7, v5
    v_lshl_add_u32 v5, v6, 4, v5
    v_add_u32 v99, 139264, v5
    v_min_u32 v126, 223, v0
    v_lshlrev_b32 v126, 4, v126
    v_add_u32 v126, 4096, v126
    v_and_b32 v123, 31, v0
    v_lshlrev_b32 v123, 7, v123
    v_add_u32 v123, 8192, v123
    v_and_b32 v9, 63, v0
    v_lshrrev_b32 v6, 1, v9
    v_lshlrev_b32 v6, 3, v6
    v_and_b32 v4, 1, v9
    v_add_u32 v6, v6, v4
    v_lshlrev_b32 v251, 7, v6
    v_add_u32 v251, 0x280000, v251
    v_and_b32 v6, 31, v6
    s_lshl_b32 s76, s4, 5
    v_add_u32 v6, s76, v6
    v_and_b32 v7, 7, v9
    s_lshl_b32 s76, s68, 3
    v_add_u32 v7, s76, v7
    v_and_b32 v4, 8, v9
    v_cmp_eq_u32 vcc, 0, v4
    s_nop 1
    v_cndmask_b32 v6, v7, v6, vcc
    v_lshlrev_b32 v110, 7, v6
    v_add_u32 v110, 0x280000, v110
    s_waitcnt vmcnt(0)
    s_barrier
    s_cmp_lg_u32 s3, 0
    s_cbranch_scc1 L_pub_5
    s_lshl_b32 s82, s70, 7
    s_add_u32 s82, s82, 0x280000
    v_mov_b32 v4, 0
    s_mov_b64 exec, 1
    buffer_store_dword v2, v4, s[44:47], s82 offen sc1
    s_mov_b64 exec, -1
L_pub_5:
    buffer_load_dwordx4 v[152:155], v125, s[32:35], 0 offen sc1
    buffer_load_dwordx4 v[156:159], v125, s[32:35], s95 offen sc1
    s_mov_b32 s11, 0
    s_cmp_eq_u32 s6, 0
    s_cbranch_scc0 L_NORELAY
    s_lshl_b32 s76, s3, 13
    v_add_u32 v4, s76, v1
    ds_write_b128 v4, v[224:227] offset:0
    ds_write_b128 v4, v[228:231] offset:1024
    ds_write_b128 v4, v[232:235] offset:2048
    ds_write_b128 v4, v[236:239] offset:3072
    ds_write_b128 v4, v[240:243] offset:4096
    ds_write_b128 v4, v[244:247] offset:5120
    v_and_b32 v5, 63, v0
    v_bfe_u32 v6, v5, 2, 2
    s_cmp_ge_u32 s2, 224
    s_cbranch_scc1 L_RELAY_WO
    v_bfe_u32 v7, v5, 4, 1
    v_lshl_add_u32 v6, v7, 3, v6
    v_lshlrev_b32 v6, 7, v6
    v_and_b32 v8, 3, v5
    v_lshl_add_u32 v6, v8, 3, v6
    v_add_u32 v6, s76, v6
    v_lshrrev_b32 v7, 5, v5
    v_lshl_add_u32 v8, v7, 11, v6
    v_lshl_add_u32 v9, v7, 5, v6
    s_waitcnt lgkmcnt(0)
    ds_read_b64_tr_b16 v[176:177], v8 offset:0
    ds_read_b64_tr_b16 v[178:179], v8 offset:512
    ds_read_b64_tr_b16 v[180:181], v8 offset:32
    ds_read_b64_tr_b16 v[182:183], v8 offset:544
    ds_read_b64_tr_b16 v[184:185], v8 offset:64
    ds_read_b64_tr_b16 v[186:187], v8 offset:576
    ds_read_b64_tr_b16 v[188:189], v8 offset:96
    ds_read_b64_tr_b16 v[190:191], v8 offset:608
    ds_read_b64_tr_b16 v[192:193], v9 offset:4096
    ds_read_b64_tr_b16 v[194:195], v9 offset:4608
    ds_read_b64_tr_b16 v[196:197], v9 offset:4160
    ds_read_b64_tr_b16 v[198:199], v9 offset:4672
    v_and_b32 v5, 31, v5
    v_lshlrev_b32 v5, 4, v5
    v_lshl_add_u32 v5, v7, 10, v5
    s_mul_i32 s77, s75, 2341
    s_lshr_b32 s77, s77, 16
    s_mul_i32 s76, s77, 28
    s_sub_u32 s76, s75, s76
    s_lshl_b32 s76, s76, 17
    s_lshr_b32 s78, s77, 1
    s_lshl_b32 s78, s78, 11
    s_add_u32 s76, s76, s78
    s_and_b32 s78, s77, 1
    s_lshl_b32 s78, s78, 9
    s_add_u32 s76, s76, s78
    s_add_u32 s76, s76, 0x400000
    s_lshr_b32 s78, s75, 3
    s_mul_i32 s79, s78, 9363
    s_lshr_b32 s79, s79, 16
    s_mul_i32 s80, s79, 7
    s_sub_u32 s78, s78, s80
    s_sub_u32 s80, s79, s75
    s_and_b32 s80, s80, 0
    s_and_b32 s80, s79, 3
    s_lshl_b32 s81, s80, 2
    s_add_u32 s81, s81, s78
    s_lshl_b32 s80, s80, 1
    s_add_u32 s80, s80, s78
    s_add_u32 s80, s80, 15
    s_cmp_ge_u32 s78, 5
    s_cselect_b32 s81, s80, s81
    s_and_b32 s80, s79, 3
    s_add_u32 s80, s80, 16
    s_cmp_eq_u32 s78, 4
    s_cselect_b32 s81, s80, s81
    s_and_b32 s77, s75, 7
    s_lshl_b32 s77, s77, 2
    s_lshr_b32 s79, s79, 2
    s_add_u32 s77, s77, s79
    s_mul_i32 s77, s77, 57344
    s_lshr_b32 s80, s81, 1
    s_lshl_b32 s80, s80, 12
    s_add_u32 s77, s77, s80
    s_and_b32 s80, s81, 1
    s_lshl_b32 s80, s80, 9
    s_add_u32 s77, s77, s80
    s_add_u32 s77, s77, 0x200000
    s_cmp_lg_u32 s3, 0
    s_cbranch_scc1 L_probe_6
    buffer_load_dword v111, v110, s[44:47], 0 offen sc1
L_probe_6:
    v_mov_b32 v200, v5
    s_mov_b32 s10, s76
    s_mov_b32 s11, 1
    s_mov_b32 s12, s77
    s_branch L_RELAY_PUB
L_RELAY_WO:
    v_lshrrev_b32 v7, 4, v5
    v_lshl_add_u32 v6, v7, 3, v6
    v_lshlrev_b32 v6, 7, v6
    v_and_b32 v8, 3, v5
    v_lshl_add_u32 v6, v8, 4, v6
    v_add_u32 v6, s76, v6
    s_waitcnt lgkmcnt(0)
    ds_read_b64_tr_b16 v[176:177], v6 offset:0
    ds_read_b64_tr_b16 v[178:179], v6 offset:512
    ds_read_b64_tr_b16 v[180:181], v6 offset:8
    ds_read_b64_tr_b16 v[182:183], v6 offset:520
    ds_read_b64_tr_b16 v[184:185], v6 offset:64
    ds_read_b64_tr_b16 v[186:187], v6 offset:576
    ds_read_b64_tr_b16 v[188:189], v6 offset:72
    ds_read_b64_tr_b16 v[190:191], v6 offset:584
    s_sub_u32 s78, s75, 896
    s_lshr_b32 s76, s78, 3
    s_lshl_b32 s76, s76, 13
    s_bfe_u32 s77, s78, 0x20001
    s_lshl_b32 s77, s77, 17
    s_add_u32 s76, s76, s77
    s_and_b32 s77, s78, 1
    s_lshl_b32 s77, s77, 12
    s_add_u32 s76, s76, s77
    s_add_u32 s76, s76, 0x100000
    s_cmp_lg_u32 s3, 0
    s_cbranch_scc1 L_probe_7
    buffer_load_dword v111, v110, s[44:47], 0 offen sc1
L_probe_7:
    s_mov_b32 s11, 2
    v_mov_b32 v200, v1
    s_waitcnt lgkmcnt(0)
    buffer_store_dwordx4 v[176:179], v1, s[48:51], s76 offen offset:0 sc1
    buffer_store_dwordx4 v[180:183], v1, s[48:51], s76 offen offset:1024 sc1
    buffer_store_dwordx4 v[184:187], v1, s[48:51], s76 offen offset:2048 sc1
    buffer_store_dwordx4 v[188:191], v1, s[48:51], s76 offen offset:3072 sc1
L_RELAY_PUB:
    s_lshr_b32 s8, s5, 3
    s_lshl_b32 s8, s8, 2
    s_add_u32 s8, s8, s3
    s_mul_i32 s8, s8, 8192
    s_mul_i32 s77, s72, 229376
    s_add_u32 s8, s8, s77
    s_add_u32 s8, s8, 0x418000
    s_lshr_b32 s9, s5, 3
    s_lshl_b32 s9, s9, 2
    s_add_u32 s9, s9, s3
    s_mul_i32 s9, s9, 14336
    s_mul_i32 s77, s69, 229376
    s_add_u32 s9, s9, s77
    s_add_u32 s9, s9, 0x200000
    s_mul_i32 s16, s72, 229376
    s_lshl_b32 s77, s3, 13
    s_add_u32 s16, s16, s77
    s_add_u32 s16, s16, 0x400000
    s_add_u32 s16, s16, s30
    s_addc_u32 s13, s31, 0
    s_lshl_b32 s17, s3, 17
    s_add_u32 s17, s17, 0x101000
    s_lshl_b32 s20, s69, 2
    s_add_u32 s20, s20, s3
    s_mul_i32 s20, s20, 57344
    s_add_u32 s20, s20, 0x200000
L_NORELAY:
    v_mov_b32 v48, 0
    v_mov_b32 v49, 0
    v_mov_b32 v50, 0
    v_mov_b32 v51, 0
    v_mov_b32 v52, 0
    v_mov_b32 v53, 0
    v_mov_b32 v54, 0
    v_mov_b32 v55, 0
    v_mov_b32 v56, 0
    v_mov_b32 v57, 0
    v_mov_b32 v58, 0
    v_mov_b32 v59, 0
    v_mov_b32 v60, 0
    v_mov_b32 v61, 0
    v_mov_b32 v62, 0
    v_mov_b32 v63, 0
    v_mov_b32 v160, 0
    v_mov_b32 v161, 0
    v_mov_b32 v162, 0
    v_mov_b32 v163, 0
    v_mov_b32 v164, 0
    v_mov_b32 v165, 0
    v_mov_b32 v166, 0
    v_mov_b32 v167, 0
    v_mov_b32 v168, 0
    v_mov_b32 v169, 0
    v_mov_b32 v170, 0
    v_mov_b32 v171, 0
    v_mov_b32 v172, 0
    v_mov_b32 v173, 0
    v_mov_b32 v174, 0
    v_mov_b32 v175, 0
    v_mov_b32 v208, 0
    v_mov_b32 v209, 0
    v_mov_b32 v210, 0
    v_mov_b32 v211, 0
    v_mov_b32 v212, 0
    v_mov_b32 v213, 0
    v_mov_b32 v214, 0
    v_mov_b32 v215, 0
    v_mov_b32 v216, 0
    v_mov_b32 v217, 0
    v_mov_b32 v218, 0
    v_mov_b32 v219, 0
    v_mov_b32 v220, 0
    v_mov_b32 v221, 0
    v_mov_b32 v222, 0
    v_mov_b32 v223, 0
    v_mov_b32 v224, 0
    v_mov_b32 v225, 0
    v_mov_b32 v226, 0
    v_mov_b32 v227, 0
    v_mov_b32 v228, 0
    v_mov_b32 v229, 0
    v_mov_b32 v230, 0
    v_mov_b32 v231, 0
    v_mov_b32 v232, 0
    v_mov_b32 v233, 0
    v_mov_b32 v234, 0
    v_mov_b32 v235, 0
    v_mov_b32 v236, 0
    v_mov_b32 v237, 0
    v_mov_b32 v238, 0
    v_mov_b32 v239, 0
    s_lshl_b32 s78, s70, 13
    s_lshl_b32 s77, s3, 10
    s_add_u32 s78, s78, s77
    s_xor_b32 s77, s78, 1024
    s_lshl_b32 s76, s4, 13
    s_and_b32 s80, s3, 1
    s_lshl_b32 s80, s80, 12
    s_add_u32 s76, s76, s80
    s_lshr_b32 s80, s3, 1
    s_lshl_b32 s80, s80, 16
    s_add_u32 s80, s80, 0x200000
    s_add_u32 s56, s76, 0
    s_and_b32 s56, s56, 0xffff
    s_add_u32 s56, s56, s80
    s_add_u32 s57, s76, 8192
    s_and_b32 s57, s57, 0xffff
    s_add_u32 s57, s57, s80
    s_add_u32 s58, s76, 16384
    s_and_b32 s58, s58, 0xffff
    s_add_u32 s58, s58, s80
    s_add_u32 s59, s76, 24576
    s_and_b32 s59, s59, 0xffff
    s_add_u32 s59, s59, s80
    s_add_u32 s60, s76, 32768
    s_and_b32 s60, s60, 0xffff
    s_add_u32 s60, s60, s80
    s_add_u32 s61, s76, 40960
    s_and_b32 s61, s61, 0xffff
    s_add_u32 s61, s61, s80
    s_add_u32 s62, s76, 49152
    s_and_b32 s62, s62, 0xffff
    s_add_u32 s62, s62, s80
    s_add_u32 s63, s76, 57344
    s_and_b32 s63, s63, 0xffff
    s_add_u32 s63, s63, s80
    s_add_u32 s64, s44, s56
    s_addc_u32 s65, s45, 0
    s_add_u32 s66, s44, s57
    s_addc_u32 s67, s45, 0
    s_cmp_lg_u32 s3, 0
    s_cbranch_scc1 L_s1_8
    s_cmp_eq_u32 s6, 0
    s_cbranch_scc0 L_s1e_9
    s_waitcnt vmcnt(4)
    s_cmp_eq_u32 s11, 2
    s_cbranch_scc1 L_s1w_11
    s_waitcnt vmcnt(0)
L_s1w_11:
    v_cmp_ne_u32 vcc, v111, v2
    s_cbranch_vccz L_s1s_10
L_s1e_9:
    s_mov_b32 s82, 200000
L_poll_s1a_12:
    buffer_load_dword v4, v110, s[44:47], 0 offen sc1
    s_waitcnt vmcnt(0)
    v_cmp_ne_u32 vcc, v4, v2
    s_cbranch_vccz L_polld_s1a_13
    s_sub_u32 s82, s82, 1
    s_cmp_lg_u32 s82, 0
    s_cbranch_scc1 L_poll_s1a_12
    s_branch L_TIMEOUT
L_polld_s1a_13:
L_s1s_10:
    buffer_load_dword v111, v251, s[44:47], 0 offen sc1
L_s1_8:
    s_waitcnt lgkmcnt(0)
    s_barrier
    buffer_load_dwordx4 v[68:71], v1, s[44:47], s77 offen sc1
    buffer_load_dwordx4 v[64:67], v1, s[44:47], s78 offen sc1
    s_add_u32 m0, s83, 0
    s_nop 0
    global_load_lds_dwordx4 v1, s[64:65] offset:0 sc1
    global_load_lds_dwordx4 v1, s[64:65] offset:1024 sc1
    global_load_lds_dwordx4 v1, s[64:65] offset:2048 sc1
    global_load_lds_dwordx4 v1, s[64:65] offset:3072 sc1
    s_add_u32 s78, s78, 4096
    s_add_u32 s77, s77, 4096
    s_add_u32 m0, s83, 4096
    s_waitcnt vmcnt(7)
    s_cmp_eq_u32 s3, 0
    s_cbranch_scc1 L_resw_14
    s_waitcnt vmcnt(6)
L_resw_14:
    v_lshlrev_b32 v136, 16, v152
    v_and_b32 v137, 0xffff0000, v152
    v_lshlrev_b32 v138, 16, v153
    v_and_b32 v139, 0xffff0000, v153
    v_lshlrev_b32 v140, 16, v154
    v_and_b32 v141, 0xffff0000, v154
    v_lshlrev_b32 v142, 16, v155
    v_and_b32 v143, 0xffff0000, v155
    v_lshlrev_b32 v144, 16, v156
    v_and_b32 v145, 0xffff0000, v156
    v_lshlrev_b32 v146, 16, v157
    v_and_b32 v147, 0xffff0000, v157
    v_lshlrev_b32 v148, 16, v158
    v_and_b32 v149, 0xffff0000, v158
    v_lshlrev_b32 v150, 16, v159
    v_and_b32 v151, 0xffff0000, v159
    s_cmp_lg_u32 s3, 0
    s_cbranch_scc1 L_s1b_15
    s_waitcnt vmcnt(6)
    v_cmp_ne_u32 vcc, v111, v2
    s_cbranch_vccz L_s1b_15
    s_mov_b32 s82, 200000
L_poll_s1b_16:
    buffer_load_dword v4, v251, s[44:47], 0 offen sc1
    s_waitcnt vmcnt(0)
    v_cmp_ne_u32 vcc, v4, v2
    s_cbranch_vccz L_polld_s1b_17
    s_sub_u32 s82, s82, 1
    s_cmp_lg_u32 s82, 0
    s_cbranch_scc1 L_poll_s1b_16
    s_branch L_TIMEOUT
L_polld_s1b_17:
L_s1b_15:
    s_waitcnt vmcnt(2)
    s_barrier
    ds_read_b128 v[72:75], v127 offset:0
    ds_read_b128 v[80:83], v97 offset:0
    ds_read_b128 v[88:91], v97 offset:512
    ds_read_b128 v[76:79], v127 offset:1024
    s_waitcnt lgkmcnt(3)
    v_mfma_f32_32x32x16_bf16 v[16:31], v[72:75], v[68:71], 0
    global_load_lds_dwordx4 v1, s[66:67] offset:0 sc1
    global_load_lds_dwordx4 v1, s[66:67] offset:1024 sc1
    global_load_lds_dwordx4 v1, s[66:67] offset:2048 sc1
    global_load_lds_dwordx4 v1, s[66:67] offset:3072 sc1
    s_add_u32 m0, s83, 8192
    s_add_u32 s64, s44, s58
    s_addc_u32 s65, s45, 0
    s_nop 4
    v_exp_f32 v16, v16
    v_exp_f32 v17, v17
    v_exp_f32 v18, v18
    s_waitcnt lgkmcnt(1)
    v_exp_f32 v19, v19
    v_exp_f32 v20, v20
    v_exp_f32 v21, v21
    v_mfma_f32_32x32x16_bf16 v[32:47], v[72:75], v[64:67], 0
    ds_read_b128 v[84:87], v97 offset:1024
    ds_read_b128 v[92:95], v97 offset:1536
    global_load_lds_dwordx4 v1, s[64:65] offset:0 sc1
    global_load_lds_dwordx4 v1, s[64:65] offset:1024 sc1
    v_exp_f32 v22, v22
    v_exp_f32 v23, v23
    v_exp_f32 v24, v24
    v_exp_f32 v25, v25
    v_exp_f32 v26, v26
    v_smfmac_f32_32x32x32_bf16 v[160:175], v[80:83], v[16:23], v96
    v_exp_f32 v27, v27
    v_exp_f32 v28, v28
    v_exp_f32 v29, v29
    v_exp_f32 v30, v30
    v_exp_f32 v31, v31
    v_exp_f32 v32, v32
    v_exp_f32 v33, v33
    v_exp_f32 v34, v34
    v_smfmac_f32_32x32x32_bf16 v[160:175], v[88:91], v[24:31], v96
    s_waitcnt lgkmcnt(2)
    v_exp_f32 v35, v35
    v_exp_f32 v36, v36
    v_exp_f32 v37, v37
    v_mfma_f32_32x32x16_bf16 v[16:31], v[76:79], v[68:71], 0
    s_waitcnt vmcnt(6)
    s_barrier
    ds_read_b128 v[72:75], v127 offset:2048
    global_load_lds_dwordx4 v1, s[64:65] offset:2048 sc1
    global_load_lds_dwordx4 v1, s[64:65] offset:3072 sc1
    v_exp_f32 v38, v38
    v_exp_f32 v39, v39
    v_exp_f32 v40, v40
    v_exp_f32 v41, v41
    v_exp_f32 v42, v42
    v_smfmac_f32_32x32x32_bf16 v[48:63], v[80:83], v[32:39], v96
    s_add_u32 s66, s44, s59
    s_addc_u32 s67, s45, 0
    s_lshl_b32 s82, s11, 2
    s_add_u32 s82, s82, s3
    s_cmp_lg_u32 s82, 11
    s_cbranch_scc1 L_wpub_18
    v_mov_b32 v4, 0
    s_mov_b64 exec, 1
    buffer_store_dword v2, v4, s[48:51], s74 offen sc1
    s_mov_b64 exec, -1
L_wpub_18:
    v_exp_f32 v43, v43
    v_exp_f32 v44, v44
    v_exp_f32 v45, v45
    v_exp_f32 v46, v46
    v_exp_f32 v47, v47
    v_exp_f32 v16, v16
    v_exp_f32 v17, v17
    v_exp_f32 v18, v18
    v_smfmac_f32_32x32x32_bf16 v[48:63], v[88:91], v[40:47], v96
    s_waitcnt lgkmcnt(1)
    v_exp_f32 v19, v19
    v_exp_f32 v20, v20
    v_exp_f32 v21, v21
    v_mfma_f32_32x32x16_bf16 v[32:47], v[76:79], v[64:67], 0
    s_add_u32 m0, s83, 12288
    ds_read_b128 v[80:83], v97 offset:2048
    ds_read_b128 v[88:91], v97 offset:2560
    global_load_lds_dwordx4 v1, s[66:67] offset:0 sc1
    global_load_lds_dwordx4 v1, s[66:67] offset:1024 sc1
    v_exp_f32 v22, v22
    v_exp_f32 v23, v23
    v_exp_f32 v24, v24
    v_exp_f32 v25, v25
    v_exp_f32 v26, v26
    v_smfmac_f32_32x32x32_bf16 v[160:175], v[84:87], v[16:23], v96
    v_exp_f32 v27, v27
    v_exp_f32 v28, v28
    v_exp_f32 v29, v29
    v_exp_f32 v30, v30
    v_exp_f32 v31, v31
    v_exp_f32 v32, v32
    v_exp_f32 v33, v33
    v_exp_f32 v34, v34
    v_smfmac_f32_32x32x32_bf16 v[160:175], v[92:95], v[24:31], v96
    s_waitcnt lgkmcnt(2)
    v_exp_f32 v35, v35
    v_exp_f32 v36, v36
    v_exp_f32 v37, v37
    v_mfma_f32_32x32x16_bf16 v[16:31], v[72:75], v[68:71], 0
    ds_read_b128 v[76:79], v127 offset:3072
    global_load_lds_dwordx4 v1, s[66:67] offset:2048 sc1
    global_load_lds_dwordx4 v1, s[66:67] offset:3072 sc1
    v_exp_f32 v38, v38
    v_exp_f32 v39, v39
    v_exp_f32 v40, v40
    v_exp_f32 v41, v41
    v_exp_f32 v42, v42
    v_smfmac_f32_32x32x32_bf16 v[48:63], v[84:87], v[32:39], v96
    s_add_u32 s64, s44, s60
    s_addc_u32 s65, s45, 0
    v_exp_f32 v43, v43
    v_exp_f32 v44, v44
    v_exp_f32 v45, v45
    v_exp_f32 v46, v46
    v_exp_f32 v47, v47
    v_exp_f32 v16, v16
    v_exp_f32 v17, v17
    v_exp_f32 v18, v18
    v_smfmac_f32_32x32x32_bf16 v[48:63], v[92:95], v[40:47], v96
    s_waitcnt lgkmcnt(1)
    v_exp_f32 v19, v19
    v_exp_f32 v20, v20
    v_exp_f32 v21, v21
    v_mfma_f32_32x32x16_bf16 v[32:47], v[72:75], v[64:67], 0
    s_add_u32 m0, s83, 16384
    ds_read_b128 v[84:87], v97 offset:3072
    ds_read_b128 v[92:95], v97 offset:3584
    global_load_lds_dwordx4 v1, s[64:65] offset:0 sc1
    global_load_lds_dwordx4 v1, s[64:65] offset:1024 sc1
    v_exp_f32 v22, v22
    v_exp_f32 v23, v23
    v_exp_f32 v24, v24
    v_exp_f32 v25, v25
    v_exp_f32 v26, v26
    v_smfmac_f32_32x32x32_bf16 v[160:175], v[80:83], v[16:23], v96
    v_exp_f32 v27, v27
    v_exp_f32 v28, v28
    v_exp_f32 v29, v29
    v_exp_f32 v30, v30
    v_exp_f32 v31, v31
    v_exp_f32 v32, v32
    v_exp_f32 v33, v33
    v_exp_f32 v34, v34
    v_smfmac_f32_32x32x32_bf16 v[160:175], v[88:91], v[24:31], v96
    s_waitcnt lgkmcnt(2)
    v_exp_f32 v35, v35
    v_exp_f32 v36, v36
    v_exp_f32 v37, v37
    v_mfma_f32_32x32x16_bf16 v[16:31], v[76:79], v[68:71], 0
    s_waitcnt vmcnt(10)
    s_barrier
    ds_read_b128 v[72:75], v127 offset:4096
    global_load_lds_dwordx4 v1, s[64:65] offset:2048 sc1
    global_load_lds_dwordx4 v1, s[64:65] offset:3072 sc1
    v_exp_f32 v38, v38
    v_exp_f32 v39, v39
    v_exp_f32 v40, v40
    v_exp_f32 v41, v41
    v_exp_f32 v42, v42
    v_smfmac_f32_32x32x32_bf16 v[48:63], v[80:83], v[32:39], v96
    s_add_u32 s66, s44, s61
    s_addc_u32 s67, s45, 0
    v_exp_f32 v43, v43
    v_exp_f32 v44, v44
    v_exp_f32 v45, v45
    v_exp_f32 v46, v46
    v_exp_f32 v47, v47
    v_exp_f32 v16, v16
    v_exp_f32 v17, v17
    v_exp_f32 v18, v18
    v_smfmac_f32_32x32x32_bf16 v[48:63], v[88:91], v[40:47], v96
    s_waitcnt lgkmcnt(1)
    v_exp_f32 v19, v19
    v_exp_f32 v20, v20
    v_exp_f32 v21, v21
    v_mfma_f32_32x32x16_bf16 v[32:47], v[76:79], v[64:67], 0
    s_add_u32 m0, s83, 20480
    ds_read_b128 v[80:83], v97 offset:4096
    ds_read_b128 v[88:91], v97 offset:4608
    global_load_lds_dwordx4 v1, s[66:67] offset:0 sc1
    global_load_lds_dwordx4 v1, s[66:67] offset:1024 sc1
    v_exp_f32 v22, v22
    v_exp_f32 v23, v23
    v_exp_f32 v24, v24
    v_exp_f32 v25, v25
    v_exp_f32 v26, v26
    v_smfmac_f32_32x32x32_bf16 v[160:175], v[84:87], v[16:23], v96
    v_exp_f32 v27, v27
    v_exp_f32 v28, v28
    v_exp_f32 v29, v29
    v_exp_f32 v30, v30
    v_exp_f32 v31, v31
    v_exp_f32 v32, v32
    v_exp_f32 v33, v33
    v_exp_f32 v34, v34
    v_smfmac_f32_32x32x32_bf16 v[160:175], v[92:95], v[24:31], v96
    s_waitcnt lgkmcnt(2)
    v_exp_f32 v35, v35
    v_exp_f32 v36, v36
    v_exp_f32 v37, v37
    v_mfma_f32_32x32x16_bf16 v[16:31], v[72:75], v[68:71], 0
    ds_read_b128 v[76:79], v127 offset:5120
    global_load_lds_dwordx4 v1, s[66:67] offset:2048 sc1
    global_load_lds_dwordx4 v1, s[66:67] offset:3072 sc1
    v_exp_f32 v38, v38
    v_exp_f32 v39, v39
    v_exp_f32 v40, v40
    v_exp_f32 v41, v41
    v_exp_f32 v42, v42
    v_smfmac_f32_32x32x32_bf16 v[48:63], v[84:87], v[32:39], v96
    s_add_u32 s64, s44, s62
    s_addc_u32 s65, s45, 0
    v_exp_f32 v43, v43
    v_exp_f32 v44, v44
    v_exp_f32 v45, v45
    v_exp_f32 v46, v46
    v_exp_f32 v47, v47
    v_exp_f32 v16, v16
    v_exp_f32 v17, v17
    v_exp_f32 v18, v18
    v_smfmac_f32_32x32x32_bf16 v[48:63], v[92:95], v[40:47], v96
    s_waitcnt lgkmcnt(1)
    v_exp_f32 v19, v19
    v_exp_f32 v20, v20
    v_exp_f32 v21, v21
    v_mfma_f32_32x32x16_bf16 v[32:47], v[72:75], v[64:67], 0
    s_add_u32 m0, s83, 24576
    ds_read_b128 v[84:87], v97 offset:5120
    ds_read_b128 v[92:95], v97 offset:5632
    global_load_lds_dwordx4 v1, s[64:65] offset:0 sc1
    global_load_lds_dwordx4 v1, s[64:65] offset:1024 sc1
    v_exp_f32 v22, v22
    v_exp_f32 v23, v23
    v_exp_f32 v24, v24
    v_exp_f32 v25, v25
    v_exp_f32 v26, v26
    v_smfmac_f32_32x32x32_bf16 v[160:175], v[80:83], v[16:23], v96
    v_exp_f32 v27, v27
    v_exp_f32 v28, v28
    v_exp_f32 v29, v29
    v_exp_f32 v30, v30
    v_exp_f32 v31, v31
    v_exp_f32 v32, v32
    v_exp_f32 v33, v33
    v_exp_f32 v34, v34
    v_smfmac_f32_32x32x32_bf16 v[160:175], v[88:91], v[24:31], v96
    s_waitcnt lgkmcnt(2)
    v_exp_f32 v35, v35
    v_exp_f32 v36, v36
    v_exp_f32 v37, v37
    v_mfma_f32_32x32x16_bf16 v[16:31], v[76:79], v[68:71], 0
    ds_read_b128 v[72:75], v127 offset:6144
    global_load_lds_dwordx4 v1, s[64:65] offset:2048 sc1
    global_load_lds_dwordx4 v1, s[64:65] offset:3072 sc1
    v_exp_f32 v38, v38
    v_exp_f32 v39, v39
    v_exp_f32 v40, v40
    v_exp_f32 v41, v41
    v_exp_f32 v42, v42
    v_smfmac_f32_32x32x32_bf16 v[48:63], v[80:83], v[32:39], v96
    s_add_u32 s66, s44, s63
    s_addc_u32 s67, s45, 0
    v_exp_f32 v43, v43
    v_exp_f32 v44, v44
    v_exp_f32 v45, v45
    v_exp_f32 v46, v46
    v_exp_f32 v47, v47
    v_exp_f32 v16, v16
    v_exp_f32 v17, v17
    v_exp_f32 v18, v18
    v_smfmac_f32_32x32x32_bf16 v[48:63], v[88:91], v[40:47], v96
    s_waitcnt lgkmcnt(1)
    v_exp_f32 v19, v19
    v_exp_f32 v20, v20
    v_exp_f32 v21, v21
    v_mfma_f32_32x32x16_bf16 v[32:47], v[76:79], v[64:67], 0
    s_add_u32 m0, s83, 28672
    ds_read_b128 v[80:83], v97 offset:6144
    ds_read_b128 v[88:91], v97 offset:6656
    global_load_lds_dwordx4 v1, s[66:67] offset:0 sc1
    global_load_lds_dwordx4 v1, s[66:67] offset:1024 sc1
    v_exp_f32 v22, v22
    v_exp_f32 v23, v23
    v_exp_f32 v24, v24
    v_exp_f32 v25, v25
    v_exp_f32 v26, v26
    v_smfmac_f32_32x32x32_bf16 v[160:175], v[84:87], v[16:23], v96
    v_exp_f32 v27, v27
    v_exp_f32 v28, v28
    v_exp_f32 v29, v29
    v_exp_f32 v30, v30
    v_exp_f32 v31, v31
    v_exp_f32 v32, v32
    v_exp_f32 v33, v33
    v_exp_f32 v34, v34
    v_smfmac_f32_32x32x32_bf16 v[160:175], v[92:95], v[24:31], v96
    s_waitcnt lgkmcnt(2)
    v_exp_f32 v35, v35
    v_exp_f32 v36, v36
    v_exp_f32 v37, v37
    v_mfma_f32_32x32x16_bf16 v[16:31], v[72:75], v[68:71], 0
    ds_read_b128 v[76:79], v127 offset:7168
    global_load_lds_dwordx4 v1, s[66:67] offset:2048 sc1
    global_load_lds_dwordx4 v1, s[66:67] offset:3072 sc1
    v_exp_f32 v38, v38
    v_exp_f32 v39, v39
    v_exp_f32 v40, v40
    v_exp_f32 v41, v41
    v_exp_f32 v42, v42
    v_smfmac_f32_32x32x32_bf16 v[48:63], v[84:87], v[32:39], v96
    v_exp_f32 v43, v43
    v_exp_f32 v44, v44
    v_exp_f32 v45, v45
    v_exp_f32 v46, v46
    v_exp_f32 v47, v47
    v_exp_f32 v16, v16
    v_exp_f32 v17, v17
    v_exp_f32 v18, v18
    v_smfmac_f32_32x32x32_bf16 v[48:63], v[92:95], v[40:47], v96
    s_waitcnt lgkmcnt(1)
    v_exp_f32 v19, v19
    v_exp_f32 v20, v20
    v_exp_f32 v21, v21
    v_mfma_f32_32x32x16_bf16 v[32:47], v[72:75], v[64:67], 0
    ds_read_b128 v[84:87], v97 offset:7168
    ds_read_b128 v[92:95], v97 offset:7680
    buffer_load_dwordx4 v[116:119], v1, s[44:47], s77 offen sc1
    buffer_load_dwordx4 v[112:115], v1, s[44:47], s78 offen sc1
    v_exp_f32 v22, v22
    v_exp_f32 v23, v23
    v_exp_f32 v24, v24
    v_exp_f32 v25, v25
    v_exp_f32 v26, v26
    v_smfmac_f32_32x32x32_bf16 v[160:175], v[80:83], v[16:23], v96
    v_exp_f32 v27, v27
    v_exp_f32 v28, v28
    v_exp_f32 v29, v29
    v_exp_f32 v30, v30
    v_exp_f32 v31, v31
    v_exp_f32 v32, v32
    v_exp_f32 v33, v33
    v_exp_f32 v34, v34
    v_smfmac_f32_32x32x32_bf16 v[160:175], v[88:91], v[24:31], v96
    s_waitcnt lgkmcnt(2)
    v_exp_f32 v35, v35
    v_exp_f32 v36, v36
    v_exp_f32 v37, v37
    v_mfma_f32_32x32x16_bf16 v[16:31], v[76:79], v[68:71], 0
    s_waitcnt vmcnt(18)
    s_barrier
    ds_read_b128 v[72:75], v127 offset:8192
    v_exp_f32 v38, v38
    v_exp_f32 v39, v39
    v_exp_f32 v40, v40
    v_exp_f32 v41, v41
    v_exp_f32 v42, v42
    v_smfmac_f32_32x32x32_bf16 v[48:63], v[80:83], v[32:39], v96
    v_exp_f32 v43, v43
    v_exp_f32 v44, v44
    v_add_u32 v97, v97, v98
    v_exp_f32 v45, v45
    v_exp_f32 v46, v46
    v_exp_f32 v47, v47
    v_exp_f32 v16, v16
    v_exp_f32 v17, v17
    v_exp_f32 v18, v18
    v_smfmac_f32_32x32x32_bf16 v[48:63], v[88:91], v[40:47], v96
    s_waitcnt lgkmcnt(1)
    v_exp_f32 v19, v19
    v_exp_f32 v20, v20
    v_exp_f32 v21, v21
    v_mfma_f32_32x32x16_bf16 v[32:47], v[76:79], v[64:67], 0
    ds_read_b128 v[80:83], v97 offset:0
    v_exp_f32 v22, v22
    v_exp_f32 v23, v23
    v_exp_f32 v24, v24
    v_exp_f32 v25, v25
    v_exp_f32 v26, v26
    v_smfmac_f32_32x32x32_bf16 v[160:175], v[84:87], v[16:23], v96
    ds_read_b128 v[88:91], v97 offset:512
    v_exp_f32 v27, v27
    v_exp_f32 v28, v28
    v_exp_f32 v29, v29
    v_exp_f32 v30, v30
    v_exp_f32 v31, v31
    v_exp_f32 v32, v32
    v_exp_f32 v33, v33
    v_exp_f32 v34, v34
    v_smfmac_f32_32x32x32_bf16 v[160:175], v[92:95], v[24:31], v96
    s_waitcnt lgkmcnt(2)
    v_exp_f32 v35, v35
    v_exp_f32 v36, v36
    v_exp_f32 v37, v37
    v_mfma_f32_32x32x16_bf16 v[16:31], v[72:75], v[68:71], 0
    ds_read_b128 v[76:79], v127 offset:9216
    v_exp_f32 v38, v38
    v_exp_f32 v39, v39
    v_exp_f32 v40, v40
    v_exp_f32 v41, v41
    v_exp_f32 v42, v42
    v_smfmac_f32_32x32x32_bf16 v[48:63], v[84:87], v[32:39], v96
    v_exp_f32 v43, v43
    v_exp_f32 v44, v44
    v_exp_f32 v45, v45
    v_exp_f32 v46, v46
    v_exp_f32 v47, v47
    v_exp_f32 v16, v16
    v_exp_f32 v17, v17
    v_exp_f32 v18, v18
    v_smfmac_f32_32x32x32_bf16 v[48:63], v[92:95], v[40:47], v96
    s_waitcnt lgkmcnt(1)
    v_exp_f32 v19, v19
    v_exp_f32 v20, v20
    v_exp_f32 v21, v21
    v_mfma_f32_32x32x16_bf16 v[32:47], v[72:75], v[64:67], 0
    ds_read_b128 v[84:87], v97 offset:1024
    v_exp_f32 v22, v22
    v_exp_f32 v23, v23
    v_exp_f32 v24, v24
    v_exp_f32 v25, v25
    v_exp_f32 v26, v26
    v_smfmac_f32_32x32x32_bf16 v[160:175], v[80:83], v[16:23], v96
    ds_read_b128 v[92:95], v97 offset:1536
    v_exp_f32 v27, v27
    v_exp_f32 v28, v28
    v_exp_f32 v29, v29
    v_exp_f32 v30, v30
    v_exp_f32 v31, v31
    v_exp_f32 v32, v32
    v_exp_f32 v33, v33
    v_exp_f32 v34, v34
    v_smfmac_f32_32x32x32_bf16 v[160:175], v[88:91], v[24:31], v96
    s_waitcnt lgkmcnt(2)
    v_exp_f32 v35, v35
    v_exp_f32 v36, v36
    v_exp_f32 v37, v37
    v_mfma_f32_32x32x16_bf16 v[16:31], v[76:79], v[68:71], 0
    ds_read_b128 v[72:75], v127 offset:10240
    buffer_load_dword v124, v123, s[48:51], 0 offen sc1
    v_exp_f32 v38, v38
    v_exp_f32 v39, v39
    v_exp_f32 v40, v40
    v_exp_f32 v41, v41
    v_exp_f32 v42, v42
    v_smfmac_f32_32x32x32_bf16 v[48:63], v[80:83], v[32:39], v96
    v_exp_f32 v43, v43
    v_exp_f32 v44, v44
    v_exp_f32 v45, v45
    v_exp_f32 v46, v46
    v_exp_f32 v47, v47
    v_exp_f32 v16, v16
    v_exp_f32 v17, v17
    v_exp_f32 v18, v18
    v_smfmac_f32_32x32x32_bf16 v[48:63], v[88:91], v[40:47], v96
    s_waitcnt lgkmcnt(1)
    v_exp_f32 v19, v19
    v_exp_f32 v20, v20
    v_exp_f32 v21, v21
    v_mfma_f32_32x32x16_bf16 v[32:47], v[76:79], v[64:67], 0
    ds_read_b128 v[80:83], v97 offset:2048
    ds_read_b128 v[88:91], v97 offset:2560
    s_cmp_eq_u32 s11, 1
    s_cbranch_scc0 L_rls_19
    buffer_store_dwordx4 v[176:179], v200, s[48:51], s10 offen sc1
    s_add_u32 s10, s10, 32768
    buffer_store_dwordx4 v[180:183], v200, s[48:51], s10 offen sc1
    s_add_u32 s10, s10, 32768
    buffer_store_dwordx4 v[184:187], v200, s[48:51], s10 offen sc1
    s_add_u32 s10, s10, 32768
L_rls_19:
    v_exp_f32 v22, v22
    v_exp_f32 v23, v23
    v_exp_f32 v24, v24
    v_exp_f32 v25, v25
    v_exp_f32 v26, v26
    v_smfmac_f32_32x32x32_bf16 v[160:175], v[84:87], v[16:23], v96
    v_exp_f32 v27, v27
    v_exp_f32 v28, v28
    v_exp_f32 v29, v29
    v_exp_f32 v30, v30
    v_exp_f32 v31, v31
    v_exp_f32 v32, v32
    v_exp_f32 v33, v33
    v_exp_f32 v34, v34
    v_smfmac_f32_32x32x32_bf16 v[160:175], v[92:95], v[24:31], v96
    s_waitcnt lgkmcnt(2)
    v_exp_f32 v35, v35
    v_exp_f32 v36, v36
    v_exp_f32 v37, v37
    v_mfma_f32_32x32x16_bf16 v[16:31], v[72:75], v[68:71], 0
    ds_read_b128 v[76:79], v127 offset:11264
    s_cmp_eq_u32 s11, 1
    s_cbranch_scc0 L_rls_20
    buffer_store_dwordx4 v[188:191], v200, s[48:51], s10 offen sc1
    s_add_u32 s10, s10, 32768
    buffer_store_dwordx4 v[192:195], v200, s[48:51], s12 offen offset:0 sc1
    buffer_store_dwordx4 v[196:199], v200, s[48:51], s12 offen offset:2048 sc1
L_rls_20:
    v_exp_f32 v38, v38
    v_exp_f32 v39, v39
    v_exp_f32 v40, v40
    v_exp_f32 v41, v41
    v_exp_f32 v42, v42
    v_smfmac_f32_32x32x32_bf16 v[48:63], v[84:87], v[32:39], v96
    v_exp_f32 v43, v43
    v_exp_f32 v44, v44
    v_exp_f32 v45, v45
    v_exp_f32 v46, v46
    v_exp_f32 v47, v47
    v_exp_f32 v16, v16
    v_exp_f32 v17, v17
    v_exp_f32 v18, v18
    v_smfmac_f32_32x32x32_bf16 v[48:63], v[92:95], v[40:47], v96
    s_waitcnt lgkmcnt(1)
    v_exp_f32 v19, v19
    v_exp_f32 v20, v20
    v_exp_f32 v21, v21
    v_mfma_f32_32x32x16_bf16 v[32:47], v[72:75], v[64:67], 0
    ds_read_b128 v[84:87], v97 offset:3072
    v_exp_f32 v22, v22
    v_exp_f32 v23, v23
    v_exp_f32 v24, v24
    v_exp_f32 v25, v25
    v_exp_f32 v26, v26
    v_smfmac_f32_32x32x32_bf16 v[160:175], v[80:83], v[16:23], v96
    ds_read_b128 v[92:95], v97 offset:3584
    v_exp_f32 v27, v27
    v_exp_f32 v28, v28
    v_exp_f32 v29, v29
    v_exp_f32 v30, v30
    v_exp_f32 v31, v31
    v_exp_f32 v32, v32
    v_exp_f32 v33, v33
    v_exp_f32 v34, v34
    v_smfmac_f32_32x32x32_bf16 v[160:175], v[88:91], v[24:31], v96
    s_waitcnt lgkmcnt(2)
    v_exp_f32 v35, v35
    v_exp_f32 v36, v36
    v_exp_f32 v37, v37
    v_mfma_f32_32x32x16_bf16 v[16:31], v[76:79], v[68:71], 0
    ds_read_b128 v[72:75], v127 offset:12288
    v_exp_f32 v38, v38
    v_exp_f32 v39, v39
    v_exp_f32 v40, v40
    v_exp_f32 v41, v41
    v_exp_f32 v42, v42
    v_smfmac_f32_32x32x32_bf16 v[48:63], v[80:83], v[32:39], v96
    v_exp_f32 v43, v43
    v_exp_f32 v44, v44
    v_exp_f32 v45, v45
    v_exp_f32 v46, v46
    v_exp_f32 v47, v47
    v_exp_f32 v16, v16
    v_exp_f32 v17, v17
    v_exp_f32 v18, v18
    v_smfmac_f32_32x32x32_bf16 v[48:63], v[88:91], v[40:47], v96
    s_waitcnt lgkmcnt(1)
    v_exp_f32 v19, v19
    v_exp_f32 v20, v20
    v_exp_f32 v21, v21
    v_mfma_f32_32x32x16_bf16 v[32:47], v[76:79], v[64:67], 0
    ds_read_b128 v[80:83], v97 offset:4096
    v_exp_f32 v22, v22
    v_exp_f32 v23, v23
    v_exp_f32 v24, v24
    v_exp_f32 v25, v25
    v_exp_f32 v26, v26
    v_smfmac_f32_32x32x32_bf16 v[160:175], v[84:87], v[16:23], v96
    ds_read_b128 v[88:91], v97 offset:4608
    v_exp_f32 v27, v27
    v_exp_f32 v28, v28
    v_exp_f32 v29, v29
    v_exp_f32 v30, v30
    v_exp_f32 v31, v31
    v_exp_f32 v32, v32
    v_exp_f32 v33, v33
    v_exp_f32 v34, v34
    v_smfmac_f32_32x32x32_bf16 v[160:175], v[92:95], v[24:31], v96
    s_waitcnt lgkmcnt(2)
    v_exp_f32 v35, v35
    v_exp_f32 v36, v36
    v_exp_f32 v37, v37
    v_mfma_f32_32x32x16_bf16 v[16:31], v[72:75], v[68:71], 0
    ds_read_b128 v[76:79], v127 offset:13312
    v_exp_f32 v38, v38
    v_exp_f32 v39, v39
    v_exp_f32 v40, v40
    v_exp_f32 v41, v41
    v_exp_f32 v42, v42
    v_smfmac_f32_32x32x32_bf16 v[48:63], v[84:87], v[32:39], v96
    v_exp_f32 v43, v43
    v_exp_f32 v44, v44
    v_exp_f32 v45, v45
    v_exp_f32 v46, v46
    v_exp_f32 v47, v47
    v_exp_f32 v16, v16
    v_exp_f32 v17, v17
    v_exp_f32 v18, v18
    v_smfmac_f32_32x32x32_bf16 v[48:63], v[92:95], v[40:47], v96
    s_waitcnt lgkmcnt(1)
    v_exp_f32 v19, v19
    v_exp_f32 v20, v20
    v_exp_f32 v21, v21
    v_mfma_f32_32x32x16_bf16 v[32:47], v[72:75], v[64:67], 0
    ds_read_b128 v[84:87], v97 offset:5120
    v_exp_f32 v22, v22
    v_exp_f32 v23, v23
    v_exp_f32 v24, v24
    v_exp_f32 v25, v25
    v_exp_f32 v26, v26
    v_smfmac_f32_32x32x32_bf16 v[160:175], v[80:83], v[16:23], v96
    ds_read_b128 v[92:95], v97 offset:5632
    v_exp_f32 v27, v27
    v_exp_f32 v28, v28
    v_exp_f32 v29, v29
    v_exp_f32 v30, v30
    v_exp_f32 v31, v31
    v_exp_f32 v32, v32
    v_exp_f32 v33, v33
    v_exp_f32 v34, v34
    v_smfmac_f32_32x32x32_bf16 v[160:175], v[88:91], v[24:31], v96
    s_waitcnt lgkmcnt(2)
    v_exp_f32 v35, v35
    v_exp_f32 v36, v36
    v_exp_f32 v37, v37
    v_mfma_f32_32x32x16_bf16 v[16:31], v[76:79], v[68:71], 0
    ds_read_b128 v[72:75], v127 offset:14336
    v_exp_f32 v38, v38
    v_exp_f32 v39, v39
    v_exp_f32 v40, v40
    v_exp_f32 v41, v41
    v_exp_f32 v42, v42
    v_smfmac_f32_32x32x32_bf16 v[48:63], v[80:83], v[32:39], v96
    v_exp_f32 v43, v43
    v_exp_f32 v44, v44
    v_exp_f32 v45, v45
    v_exp_f32 v46, v46
    v_exp_f32 v47, v47
    v_exp_f32 v16, v16
    v_exp_f32 v17, v17
    v_exp_f32 v18, v18
    v_smfmac_f32_32x32x32_bf16 v[48:63], v[88:91], v[40:47], v96
    s_waitcnt lgkmcnt(1)
    v_exp_f32 v19, v19
    v_exp_f32 v20, v20
    v_exp_f32 v21, v21
    v_mfma_f32_32x32x16_bf16 v[32:47], v[76:79], v[64:67], 0
    ds_read_b128 v[80:83], v97 offset:6144
    v_exp_f32 v22, v22
    v_exp_f32 v23, v23
    v_exp_f32 v24, v24
    v_exp_f32 v25, v25
    v_exp_f32 v26, v26
    v_smfmac_f32_32x32x32_bf16 v[160:175], v[84:87], v[16:23], v96
    ds_read_b128 v[88:91], v97 offset:6656
    v_exp_f32 v27, v27
    v_exp_f32 v28, v28
    v_exp_f32 v29, v29
    v_exp_f32 v30, v30
    v_exp_f32 v31, v31
    v_exp_f32 v32, v32
    v_exp_f32 v33, v33
    v_exp_f32 v34, v34
    v_smfmac_f32_32x32x32_bf16 v[160:175], v[92:95], v[24:31], v96
    s_waitcnt lgkmcnt(2)
    v_exp_f32 v35, v35
    v_exp_f32 v36, v36
    v_exp_f32 v37, v37
    v_mfma_f32_32x32x16_bf16 v[16:31], v[72:75], v[68:71], 0
    ds_read_b128 v[76:79], v127 offset:15360
    v_exp_f32 v38, v38
    v_exp_f32 v39, v39
    v_exp_f32 v40, v40
    v_exp_f32 v41, v41
    v_exp_f32 v42, v42
    v_smfmac_f32_32x32x32_bf16 v[48:63], v[84:87], v[32:39], v96
    v_exp_f32 v43, v43
    v_exp_f32 v44, v44
    v_exp_f32 v45, v45
    v_exp_f32 v46, v46
    v_exp_f32 v47, v47
    v_exp_f32 v16, v16
    v_exp_f32 v17, v17
    v_exp_f32 v18, v18
    v_smfmac_f32_32x32x32_bf16 v[48:63], v[92:95], v[40:47], v96
    s_waitcnt lgkmcnt(1)
    v_exp_f32 v19, v19
    v_exp_f32 v20, v20
    v_exp_f32 v21, v21
    v_mfma_f32_32x32x16_bf16 v[32:47], v[72:75], v[64:67], 0
    ds_read_b128 v[84:87], v97 offset:7168
    v_exp_f32 v22, v22
    v_exp_f32 v23, v23
    v_exp_f32 v24, v24
    v_exp_f32 v25, v25
    v_exp_f32 v26, v26
    v_smfmac_f32_32x32x32_bf16 v[160:175], v[80:83], v[16:23], v96
    ds_read_b128 v[92:95], v97 offset:7680
    v_exp_f32 v27, v27
    v_exp_f32 v28, v28
    v_exp_f32 v29, v29
    v_exp_f32 v30, v30
    v_exp_f32 v31, v31
    v_exp_f32 v32, v32
    v_exp_f32 v33, v33
    v_exp_f32 v34, v34
    v_smfmac_f32_32x32x32_bf16 v[160:175], v[88:91], v[24:31], v96
    s_waitcnt lgkmcnt(2)
    v_exp_f32 v35, v35
    v_exp_f32 v36, v36
    v_exp_f32 v37, v37
    v_mfma_f32_32x32x16_bf16 v[16:31], v[76:79], v[68:71], 0
    s_waitcnt vmcnt(0)
    v_cmp_ne_u32 vcc, v124, v2
    s_cbranch_vccz L_ok_ofl_21
    s_mov_b32 s82, 200000
L_poll_ofl_22:
    buffer_load_dword v124, v123, s[48:51], 0 offen sc1
    s_waitcnt vmcnt(0)
    v_cmp_ne_u32 vcc, v124, v2
    s_cbranch_vccz L_polld_ofl_23
    s_sub_u32 s82, s82, 1
    s_cmp_lg_u32 s82, 0
    s_cbranch_scc1 L_poll_ofl_22
    s_branch L_TIMEOUT
L_polld_ofl_23:
L_ok_ofl_21:
    s_waitcnt vmcnt(0)
    s_barrier
    s_lshl_b32 s82, s11, 2
    s_add_u32 s82, s82, s3
    s_cmp_lg_u32 s82, 7
    s_cbranch_scc1 L_wpub_24
    v_mov_b32 v4, 0
    s_mov_b64 exec, 1
    buffer_store_dword v2, v4, s[48:51], s74 offen sc1
    s_mov_b64 exec, -1
L_wpub_24:
    ds_read_b128 v[72:75], v127 offset:16384
    v_exp_f32 v38, v38
    v_exp_f32 v39, v39
    v_exp_f32 v40, v40
    v_exp_f32 v41, v41
    v_exp_f32 v42, v42
    v_smfmac_f32_32x32x32_bf16 v[48:63], v[80:83], v[32:39], v96
    s_add_u32 s64, s30, s17
    s_addc_u32 s65, s31, 0
    v_exp_f32 v43, v43
    v_exp_f32 v44, v44
    v_add_u32 v97, v97, v98
    v_exp_f32 v45, v45
    v_exp_f32 v46, v46
    v_exp_f32 v47, v47
    v_exp_f32 v16, v16
    v_exp_f32 v17, v17
    v_exp_f32 v18, v18
    v_smfmac_f32_32x32x32_bf16 v[48:63], v[88:91], v[40:47], v96
    s_waitcnt lgkmcnt(1)
    v_exp_f32 v19, v19
    v_exp_f32 v20, v20
    v_exp_f32 v21, v21
    v_mfma_f32_32x32x16_bf16 v[32:47], v[76:79], v[64:67], 0
    ds_read_b128 v[80:83], v97 offset:0
    ds_read_b128 v[88:91], v97 offset:512
    global_load_dwordx4 a[0:3], v1, s[64:65] offset:-4096 sc1
    global_load_dwordx4 a[4:7], v1, s[64:65] offset:-3072 sc1
    v_exp_f32 v22, v22
    v_exp_f32 v23, v23
    v_exp_f32 v24, v24
    v_exp_f32 v25, v25
    v_exp_f32 v26, v26
    v_smfmac_f32_32x32x32_bf16 v[160:175], v[84:87], v[16:23], v96
    v_exp_f32 v27, v27
    v_exp_f32 v28, v28
    v_exp_f32 v29, v29
    v_exp_f32 v30, v30
    v_exp_f32 v31, v31
    v_exp_f32 v32, v32
    v_exp_f32 v33, v33
    v_exp_f32 v34, v34
    v_smfmac_f32_32x32x32_bf16 v[160:175], v[92:95], v[24:31], v96
    s_waitcnt lgkmcnt(2)
    v_exp_f32 v35, v35
    v_exp_f32 v36, v36
    v_exp_f32 v37, v37
    v_mfma_f32_32x32x16_bf16 v[16:31], v[72:75], v[68:71], 0
    ds_read_b128 v[76:79], v127 offset:17408
    global_load_dwordx4 a[8:11], v1, s[64:65] offset:-2048 sc1
    global_load_dwordx4 a[12:15], v1, s[64:65] offset:-1024 sc1
    v_exp_f32 v38, v38
    v_exp_f32 v39, v39
    v_exp_f32 v40, v40
    v_exp_f32 v41, v41
    v_exp_f32 v42, v42
    v_smfmac_f32_32x32x32_bf16 v[48:63], v[84:87], v[32:39], v96
    v_exp_f32 v43, v43
    v_exp_f32 v44, v44
    v_exp_f32 v45, v45
    v_exp_f32 v46, v46
    v_exp_f32 v47, v47
    v_exp_f32 v16, v16
    v_exp_f32 v17, v17
    v_exp_f32 v18, v18
    v_smfmac_f32_32x32x32_bf16 v[48:63], v[92:95], v[40:47], v96
    s_waitcnt lgkmcnt(1)
    v_exp_f32 v19, v19
    v_exp_f32 v20, v20
    v_exp_f32 v21, v21
    v_mfma_f32_32x32x16_bf16 v[32:47], v[72:75], v[64:67], 0
    ds_read_b128 v[84:87], v97 offset:1024
    ds_read_b128 v[92:95], v97 offset:1536
    global_load_dwordx4 a[16:19], v1, s[64:65] offset:0 sc1
    global_load_dwordx4 a[20:23], v1, s[64:65] offset:1024 sc1
    v_exp_f32 v22, v22
    v_exp_f32 v23, v23
    v_exp_f32 v24, v24
    v_exp_f32 v25, v25
    v_exp_f32 v26, v26
    v_smfmac_f32_32x32x32_bf16 v[160:175], v[80:83], v[16:23], v96
    v_exp_f32 v27, v27
    v_exp_f32 v28, v28
    v_exp_f32 v29, v29
    v_exp_f32 v30, v30
    v_exp_f32 v31, v31
    v_exp_f32 v32, v32
    v_exp_f32 v33, v33
    v_exp_f32 v34, v34
    v_smfmac_f32_32x32x32_bf16 v[160:175], v[88:91], v[24:31], v96
    s_waitcnt lgkmcnt(2)
    v_exp_f32 v35, v35
    v_exp_f32 v36, v36
    v_exp_f32 v37, v37
    v_mfma_f32_32x32x16_bf16 v[16:31], v[76:79], v[68:71], 0
    ds_read_b128 v[72:75], v127 offset:18432
    global_load_dwordx4 a[24:27], v1, s[64:65] offset:2048 sc1
    global_load_dwordx4 a[28:31], v1, s[64:65] offset:3072 sc1
    v_exp_f32 v38, v38
    v_exp_f32 v39, v39
    v_exp_f32 v40, v40
    v_exp_f32 v41, v41
    v_exp_f32 v42, v42
    v_smfmac_f32_32x32x32_bf16 v[48:63], v[80:83], v[32:39], v96
    s_add_u32 s64, s64, 8192
    s_addc_u32 s65, s65, 0
    v_exp_f32 v43, v43
    v_exp_f32 v44, v44
    v_exp_f32 v45, v45
    v_exp_f32 v46, v46
    v_exp_f32 v47, v47
    v_exp_f32 v16, v16
    v_exp_f32 v17, v17
    v_exp_f32 v18, v18
    v_smfmac_f32_32x32x32_bf16 v[48:63], v[88:91], v[40:47], v96
    s_waitcnt lgkmcnt(1)
    v_exp_f32 v19, v19
    v_exp_f32 v20, v20
    v_exp_f32 v21, v21
    v_mfma_f32_32x32x16_bf16 v[32:47], v[76:79], v[64:67], 0
    ds_read_b128 v[80:83], v97 offset:2048
    ds_read_b128 v[88:91], v97 offset:2560
    global_load_dwordx4 a[32:35], v1, s[64:65] offset:-4096 sc1
    global_load_dwordx4 a[36:39], v1, s[64:65] offset:-3072 sc1
    v_exp_f32 v22, v22
    v_exp_f32 v23, v23
    v_exp_f32 v24, v24
    v_exp_f32 v25, v25
    v_exp_f32 v26, v26
    v_smfmac_f32_32x32x32_bf16 v[160:175], v[84:87], v[16:23], v96
    v_exp_f32 v27, v27
    v_exp_f32 v28, v28
    v_exp_f32 v29, v29
    v_exp_f32 v30, v30
    v_exp_f32 v31, v31
    v_exp_f32 v32, v32
    v_exp_f32 v33, v33
    v_exp_f32 v34, v34
    v_smfmac_f32_32x32x32_bf16 v[160:175], v[92:95], v[24:31], v96
    s_waitcnt lgkmcnt(2)
    v_exp_f32 v35, v35
    v_exp_f32 v36, v36
    v_exp_f32 v37, v37
    v_mfma_f32_32x32x16_bf16 v[16:31], v[72:75], v[68:71], 0
    ds_read_b128 v[76:79], v127 offset:19456
    global_load_dwordx4 a[40:43], v1, s[64:65] offset:-2048 sc1
    global_load_dwordx4 a[44:47], v1, s[64:65] offset:-1024 sc1
    v_exp_f32 v38, v38
    v_exp_f32 v39, v39
    v_exp_f32 v40, v40
    v_exp_f32 v41, v41
    v_exp_f32 v42, v42
    v_smfmac_f32_32x32x32_bf16 v[48:63], v[84:87], v[32:39], v96
    v_exp_f32 v43, v43
    v_exp_f32 v44, v44
    v_exp_f32 v45, v45
    v_exp_f32 v46, v46
    v_exp_f32 v47, v47
    v_exp_f32 v16, v16
    v_exp_f32 v17, v17
    v_exp_f32 v18, v18
    v_smfmac_f32_32x32x32_bf16 v[48:63], v[92:95], v[40:47], v96
    s_waitcnt lgkmcnt(1)
    v_exp_f32 v19, v19
    v_exp_f32 v20, v20
    v_exp_f32 v21, v21
    v_mfma_f32_32x32x16_bf16 v[32:47], v[72:75], v[64:67], 0
    ds_read_b128 v[84:87], v97 offset:3072
    ds_read_b128 v[92:95], v97 offset:3584
    global_load_dwordx4 a[48:51], v1, s[64:65] offset:0 sc1
    global_load_dwordx4 a[52:55], v1, s[64:65] offset:1024 sc1
    v_exp_f32 v22, v22
    v_exp_f32 v23, v23
    v_exp_f32 v24, v24
    v_exp_f32 v25, v25
    v_exp_f32 v26, v26
    v_smfmac_f32_32x32x32_bf16 v[160:175], v[80:83], v[16:23], v96
    v_exp_f32 v27, v27
    v_exp_f32 v28, v28
    v_exp_f32 v29, v29
    v_exp_f32 v30, v30
    v_exp_f32 v31, v31
    v_exp_f32 v32, v32
    v_exp_f32 v33, v33
    v_exp_f32 v34, v34
    v_smfmac_f32_32x32x32_bf16 v[160:175], v[88:91], v[24:31], v96
    s_waitcnt lgkmcnt(2)
    v_exp_f32 v35, v35
    v_exp_f32 v36, v36
    v_exp_f32 v37, v37
    v_mfma_f32_32x32x16_bf16 v[16:31], v[76:79], v[68:71], 0
    ds_read_b128 v[72:75], v127 offset:20480
    global_load_dwordx4 a[56:59], v1, s[64:65] offset:2048 sc1
    global_load_dwordx4 a[60:63], v1, s[64:65] offset:3072 sc1
    v_exp_f32 v38, v38
    v_exp_f32 v39, v39
    v_exp_f32 v40, v40
    v_exp_f32 v41, v41
    v_exp_f32 v42, v42
    v_smfmac_f32_32x32x32_bf16 v[48:63], v[80:83], v[32:39], v96
    s_add_u32 s64, s64, 8192
    s_addc_u32 s65, s65, 0
    v_exp_f32 v43, v43
    v_exp_f32 v44, v44
    v_exp_f32 v45, v45
    v_exp_f32 v46, v46
    v_exp_f32 v47, v47
    v_exp_f32 v16, v16
    v_exp_f32 v17, v17
    v_exp_f32 v18, v18
    v_smfmac_f32_32x32x32_bf16 v[48:63], v[88:91], v[40:47], v96
    s_waitcnt lgkmcnt(1)
    v_exp_f32 v19, v19
    v_exp_f32 v20, v20
    v_exp_f32 v21, v21
    v_mfma_f32_32x32x16_bf16 v[32:47], v[76:79], v[64:67], 0
    ds_read_b128 v[80:83], v97 offset:4096
    ds_read_b128 v[88:91], v97 offset:4608
    global_load_dwordx4 a[64:67], v1, s[64:65] offset:-4096 sc1
    global_load_dwordx4 a[68:71], v1, s[64:65] offset:-3072 sc1
    v_exp_f32 v22, v22
    v_exp_f32 v23, v23
    v_exp_f32 v24, v24
    v_exp_f32 v25, v25
    v_exp_f32 v26, v26
    v_smfmac_f32_32x32x32_bf16 v[160:175], v[84:87], v[16:23], v96
    v_exp_f32 v27, v27
    v_exp_f32 v28, v28
    v_exp_f32 v29, v29
    v_exp_f32 v30, v30
    v_exp_f32 v31, v31
    v_exp_f32 v32, v32
    v_exp_f32 v33, v33
    v_exp_f32 v34, v34
    v_smfmac_f32_32x32x32_bf16 v[160:175], v[92:95], v[24:31], v96
    s_waitcnt lgkmcnt(2)
    v_exp_f32 v35, v35
    v_exp_f32 v36, v36
    v_exp_f32 v37, v37
    v_mfma_f32_32x32x16_bf16 v[16:31], v[72:75], v[68:71], 0
    ds_read_b128 v[76:79], v127 offset:21504
    global_load_dwordx4 a[72:75], v1, s[64:65] offset:-2048 sc1
    global_load_dwordx4 a[76:79], v1, s[64:65] offset:-1024 sc1
    v_exp_f32 v38, v38
    v_exp_f32 v39, v39
    v_exp_f32 v40, v40
    v_exp_f32 v41, v41
    v_exp_f32 v42, v42
    v_smfmac_f32_32x32x32_bf16 v[48:63], v[84:87], v[32:39], v96
    v_exp_f32 v43, v43
    v_exp_f32 v44, v44
    v_exp_f32 v45, v45
    v_exp_f32 v46, v46
    v_exp_f32 v47, v47
    v_exp_f32 v16, v16
    v_exp_f32 v17, v17
    v_exp_f32 v18, v18
    v_smfmac_f32_32x32x32_bf16 v[48:63], v[92:95], v[40:47], v96
    s_waitcnt lgkmcnt(1)
    v_exp_f32 v19, v19
    v_exp_f32 v20, v20
    v_exp_f32 v21, v21
    v_mfma_f32_32x32x16_bf16 v[32:47], v[72:75], v[64:67], 0
    ds_read_b128 v[84:87], v97 offset:5120
    ds_read_b128 v[92:95], v97 offset:5632
    global_load_dwordx4 a[80:83], v1, s[64:65] offset:0 sc1
    global_load_dwordx4 a[84:87], v1, s[64:65] offset:1024 sc1
    v_exp_f32 v22, v22
    v_exp_f32 v23, v23
    v_exp_f32 v24, v24
    v_exp_f32 v25, v25
    v_exp_f32 v26, v26
    v_smfmac_f32_32x32x32_bf16 v[160:175], v[80:83], v[16:23], v96
    v_exp_f32 v27, v27
    v_exp_f32 v28, v28
    v_exp_f32 v29, v29
    v_exp_f32 v30, v30
    v_exp_f32 v31, v31
    v_exp_f32 v32, v32
    v_exp_f32 v33, v33
    v_exp_f32 v34, v34
    v_smfmac_f32_32x32x32_bf16 v[160:175], v[88:91], v[24:31], v96
    s_waitcnt lgkmcnt(2)
    v_exp_f32 v35, v35
    v_exp_f32 v36, v36
    v_exp_f32 v37, v37
    v_mfma_f32_32x32x16_bf16 v[16:31], v[76:79], v[68:71], 0
    ds_read_b128 v[72:75], v127 offset:22528
    global_load_dwordx4 a[88:91], v1, s[64:65] offset:2048 sc1
    global_load_dwordx4 a[92:95], v1, s[64:65] offset:3072 sc1
    v_exp_f32 v38, v38
    v_exp_f32 v39, v39
    v_exp_f32 v40, v40
    v_exp_f32 v41, v41
    v_exp_f32 v42, v42
    v_smfmac_f32_32x32x32_bf16 v[48:63], v[80:83], v[32:39], v96
    s_add_u32 s64, s64, 8192
    s_addc_u32 s65, s65, 0
    v_exp_f32 v43, v43
    v_exp_f32 v44, v44
    v_exp_f32 v45, v45
    v_exp_f32 v46, v46
    v_exp_f32 v47, v47
    v_exp_f32 v16, v16
    v_exp_f32 v17, v17
    v_exp_f32 v18, v18
    v_smfmac_f32_32x32x32_bf16 v[48:63], v[88:91], v[40:47], v96
    s_waitcnt lgkmcnt(1)
    v_exp_f32 v19, v19
    v_exp_f32 v20, v20
    v_exp_f32 v21, v21
    v_mfma_f32_32x32x16_bf16 v[32:47], v[76:79], v[64:67], 0
    ds_read_b128 v[80:83], v97 offset:6144
    ds_read_b128 v[88:91], v97 offset:6656
    global_load_dwordx4 a[96:99], v1, s[64:65] offset:-4096 sc1
    global_load_dwordx4 a[100:103], v1, s[64:65] offset:-3072 sc1
    v_exp_f32 v22, v22
    v_exp_f32 v23, v23
    v_exp_f32 v24, v24
    v_exp_f32 v25, v25
    v_exp_f32 v26, v26
    v_smfmac_f32_32x32x32_bf16 v[160:175], v[84:87], v[16:23], v96
    v_exp_f32 v27, v27
    v_exp_f32 v28, v28
    v_exp_f32 v29, v29
    v_exp_f32 v30, v30
    v_exp_f32 v31, v31
    v_exp_f32 v32, v32
    v_exp_f32 v33, v33
    v_exp_f32 v34, v34
    v_smfmac_f32_32x32x32_bf16 v[160:175], v[92:95], v[24:31], v96
    s_waitcnt lgkmcnt(2)
    v_exp_f32 v35, v35
    v_exp_f32 v36, v36
    v_exp_f32 v37, v37
    v_mfma_f32_32x32x16_bf16 v[16:31], v[72:75], v[68:71], 0
    ds_read_b128 v[76:79], v127 offset:23552
    global_load_dwordx4 a[104:107], v1, s[64:65] offset:-2048 sc1
    global_load_dwordx4 a[108:111], v1, s[64:65] offset:-1024 sc1
    v_exp_f32 v38, v38
    v_exp_f32 v39, v39
    v_exp_f32 v40, v40
    v_exp_f32 v41, v41
    v_exp_f32 v42, v42
    v_smfmac_f32_32x32x32_bf16 v[48:63], v[84:87], v[32:39], v96
    v_exp_f32 v43, v43
    v_exp_f32 v44, v44
    v_exp_f32 v45, v45
    v_exp_f32 v46, v46
    v_exp_f32 v47, v47
    v_exp_f32 v16, v16
    v_exp_f32 v17, v17
    v_exp_f32 v18, v18
    v_smfmac_f32_32x32x32_bf16 v[48:63], v[92:95], v[40:47], v96
    s_waitcnt lgkmcnt(1)
    v_exp_f32 v19, v19
    v_exp_f32 v20, v20
    v_exp_f32 v21, v21
    v_mfma_f32_32x32x16_bf16 v[32:47], v[72:75], v[64:67], 0
    ds_read_b128 v[84:87], v97 offset:7168
    ds_read_b128 v[92:95], v97 offset:7680
    global_load_dwordx4 a[112:115], v1, s[64:65] offset:0 sc1
    global_load_dwordx4 a[116:119], v1, s[64:65] offset:1024 sc1
    v_exp_f32 v22, v22
    v_exp_f32 v23, v23
    v_exp_f32 v24, v24
    v_exp_f32 v25, v25
    v_exp_f32 v26, v26
    v_smfmac_f32_32x32x32_bf16 v[160:175], v[80:83], v[16:23], v96
    v_exp_f32 v27, v27
    v_exp_f32 v28, v28
    v_exp_f32 v29, v29
    v_exp_f32 v30, v30
    v_exp_f32 v31, v31
    v_exp_f32 v32, v32
    v_exp_f32 v33, v33
    v_exp_f32 v34, v34
    v_smfmac_f32_32x32x32_bf16 v[160:175], v[88:91], v[24:31], v96
    s_waitcnt lgkmcnt(2)
    v_exp_f32 v35, v35
    v_exp_f32 v36, v36
    v_exp_f32 v37, v37
    v_mfma_f32_32x32x16_bf16 v[16:31], v[76:79], v[68:71], 0
    ds_read_b128 v[72:75], v127 offset:24576
    global_load_dwordx4 a[120:123], v1, s[64:65] offset:2048 sc1
    global_load_dwordx4 a[124:127], v1, s[64:65] offset:3072 sc1
    v_exp_f32 v38, v38
    v_exp_f32 v39, v39
    v_exp_f32 v40, v40
    v_exp_f32 v41, v41
    v_exp_f32 v42, v42
    v_smfmac_f32_32x32x32_bf16 v[48:63], v[80:83], v[32:39], v96
    s_add_u32 s64, s64, 8192
    s_addc_u32 s65, s65, 0
    v_exp_f32 v43, v43
    v_exp_f32 v44, v44
    v_add_u32 v97, v97, v98
    v_exp_f32 v45, v45
    v_exp_f32 v46, v46
    v_exp_f32 v47, v47
    v_exp_f32 v16, v16
    v_exp_f32 v17, v17
    v_exp_f32 v18, v18
    v_smfmac_f32_32x32x32_bf16 v[48:63], v[88:91], v[40:47], v96
    s_waitcnt lgkmcnt(1)
    v_exp_f32 v19, v19
    v_exp_f32 v20, v20
    v_exp_f32 v21, v21
    v_mfma_f32_32x32x16_bf16 v[32:47], v[76:79], v[64:67], 0
    ds_read_b128 v[80:83], v97 offset:0
    ds_read_b128 v[88:91], v97 offset:512
    global_load_dwordx4 a[128:131], v1, s[64:65] offset:-4096 sc1
    global_load_dwordx4 a[132:135], v1, s[64:65] offset:-3072 sc1
    v_exp_f32 v22, v22
    v_exp_f32 v23, v23
    v_exp_f32 v24, v24
    v_exp_f32 v25, v25
    v_exp_f32 v26, v26
    v_smfmac_f32_32x32x32_bf16 v[160:175], v[84:87], v[16:23], v96
    v_exp_f32 v27, v27
    v_exp_f32 v28, v28
    v_exp_f32 v29, v29
    v_exp_f32 v30, v30
    v_exp_f32 v31, v31
    v_exp_f32 v32, v32
    v_exp_f32 v33, v33
    v_exp_f32 v34, v34
    v_smfmac_f32_32x32x32_bf16 v[160:175], v[92:95], v[24:31], v96
    s_waitcnt lgkmcnt(2)
    v_exp_f32 v35, v35
    v_exp_f32 v36, v36
    v_exp_f32 v37, v37
    v_mfma_f32_32x32x16_bf16 v[16:31], v[72:75], v[68:71], 0
    ds_read_b128 v[76:79], v127 offset:25600
    global_load_dwordx4 a[136:139], v1, s[64:65] offset:-2048 sc1
    global_load_dwordx4 a[140:143], v1, s[64:65] offset:-1024 sc1
    v_exp_f32 v38, v38
    v_exp_f32 v39, v39
    v_exp_f32 v40, v40
    v_exp_f32 v41, v41
    v_exp_f32 v42, v42
    v_smfmac_f32_32x32x32_bf16 v[48:63], v[84:87], v[32:39], v96
    v_exp_f32 v43, v43
    v_exp_f32 v44, v44
    v_exp_f32 v45, v45
    v_exp_f32 v46, v46
    v_exp_f32 v47, v47
    v_exp_f32 v16, v16
    v_exp_f32 v17, v17
    v_exp_f32 v18, v18
    v_smfmac_f32_32x32x32_bf16 v[48:63], v[92:95], v[40:47], v96
    s_waitcnt lgkmcnt(1)
    v_exp_f32 v19, v19
    v_exp_f32 v20, v20
    v_exp_f32 v21, v21
    v_mfma_f32_32x32x16_bf16 v[32:47], v[72:75], v[64:67], 0
    ds_read_b128 v[84:87], v97 offset:1024
    ds_read_b128 v[92:95], v97 offset:1536
    global_load_dwordx4 a[144:147], v1, s[64:65] offset:0 sc1
    global_load_dwordx4 a[148:151], v1, s[64:65] offset:1024 sc1
    v_exp_f32 v22, v22
    v_exp_f32 v23, v23
    v_exp_f32 v24, v24
    v_exp_f32 v25, v25
    v_exp_f32 v26, v26
    v_smfmac_f32_32x32x32_bf16 v[160:175], v[80:83], v[16:23], v96
    v_exp_f32 v27, v27
    v_exp_f32 v28, v28
    v_exp_f32 v29, v29
    v_exp_f32 v30, v30
    v_exp_f32 v31, v31
    v_exp_f32 v32, v32
    v_exp_f32 v33, v33
    v_exp_f32 v34, v34
    v_smfmac_f32_32x32x32_bf16 v[160:175], v[88:91], v[24:31], v96
    s_waitcnt lgkmcnt(2)
    v_exp_f32 v35, v35
    v_exp_f32 v36, v36
    v_exp_f32 v37, v37
    v_mfma_f32_32x32x16_bf16 v[16:31], v[76:79], v[68:71], 0
    ds_read_b128 v[72:75], v127 offset:26624
    global_load_dwordx4 a[152:155], v1, s[64:65] offset:2048 sc1
    global_load_dwordx4 a[156:159], v1, s[64:65] offset:3072 sc1
    v_exp_f32 v38, v38
    v_exp_f32 v39, v39
    v_exp_f32 v40, v40
    v_exp_f32 v41, v41
    v_exp_f32 v42, v42
    v_smfmac_f32_32x32x32_bf16 v[48:63], v[80:83], v[32:39], v96
    s_add_u32 s64, s64, 8192
    s_addc_u32 s65, s65, 0
    v_exp_f32 v43, v43
    v_exp_f32 v44, v44
    v_exp_f32 v45, v45
    v_exp_f32 v46, v46
    v_exp_f32 v47, v47
    v_exp_f32 v16, v16
    v_exp_f32 v17, v17
    v_exp_f32 v18, v18
    v_smfmac_f32_32x32x32_bf16 v[48:63], v[88:91], v[40:47], v96
    s_waitcnt lgkmcnt(1)
    v_exp_f32 v19, v19
    v_exp_f32 v20, v20
    v_exp_f32 v21, v21
    v_mfma_f32_32x32x16_bf16 v[32:47], v[76:79], v[64:67], 0
    ds_read_b128 v[80:83], v97 offset:2048
    ds_read_b128 v[88:91], v97 offset:2560
    global_load_dwordx4 a[160:163], v1, s[64:65] offset:-4096 sc1
    global_load_dwordx4 a[164:167], v1, s[64:65] offset:-3072 sc1
    v_exp_f32 v22, v22
    v_exp_f32 v23, v23
    v_exp_f32 v24, v24
    v_exp_f32 v25, v25
    v_exp_f32 v26, v26
    v_smfmac_f32_32x32x32_bf16 v[160:175], v[84:87], v[16:23], v96
    v_exp_f32 v27, v27
    v_exp_f32 v28, v28
    v_exp_f32 v29, v29
    v_exp_f32 v30, v30
    v_exp_f32 v31, v31
    v_exp_f32 v32, v32
    v_exp_f32 v33, v33
    v_exp_f32 v34, v34
    v_smfmac_f32_32x32x32_bf16 v[160:175], v[92:95], v[24:31], v96
    s_waitcnt lgkmcnt(2)
    v_exp_f32 v35, v35
    v_exp_f32 v36, v36
    v_exp_f32 v37, v37
    v_mfma_f32_32x32x16_bf16 v[16:31], v[72:75], v[68:71], 0
    ds_read_b128 v[76:79], v127 offset:27648
    global_load_dwordx4 a[168:171], v1, s[64:65] offset:-2048 sc1
    global_load_dwordx4 a[172:175], v1, s[64:65] offset:-1024 sc1
    v_exp_f32 v38, v38
    v_exp_f32 v39, v39
    v_exp_f32 v40, v40
    v_exp_f32 v41, v41
    v_exp_f32 v42, v42
    v_smfmac_f32_32x32x32_bf16 v[48:63], v[84:87], v[32:39], v96
    v_exp_f32 v43, v43
    v_exp_f32 v44, v44
    v_exp_f32 v45, v45
    v_exp_f32 v46, v46
    v_exp_f32 v47, v47
    v_exp_f32 v16, v16
    v_exp_f32 v17, v17
    v_exp_f32 v18, v18
    v_smfmac_f32_32x32x32_bf16 v[48:63], v[92:95], v[40:47], v96
    s_waitcnt lgkmcnt(1)
    v_exp_f32 v19, v19
    v_exp_f32 v20, v20
    v_exp_f32 v21, v21
    v_mfma_f32_32x32x16_bf16 v[32:47], v[72:75], v[64:67], 0
    ds_read_b128 v[84:87], v97 offset:3072
    ds_read_b128 v[92:95], v97 offset:3584
    global_load_dwordx4 a[176:179], v1, s[64:65] offset:0 sc1
    global_load_dwordx4 a[180:183], v1, s[64:65] offset:1024 sc1
    v_exp_f32 v22, v22
    v_exp_f32 v23, v23
    v_exp_f32 v24, v24
    v_exp_f32 v25, v25
    v_exp_f32 v26, v26
    v_smfmac_f32_32x32x32_bf16 v[160:175], v[80:83], v[16:23], v96
    v_exp_f32 v27, v27
    v_exp_f32 v28, v28
    v_exp_f32 v29, v29
    v_exp_f32 v30, v30
    v_exp_f32 v31, v31
    v_exp_f32 v32, v32
    v_exp_f32 v33, v33
    v_exp_f32 v34, v34
    v_smfmac_f32_32x32x32_bf16 v[160:175], v[88:91], v[24:31], v96
    s_waitcnt lgkmcnt(2)
    v_exp_f32 v35, v35
    v_exp_f32 v36, v36
    v_exp_f32 v37, v37
    v_mfma_f32_32x32x16_bf16 v[16:31], v[76:79], v[68:71], 0
    ds_read_b128 v[72:75], v127 offset:28672
    global_load_dwordx4 a[184:187], v1, s[64:65] offset:2048 sc1
    global_load_dwordx4 a[188:191], v1, s[64:65] offset:3072 sc1
    v_exp_f32 v38, v38
    v_exp_f32 v39, v39
    v_exp_f32 v40, v40
    v_exp_f32 v41, v41
    v_exp_f32 v42, v42
    v_smfmac_f32_32x32x32_bf16 v[48:63], v[80:83], v[32:39], v96
    s_add_u32 s64, s64, 8192
    s_addc_u32 s65, s65, 0
    v_exp_f32 v43, v43
    v_exp_f32 v44, v44
    v_exp_f32 v45, v45
    v_exp_f32 v46, v46
    v_exp_f32 v47, v47
    v_exp_f32 v16, v16
    v_exp_f32 v17, v17
    v_exp_f32 v18, v18
    v_smfmac_f32_32x32x32_bf16 v[48:63], v[88:91], v[40:47], v96
    s_waitcnt lgkmcnt(1)
    v_exp_f32 v19, v19
    v_exp_f32 v20, v20
    v_exp_f32 v21, v21
    v_mfma_f32_32x32x16_bf16 v[32:47], v[76:79], v[64:67], 0
    ds_read_b128 v[80:83], v97 offset:4096
    ds_read_b128 v[88:91], v97 offset:4608
    global_load_dwordx4 a[192:195], v1, s[64:65] offset:-4096 sc1
    global_load_dwordx4 a[196:199], v1, s[64:65] offset:-3072 sc1
    v_exp_f32 v22, v22
    v_exp_f32 v23, v23
    v_exp_f32 v24, v24
    v_exp_f32 v25, v25
    v_exp_f32 v26, v26
    v_smfmac_f32_32x32x32_bf16 v[160:175], v[84:87], v[16:23], v96
    v_exp_f32 v27, v27
    v_exp_f32 v28, v28
    v_exp_f32 v29, v29
    v_exp_f32 v30, v30
    v_exp_f32 v31, v31
    v_exp_f32 v32, v32
    v_exp_f32 v33, v33
    v_exp_f32 v34, v34
    v_smfmac_f32_32x32x32_bf16 v[160:175], v[92:95], v[24:31], v96
    s_waitcnt lgkmcnt(2)
    v_exp_f32 v35, v35
    v_exp_f32 v36, v36
    v_exp_f32 v37, v37
    v_mfma_f32_32x32x16_bf16 v[16:31], v[72:75], v[68:71], 0
    ds_read_b128 v[76:79], v127 offset:29696
    global_load_dwordx4 a[200:203], v1, s[64:65] offset:-2048 sc1
    global_load_dwordx4 a[204:207], v1, s[64:65] offset:-1024 sc1
    v_exp_f32 v38, v38
    v_exp_f32 v39, v39
    v_exp_f32 v40, v40
    v_exp_f32 v41, v41
    v_exp_f32 v42, v42
    v_smfmac_f32_32x32x32_bf16 v[48:63], v[84:87], v[32:39], v96
    v_exp_f32 v43, v43
    v_exp_f32 v44, v44
    v_exp_f32 v45, v45
    v_exp_f32 v46, v46
    v_exp_f32 v47, v47
    v_exp_f32 v16, v16
    v_exp_f32 v17, v17
    v_exp_f32 v18, v18
    v_smfmac_f32_32x32x32_bf16 v[48:63], v[92:95], v[40:47], v96
    s_waitcnt lgkmcnt(1)
    v_exp_f32 v19, v19
    v_exp_f32 v20, v20
    v_exp_f32 v21, v21
    v_mfma_f32_32x32x16_bf16 v[32:47], v[72:75], v[64:67], 0
    ds_read_b128 v[84:87], v97 offset:5120
    ds_read_b128 v[92:95], v97 offset:5632
    global_load_dwordx4 a[208:211], v1, s[64:65] offset:0 sc1
    global_load_dwordx4 a[212:215], v1, s[64:65] offset:1024 sc1
    v_exp_f32 v22, v22
    v_exp_f32 v23, v23
    v_exp_f32 v24, v24
    v_exp_f32 v25, v25
    v_exp_f32 v26, v26
    v_smfmac_f32_32x32x32_bf16 v[160:175], v[80:83], v[16:23], v96
    v_exp_f32 v27, v27
    v_exp_f32 v28, v28
    v_exp_f32 v29, v29
    v_exp_f32 v30, v30
    v_exp_f32 v31, v31
    v_exp_f32 v32, v32
    v_exp_f32 v33, v33
    v_exp_f32 v34, v34
    v_smfmac_f32_32x32x32_bf16 v[160:175], v[88:91], v[24:31], v96
    s_waitcnt lgkmcnt(2)
    v_exp_f32 v35, v35
    v_exp_f32 v36, v36
    v_exp_f32 v37, v37
    v_mfma_f32_32x32x16_bf16 v[16:31], v[76:79], v[68:71], 0
    ds_read_b128 v[72:75], v127 offset:30720
    global_load_dwordx4 a[216:219], v1, s[64:65] offset:2048 sc1
    global_load_dwordx4 a[220:223], v1, s[64:65] offset:3072 sc1
    v_exp_f32 v38, v38
    v_exp_f32 v39, v39
    v_exp_f32 v40, v40
    v_exp_f32 v41, v41
    v_exp_f32 v42, v42
    v_smfmac_f32_32x32x32_bf16 v[48:63], v[80:83], v[32:39], v96
    s_add_u32 s64, s64, 8192
    s_addc_u32 s65, s65, 0
    v_exp_f32 v43, v43
    v_exp_f32 v44, v44
    v_exp_f32 v45, v45
    v_exp_f32 v46, v46
    v_exp_f32 v47, v47
    v_exp_f32 v16, v16
    v_exp_f32 v17, v17
    v_exp_f32 v18, v18
    v_smfmac_f32_32x32x32_bf16 v[48:63], v[88:91], v[40:47], v96
    s_waitcnt lgkmcnt(1)
    v_exp_f32 v19, v19
    v_exp_f32 v20, v20
    v_exp_f32 v21, v21
    v_mfma_f32_32x32x16_bf16 v[32:47], v[76:79], v[64:67], 0
    ds_read_b128 v[80:83], v97 offset:6144
    ds_read_b128 v[88:91], v97 offset:6656
    global_load_dwordx4 a[224:227], v1, s[64:65] offset:-4096 sc1
    global_load_dwordx4 a[228:231], v1, s[64:65] offset:-3072 sc1
    v_exp_f32 v22, v22
    v_exp_f32 v23, v23
    v_exp_f32 v24, v24
    v_exp_f32 v25, v25
    v_exp_f32 v26, v26
    v_smfmac_f32_32x32x32_bf16 v[160:175], v[84:87], v[16:23], v96
    v_exp_f32 v27, v27
    v_exp_f32 v28, v28
    v_exp_f32 v29, v29
    v_exp_f32 v30, v30
    v_exp_f32 v31, v31
    v_exp_f32 v32, v32
    v_exp_f32 v33, v33
    v_exp_f32 v34, v34
    v_smfmac_f32_32x32x32_bf16 v[160:175], v[92:95], v[24:31], v96
    s_waitcnt lgkmcnt(2)
    v_exp_f32 v35, v35
    v_exp_f32 v36, v36
    v_exp_f32 v37, v37
    v_mfma_f32_32x32x16_bf16 v[16:31], v[72:75], v[68:71], 0
    ds_read_b128 v[76:79], v127 offset:31744
    global_load_dwordx4 a[232:235], v1, s[64:65] offset:-2048 sc1
    global_load_dwordx4 a[236:239], v1, s[64:65] offset:-1024 sc1
    v_exp_f32 v38, v38
    v_exp_f32 v39, v39
    v_exp_f32 v40, v40
    v_exp_f32 v41, v41
    v_exp_f32 v42, v42
    v_smfmac_f32_32x32x32_bf16 v[48:63], v[84:87], v[32:39], v96
    v_exp_f32 v43, v43
    v_exp_f32 v44, v44
    v_exp_f32 v45, v45
    v_exp_f32 v46, v46
    v_exp_f32 v47, v47
    v_exp_f32 v16, v16
    v_exp_f32 v17, v17
    v_exp_f32 v18, v18
    v_smfmac_f32_32x32x32_bf16 v[48:63], v[92:95], v[40:47], v96
    s_waitcnt lgkmcnt(1)
    v_exp_f32 v19, v19
    v_exp_f32 v20, v20
    v_exp_f32 v21, v21
    v_mfma_f32_32x32x16_bf16 v[32:47], v[72:75], v[64:67], 0
    ds_read_b128 v[84:87], v97 offset:7168
    ds_read_b128 v[92:95], v97 offset:7680
    global_load_dwordx4 a[240:243], v1, s[64:65] offset:0 sc1
    global_load_dwordx4 a[244:247], v1, s[64:65] offset:1024 sc1
    v_exp_f32 v22, v22
    v_exp_f32 v23, v23
    v_exp_f32 v24, v24
    v_exp_f32 v25, v25
    v_exp_f32 v26, v26
    v_smfmac_f32_32x32x32_bf16 v[160:175], v[80:83], v[16:23], v96
    v_exp_f32 v27, v27
    v_exp_f32 v28, v28
    v_exp_f32 v29, v29
    v_exp_f32 v30, v30
    v_exp_f32 v31, v31
    v_exp_f32 v32, v32
    v_exp_f32 v33, v33
    v_exp_f32 v34, v34
    v_smfmac_f32_32x32x32_bf16 v[160:175], v[88:91], v[24:31], v96
    s_waitcnt lgkmcnt(2)
    v_exp_f32 v35, v35
    v_exp_f32 v36, v36
    v_exp_f32 v37, v37
    v_mfma_f32_32x32x16_bf16 v[16:31], v[76:79], v[68:71], 0
    ds_read_b128 v[72:75], v127 offset:0
    global_load_dwordx4 a[248:251], v1, s[64:65] offset:2048 sc1
    global_load_dwordx4 a[252:255], v1, s[64:65] offset:3072 sc1
    v_exp_f32 v38, v38
    v_exp_f32 v39, v39
    v_exp_f32 v40, v40
    v_exp_f32 v41, v41
    v_exp_f32 v42, v42
    v_smfmac_f32_32x32x32_bf16 v[48:63], v[80:83], v[32:39], v96
    v_exp_f32 v43, v43
    v_exp_f32 v44, v44
    v_mul_u32_u24 v5, 3, v98
    v_sub_u32 v97, v97, v5
    v_exp_f32 v45, v45
    v_exp_f32 v46, v46
    v_exp_f32 v47, v47
    v_exp_f32 v16, v16
    v_exp_f32 v17, v17
    v_exp_f32 v18, v18
    v_smfmac_f32_32x32x32_bf16 v[48:63], v[88:91], v[40:47], v96
    s_waitcnt lgkmcnt(1)
    v_exp_f32 v19, v19
    v_exp_f32 v20, v20
    v_exp_f32 v21, v21
    v_mfma_f32_32x32x16_bf16 v[32:47], v[76:79], v[64:67], 0
    ds_read_b128 v[80:83], v97 offset:0
    v_exp_f32 v22, v22
    v_exp_f32 v23, v23
    v_exp_f32 v24, v24
    v_exp_f32 v25, v25
    v_exp_f32 v26, v26
    v_smfmac_f32_32x32x32_bf16 v[160:175], v[84:87], v[16:23], v96
    ds_read_b128 v[88:91], v97 offset:512
    v_exp_f32 v27, v27
    v_exp_f32 v28, v28
    v_exp_f32 v29, v29
    v_exp_f32 v30, v30
    v_exp_f32 v31, v31
    v_exp_f32 v32, v32
    v_exp_f32 v33, v33
    v_exp_f32 v34, v34
    v_smfmac_f32_32x32x32_bf16 v[160:175], v[92:95], v[24:31], v96
    s_waitcnt lgkmcnt(2)
    v_exp_f32 v35, v35
    v_exp_f32 v36, v36
    v_exp_f32 v37, v37
    v_mfma_f32_32x32x16_bf16 v[16:31], v[72:75], v[116:119], 0
    ds_read_b128 v[76:79], v127 offset:1024
    buffer_load_dword v121, v126, s[48:51], 0 offen sc1
    v_exp_f32 v38, v38
    v_exp_f32 v39, v39
    v_exp_f32 v40, v40
    v_exp_f32 v41, v41
    v_exp_f32 v42, v42
    v_smfmac_f32_32x32x32_bf16 v[48:63], v[84:87], v[32:39], v96
    v_exp_f32 v43, v43
    v_exp_f32 v44, v44
    v_exp_f32 v45, v45
    v_exp_f32 v46, v46
    v_exp_f32 v47, v47
    v_exp_f32 v16, v16
    v_exp_f32 v17, v17
    v_exp_f32 v18, v18
    v_smfmac_f32_32x32x32_bf16 v[48:63], v[92:95], v[40:47], v96
    s_waitcnt lgkmcnt(1)
    v_exp_f32 v19, v19
    v_exp_f32 v20, v20
    v_exp_f32 v21, v21
    v_mfma_f32_32x32x16_bf16 v[32:47], v[72:75], v[112:115], 0
    ds_read_b128 v[84:87], v97 offset:1024
    ds_read_b128 v[92:95], v97 offset:1536
    ds_write_b128 v108, v[160:163]
    ds_write_b128 v108, v[164:167] offset:1024
    ds_write_b32 v108, v168 offset:2048
    v_exp_f32 v22, v22
    v_exp_f32 v23, v23
    v_exp_f32 v24, v24
    v_exp_f32 v25, v25
    v_exp_f32 v26, v26
    v_smfmac_f32_32x32x32_bf16 v[224:239], v[80:83], v[16:23], v96
    v_exp_f32 v27, v27
    v_exp_f32 v28, v28
    v_exp_f32 v29, v29
    v_exp_f32 v30, v30
    v_exp_f32 v31, v31
    v_exp_f32 v32, v32
    v_exp_f32 v33, v33
    v_exp_f32 v34, v34
    v_smfmac_f32_32x32x32_bf16 v[224:239], v[88:91], v[24:31], v96
    s_waitcnt lgkmcnt(5)
    v_exp_f32 v35, v35
    v_exp_f32 v36, v36
    v_exp_f32 v37, v37
    v_mfma_f32_32x32x16_bf16 v[16:31], v[76:79], v[116:119], 0
    s_waitcnt lgkmcnt(0)
    s_barrier
    ds_read_b128 v[72:75], v127 offset:2048
    ds_read_b128 v[240:243], v109
    ds_read_b128 v[244:247], v109 offset:1024
    ds_read_b32 v248, v109 offset:2048
    v_exp_f32 v38, v38
    v_exp_f32 v39, v39
    v_exp_f32 v40, v40
    v_exp_f32 v41, v41
    v_exp_f32 v42, v42
    v_smfmac_f32_32x32x32_bf16 v[208:223], v[80:83], v[32:39], v96
    v_exp_f32 v43, v43
    v_exp_f32 v44, v44
    v_exp_f32 v45, v45
    v_exp_f32 v46, v46
    v_exp_f32 v47, v47
    v_exp_f32 v16, v16
    v_exp_f32 v17, v17
    v_exp_f32 v18, v18
    v_smfmac_f32_32x32x32_bf16 v[208:223], v[88:91], v[40:47], v96
    v_exp_f32 v19, v19
    v_exp_f32 v20, v20
    v_exp_f32 v21, v21
    v_mfma_f32_32x32x16_bf16 v[32:47], v[76:79], v[112:115], 0
    ds_read_b128 v[80:83], v97 offset:2048
    v_exp_f32 v22, v22
    v_exp_f32 v23, v23
    v_exp_f32 v24, v24
    v_exp_f32 v25, v25
    v_exp_f32 v26, v26
    v_smfmac_f32_32x32x32_bf16 v[224:239], v[84:87], v[16:23], v96
    ds_read_b128 v[88:91], v97 offset:2560
    v_exp_f32 v27, v27
    v_exp_f32 v28, v28
    s_waitcnt lgkmcnt(2)
    v_add_f32 v56, v56, v248
    v_add_f32 v48, v48, v240
    v_fma_f32 v4, v48, 0, v56
    v_add_f32 v49, v49, v241
    v_fma_f32 v4, v49, 0, v4
    v_add_f32 v50, v50, v242
    v_fma_f32 v4, v50, 0, v4
    v_add_f32 v51, v51, v243
    v_fma_f32 v4, v51, 0, v4
    v_add_f32 v52, v52, v244
    v_fma_f32 v4, v52, 0, v4
    v_exp_f32 v29, v29
    v_exp_f32 v30, v30
    v_exp_f32 v31, v31
    v_exp_f32 v32, v32
    v_exp_f32 v33, v33
    v_exp_f32 v34, v34
    v_smfmac_f32_32x32x32_bf16 v[224:239], v[92:95], v[24:31], v96
    v_exp_f32 v35, v35
    v_exp_f32 v36, v36
    v_exp_f32 v37, v37
    v_mfma_f32_32x32x16_bf16 v[16:31], v[72:75], v[116:119], 0
    ds_read_b128 v[76:79], v127 offset:3072
    v_exp_f32 v38, v38
    v_exp_f32 v39, v39
    v_exp_f32 v40, v40
    v_exp_f32 v41, v41
    v_exp_f32 v42, v42
    v_smfmac_f32_32x32x32_bf16 v[208:223], v[84:87], v[32:39], v96
    v_exp_f32 v43, v43
    v_exp_f32 v44, v44
    v_add_f32 v53, v53, v245
    v_fma_f32 v4, v53, 0, v4
    v_add_f32 v54, v54, v246
    v_fma_f32 v4, v54, 0, v4
    v_add_f32 v55, v55, v247
    v_fma_f32 v4, v55, 0, v4
    v_add_u32 v4, 0xde800000, v4
    v_cmp_lt_u32 vcc, 0x3c000000, v4
    s_cbranch_vccnz L_FB0
L_FBR0:
    v_rcp_f32 v4, v56
    s_nop 0
    v_mul_f32 v48, v4, v48
    v_mul_f32 v49, v4, v49
    v_exp_f32 v45, v45
    v_exp_f32 v46, v46
    v_exp_f32 v47, v47
    v_exp_f32 v16, v16
    v_exp_f32 v17, v17
    v_exp_f32 v18, v18
    v_smfmac_f32_32x32x32_bf16 v[208:223], v[92:95], v[40:47], v96
    s_waitcnt lgkmcnt(1)
    v_exp_f32 v19, v19
    v_exp_f32 v20, v20
    v_exp_f32 v21, v21
    v_mfma_f32_32x32x16_bf16 v[32:47], v[72:75], v[112:115], 0
    ds_read_b128 v[84:87], v97 offset:3072
    v_exp_f32 v22, v22
    v_exp_f32 v23, v23
    v_exp_f32 v24, v24
    v_exp_f32 v25, v25
    v_exp_f32 v26, v26
    v_smfmac_f32_32x32x32_bf16 v[224:239], v[80:83], v[16:23], v96
    ds_read_b128 v[92:95], v97 offset:3584
    v_exp_f32 v27, v27
    v_exp_f32 v28, v28
    v_mul_f32 v50, v4, v50
    v_mul_f32 v51, v4, v51
    v_mul_f32 v52, v4, v52
    v_mul_f32 v53, v4, v53
    v_mul_f32 v54, v4, v54
    v_mul_f32 v55, v4, v55
    v_cvt_pk_bf16_f32 v8, v48, v49
    v_cvt_pk_bf16_f32 v9, v50, v51
    v_cvt_pk_bf16_f32 v10, v52, v53
    v_cvt_pk_bf16_f32 v11, v54, v55
    v_exp_f32 v29, v29
    v_exp_f32 v30, v30
    v_exp_f32 v31, v31
    v_exp_f32 v32, v32
    v_exp_f32 v33, v33
    v_exp_f32 v34, v34
    v_smfmac_f32_32x32x32_bf16 v[224:239], v[88:91], v[24:31], v96
    s_waitcnt lgkmcnt(2)
    v_exp_f32 v35, v35
    v_exp_f32 v36, v36
    v_exp_f32 v37, v37
    v_mfma_f32_32x32x16_bf16 v[16:31], v[76:79], v[116:119], 0
    ds_read_b128 v[72:75], v127 offset:4096
    ds_write_b128 v120, v[8:11] offset:0
    v_exp_f32 v38, v38
    v_exp_f32 v39, v39
    v_exp_f32 v40, v40
    v_exp_f32 v41, v41
    v_exp_f32 v42, v42
    v_smfmac_f32_32x32x32_bf16 v[208:223], v[80:83], v[32:39], v96
    v_exp_f32 v43, v43
    v_exp_f32 v44, v44
    v_exp_f32 v45, v45
    v_exp_f32 v46, v46
    v_exp_f32 v47, v47
    v_exp_f32 v16, v16
    v_exp_f32 v17, v17
    v_exp_f32 v18, v18
    v_smfmac_f32_32x32x32_bf16 v[208:223], v[88:91], v[40:47], v96
    s_waitcnt lgkmcnt(2)
    v_exp_f32 v19, v19
    v_exp_f32 v20, v20
    v_exp_f32 v21, v21
    v_mfma_f32_32x32x16_bf16 v[32:47], v[76:79], v[112:115], 0
    s_waitcnt vmcnt(0)
    v_cmp_ne_u32 vcc, v121, v2
    s_cbranch_vccz L_ok_wfl_25
    s_mov_b32 s82, 200000
L_poll_wfl_26:
    buffer_load_dword v121, v126, s[48:51], 0 offen sc1
    s_waitcnt vmcnt(0)
    v_cmp_ne_u32 vcc, v121, v2
    s_cbranch_vccz L_polld_wfl_27
    s_sub_u32 s82, s82, 1
    s_cmp_lg_u32 s82, 0
    s_cbranch_scc1 L_poll_wfl_26
    s_branch L_TIMEOUT
L_polld_wfl_27:
L_ok_wfl_25:
    s_waitcnt lgkmcnt(0)
    s_barrier
    ds_read_b128 v[80:83], v97 offset:4096
    ds_read_b128 v[88:91], v97 offset:4608
    ds_read_b128 v[128:131], v99 offset:0
    v_exp_f32 v22, v22
    v_exp_f32 v23, v23
    v_exp_f32 v24, v24
    v_exp_f32 v25, v25
    v_exp_f32 v26, v26
    v_smfmac_f32_32x32x32_bf16 v[224:239], v[84:87], v[16:23], v96
    v_exp_f32 v27, v27
    v_exp_f32 v28, v28
    v_exp_f32 v29, v29
    v_exp_f32 v30, v30
    v_exp_f32 v31, v31
    v_exp_f32 v32, v32
    v_exp_f32 v33, v33
    v_exp_f32 v34, v34
    v_smfmac_f32_32x32x32_bf16 v[224:239], v[92:95], v[24:31], v96
    v_exp_f32 v35, v35
    v_exp_f32 v36, v36
    v_exp_f32 v37, v37
    v_mfma_f32_32x32x16_bf16 v[16:31], v[72:75], v[116:119], 0
    ds_read_b128 v[76:79], v127 offset:5120
    v_exp_f32 v38, v38
    v_exp_f32 v39, v39
    v_exp_f32 v40, v40
    s_waitcnt lgkmcnt(1)
    v_mfma_f32_16x16x32_bf16 v[176:179], a[0:3], v[128:131], v[136:139]
    v_exp_f32 v41, v41
    v_exp_f32 v42, v42
    v_smfmac_f32_32x32x32_bf16 v[208:223], v[84:87], v[32:39], v96
    s_add_u32 s64, s64, 8192
    s_addc_u32 s65, s65, 0
    v_exp_f32 v43, v43
    v_exp_f32 v44, v44
    v_exp_f32 v45, v45
    v_mfma_f32_16x16x32_bf16 v[180:183], a[4:7], v[128:131], v[140:143]
    v_exp_f32 v46, v46
    v_exp_f32 v47, v47
    v_exp_f32 v16, v16
    v_exp_f32 v17, v17
    v_exp_f32 v18, v18
    v_smfmac_f32_32x32x32_bf16 v[208:223], v[92:95], v[40:47], v96
    v_exp_f32 v19, v19
    v_exp_f32 v20, v20
    v_exp_f32 v21, v21
    v_mfma_f32_32x32x16_bf16 v[32:47], v[72:75], v[112:115], 0
    ds_read_b128 v[84:87], v97 offset:5120
    ds_read_b128 v[92:95], v97 offset:5632
    global_load_dwordx4 a[0:3], v1, s[64:65] offset:-4096 sc1
    ds_read_b128 v[132:135], v99 offset:512
    global_load_dwordx4 a[4:7], v1, s[64:65] offset:-3072 sc1
    v_exp_f32 v22, v22
    v_exp_f32 v23, v23
    v_exp_f32 v24, v24
    v_mfma_f32_16x16x32_bf16 v[184:187], a[8:11], v[128:131], v[144:147]
    v_exp_f32 v25, v25
    v_exp_f32 v26, v26
    v_smfmac_f32_32x32x32_bf16 v[224:239], v[80:83], v[16:23], v96
    v_exp_f32 v27, v27
    v_exp_f32 v28, v28
    v_exp_f32 v29, v29
    v_mfma_f32_16x16x32_bf16 v[188:191], a[12:15], v[128:131], v[148:151]
    v_exp_f32 v30, v30
    v_exp_f32 v31, v31
    v_exp_f32 v32, v32
    v_exp_f32 v33, v33
    v_exp_f32 v34, v34
    v_smfmac_f32_32x32x32_bf16 v[224:239], v[88:91], v[24:31], v96
    s_waitcnt lgkmcnt(3)
    v_exp_f32 v35, v35
    v_exp_f32 v36, v36
    v_exp_f32 v37, v37
    v_mfma_f32_32x32x16_bf16 v[16:31], v[76:79], v[116:119], 0
    ds_read_b128 v[72:75], v127 offset:6144
    global_load_dwordx4 a[8:11], v1, s[64:65] offset:-2048 sc1
    global_load_dwordx4 a[12:15], v1, s[64:65] offset:-1024 sc1
    v_exp_f32 v38, v38
    v_exp_f32 v39, v39
    v_exp_f32 v40, v40
    v_mfma_f32_16x16x32_bf16 v[192:195], a[16:19], v[128:131], v[136:139]
    v_exp_f32 v41, v41
    v_exp_f32 v42, v42
    v_smfmac_f32_32x32x32_bf16 v[208:223], v[80:83], v[32:39], v96
    v_exp_f32 v43, v43
    v_exp_f32 v44, v44
    v_exp_f32 v45, v45
    v_mfma_f32_16x16x32_bf16 v[196:199], a[20:23], v[128:131], v[140:143]
    v_exp_f32 v46, v46
    v_exp_f32 v47, v47
    v_exp_f32 v16, v16
    v_exp_f32 v17, v17
    v_exp_f32 v18, v18
    v_smfmac_f32_32x32x32_bf16 v[208:223], v[88:91], v[40:47], v96
    s_waitcnt lgkmcnt(2)
    v_exp_f32 v19, v19
    v_exp_f32 v20, v20
    v_exp_f32 v21, v21
    v_mfma_f32_32x32x16_bf16 v[32:47], v[76:79], v[112:115], 0
    ds_read_b128 v[80:83], v97 offset:6144
    ds_read_b128 v[88:91], v97 offset:6656
    global_load_dwordx4 a[16:19], v1, s[64:65] offset:0 sc1
    global_load_dwordx4 a[20:23], v1, s[64:65] offset:1024 sc1
    v_exp_f32 v22, v22
    v_exp_f32 v23, v23
    v_exp_f32 v24, v24
    v_mfma_f32_16x16x32_bf16 v[200:203], a[24:27], v[128:131], v[144:147]
    v_exp_f32 v25, v25
    v_exp_f32 v26, v26
    v_smfmac_f32_32x32x32_bf16 v[224:239], v[84:87], v[16:23], v96
    v_exp_f32 v27, v27
    v_exp_f32 v28, v28
    v_exp_f32 v29, v29
    v_mfma_f32_16x16x32_bf16 v[204:207], a[28:31], v[128:131], v[148:151]
    v_exp_f32 v30, v30
    v_exp_f32 v31, v31
    v_exp_f32 v32, v32
    v_exp_f32 v33, v33
    v_exp_f32 v34, v34
    v_smfmac_f32_32x32x32_bf16 v[224:239], v[92:95], v[24:31], v96
    s_waitcnt lgkmcnt(2)
    v_exp_f32 v35, v35
    v_exp_f32 v36, v36
    v_exp_f32 v37, v37
    v_mfma_f32_32x32x16_bf16 v[16:31], v[72:75], v[116:119], 0
    ds_read_b128 v[76:79], v127 offset:7168
    global_load_dwordx4 a[24:27], v1, s[64:65] offset:2048 sc1
    global_load_dwordx4 a[28:31], v1, s[64:65] offset:3072 sc1
    v_exp_f32 v38, v38
    v_exp_f32 v39, v39
    v_exp_f32 v40, v40
    v_mfma_f32_16x16x32_bf16 v[176:179], a[32:35], v[132:135], v[176:179]
    v_exp_f32 v41, v41
    v_exp_f32 v42, v42
    v_smfmac_f32_32x32x32_bf16 v[208:223], v[84:87], v[32:39], v96
    s_add_u32 s64, s64, 8192
    s_addc_u32 s65, s65, 0
    v_exp_f32 v43, v43
    v_exp_f32 v44, v44
    v_exp_f32 v45, v45
    v_mfma_f32_16x16x32_bf16 v[180:183], a[36:39], v[132:135], v[180:183]
    v_exp_f32 v46, v46
    v_exp_f32 v47, v47
    v_exp_f32 v16, v16
    v_exp_f32 v17, v17
    v_exp_f32 v18, v18
    v_smfmac_f32_32x32x32_bf16 v[208:223], v[92:95], v[40:47], v96
    s_waitcnt lgkmcnt(1)
    v_exp_f32 v19, v19
    v_exp_f32 v20, v20
    v_exp_f32 v21, v21
    v_mfma_f32_32x32x16_bf16 v[32:47], v[72:75], v[112:115], 0
    ds_read_b128 v[84:87], v97 offset:7168
    ds_read_b128 v[92:95], v97 offset:7680
    global_load_dwordx4 a[32:35], v1, s[64:65] offset:-4096 sc1
    ds_read_b128 v[128:131], v99 offset:1024
    global_load_dwordx4 a[36:39], v1, s[64:65] offset:-3072 sc1
    v_exp_f32 v22, v22
    v_exp_f32 v23, v23
    v_exp_f32 v24, v24
    v_mfma_f32_16x16x32_bf16 v[184:187], a[40:43], v[132:135], v[184:187]
    v_exp_f32 v25, v25
    v_exp_f32 v26, v26
    v_smfmac_f32_32x32x32_bf16 v[224:239], v[80:83], v[16:23], v96
    v_exp_f32 v27, v27
    v_exp_f32 v28, v28
    v_exp_f32 v29, v29
    v_mfma_f32_16x16x32_bf16 v[188:191], a[44:47], v[132:135], v[188:191]
    v_exp_f32 v30, v30
    v_exp_f32 v31, v31
    v_exp_f32 v32, v32
    v_exp_f32 v33, v33
    v_exp_f32 v34, v34
    v_smfmac_f32_32x32x32_bf16 v[224:239], v[88:91], v[24:31], v96
    s_waitcnt lgkmcnt(3)
    v_exp_f32 v35, v35
    v_exp_f32 v36, v36
    v_exp_f32 v37, v37
    v_mfma_f32_32x32x16_bf16 v[16:31], v[76:79], v[116:119], 0
    ds_read_b128 v[72:75], v127 offset:8192
    global_load_dwordx4 a[40:43], v1, s[64:65] offset:-2048 sc1
    global_load_dwordx4 a[44:47], v1, s[64:65] offset:-1024 sc1
    v_exp_f32 v38, v38
    v_exp_f32 v39, v39
    v_exp_f32 v40, v40
    v_mfma_f32_16x16x32_bf16 v[192:195], a[48:51], v[132:135], v[192:195]
    v_exp_f32 v41, v41
    v_exp_f32 v42, v42
    v_smfmac_f32_32x32x32_bf16 v[208:223], v[80:83], v[32:39], v96
    v_exp_f32 v43, v43
    v_exp_f32 v44, v44
    v_add_u32 v97, v97, v98
    v_exp_f32 v45, v45
    v_mfma_f32_16x16x32_bf16 v[196:199], a[52:55], v[132:135], v[196:199]
    v_exp_f32 v46, v46
    v_exp_f32 v47, v47
    v_exp_f32 v16, v16
    v_exp_f32 v17, v17
    v_exp_f32 v18, v18
    v_smfmac_f32_32x32x32_bf16 v[208:223], v[88:91], v[40:47], v96
    s_waitcnt lgkmcnt(2)
    v_exp_f32 v19, v19
    v_exp_f32 v20, v20
    v_exp_f32 v21, v21
    v_mfma_f32_32x32x16_bf16 v[32:47], v[76:79], v[112:115], 0
    ds_read_b128 v[80:83], v97 offset:0
    ds_read_b128 v[88:91], v97 offset:512
    global_load_dwordx4 a[48:51], v1, s[64:65] offset:0 sc1
    global_load_dwordx4 a[52:55], v1, s[64:65] offset:1024 sc1
    v_exp_f32 v22, v22
    v_exp_f32 v23, v23
    v_exp_f32 v24, v24
    v_mfma_f32_16x16x32_bf16 v[200:203], a[56:59], v[132:135], v[200:203]
    v_exp_f32 v25, v25
    v_exp_f32 v26, v26
    v_smfmac_f32_32x32x32_bf16 v[224:239], v[84:87], v[16:23], v96
    v_exp_f32 v27, v27
    v_exp_f32 v28, v28
    v_exp_f32 v29, v29
    v_mfma_f32_16x16x32_bf16 v[204:207], a[60:63], v[132:135], v[204:207]
    v_exp_f32 v30, v30
    v_exp_f32 v31, v31
    v_exp_f32 v32, v32
    v_exp_f32 v33, v33
    v_exp_f32 v34, v34
    v_smfmac_f32_32x32x32_bf16 v[224:239], v[92:95], v[24:31], v96
    s_waitcnt lgkmcnt(2)
    v_exp_f32 v35, v35
    v_exp_f32 v36, v36
    v_exp_f32 v37, v37
    v_mfma_f32_32x32x16_bf16 v[16:31], v[72:75], v[116:119], 0
    ds_read_b128 v[76:79], v127 offset:9216
    global_load_dwordx4 a[56:59], v1, s[64:65] offset:2048 sc1
    global_load_dwordx4 a[60:63], v1, s[64:65] offset:3072 sc1
    v_exp_f32 v38, v38
    v_exp_f32 v39, v39
    v_exp_f32 v40, v40
    v_mfma_f32_16x16x32_bf16 v[176:179], a[64:67], v[128:131], v[176:179]
    v_exp_f32 v41, v41
    v_exp_f32 v42, v42
    v_smfmac_f32_32x32x32_bf16 v[208:223], v[84:87], v[32:39], v96
    s_add_u32 s64, s64, 8192
    s_addc_u32 s65, s65, 0
    v_exp_f32 v43, v43
    v_exp_f32 v44, v44
    v_exp_f32 v45, v45
    v_mfma_f32_16x16x32_bf16 v[180:183], a[68:71], v[128:131], v[180:183]
    v_exp_f32 v46, v46
    v_exp_f32 v47, v47
    v_exp_f32 v16, v16
    v_exp_f32 v17, v17
    v_exp_f32 v18, v18
    v_smfmac_f32_32x32x32_bf16 v[208:223], v[92:95], v[40:47], v96
    s_waitcnt lgkmcnt(1)
    v_exp_f32 v19, v19
    v_exp_f32 v20, v20
    v_exp_f32 v21, v21
    v_mfma_f32_32x32x16_bf16 v[32:47], v[72:75], v[112:115], 0
    ds_read_b128 v[84:87], v97 offset:1024
    ds_read_b128 v[92:95], v97 offset:1536
    global_load_dwordx4 a[64:67], v1, s[64:65] offset:-4096 sc1
    ds_read_b128 v[132:135], v99 offset:1536
    global_load_dwordx4 a[68:71], v1, s[64:65] offset:-3072 sc1
    v_exp_f32 v22, v22
    v_exp_f32 v23, v23
    v_exp_f32 v24, v24
    v_mfma_f32_16x16x32_bf16 v[184:187], a[72:75], v[128:131], v[184:187]
    v_exp_f32 v25, v25
    v_exp_f32 v26, v26
    v_smfmac_f32_32x32x32_bf16 v[224:239], v[80:83], v[16:23], v96
    v_exp_f32 v27, v27
    v_exp_f32 v28, v28
    v_exp_f32 v29, v29
    v_mfma_f32_16x16x32_bf16 v[188:191], a[76:79], v[128:131], v[188:191]
    v_exp_f32 v30, v30
    v_exp_f32 v31, v31
    v_exp_f32 v32, v32
    v_exp_f32 v33, v33
    v_exp_f32 v34, v34
    v_smfmac_f32_32x32x32_bf16 v[224:239], v[88:91], v[24:31], v96
    s_waitcnt lgkmcnt(3)
    v_exp_f32 v35, v35
    v_exp_f32 v36, v36
    v_exp_f32 v37, v37
    v_mfma_f32_32x32x16_bf16 v[16:31], v[76:79], v[116:119], 0
    ds_read_b128 v[72:75], v127 offset:10240
    global_load_dwordx4 a[72:75], v1, s[64:65] offset:-2048 sc1
    global_load_dwordx4 a[76:79], v1, s[64:65] offset:-1024 sc1
    v_exp_f32 v38, v38
    v_exp_f32 v39, v39
    v_exp_f32 v40, v40
    v_mfma_f32_16x16x32_bf16 v[192:195], a[80:83], v[128:131], v[192:195]
    v_exp_f32 v41, v41
    v_exp_f32 v42, v42
    v_smfmac_f32_32x32x32_bf16 v[208:223], v[80:83], v[32:39], v96
    v_exp_f32 v43, v43
    v_exp_f32 v44, v44
    v_exp_f32 v45, v45
    v_mfma_f32_16x16x32_bf16 v[196:199], a[84:87], v[128:131], v[196:199]
    v_exp_f32 v46, v46
    v_exp_f32 v47, v47
    v_exp_f32 v16, v16
    v_exp_f32 v17, v17
    v_exp_f32 v18, v18
    v_smfmac_f32_32x32x32_bf16 v[208:223], v[88:91], v[40:47], v96
    s_waitcnt lgkmcnt(2)
    v_exp_f32 v19, v19
    v_exp_f32 v20, v20
    v_exp_f32 v21, v21
    v_mfma_f32_32x32x16_bf16 v[32:47], v[76:79], v[112:115], 0
    ds_read_b128 v[80:83], v97 offset:2048
    ds_read_b128 v[88:91], v97 offset:2560
    global_load_dwordx4 a[80:83], v1, s[64:65] offset:0 sc1
    global_load_dwordx4 a[84:87], v1, s[64:65] offset:1024 sc1
    v_exp_f32 v22, v22
    v_exp_f32 v23, v23
    v_exp_f32 v24, v24
    v_mfma_f32_16x16x32_bf16 v[200:203], a[88:91], v[128:131], v[200:203]
    v_exp_f32 v25, v25
    v_exp_f32 v26, v26
    v_smfmac_f32_32x32x32_bf16 v[224:239], v[84:87], v[16:23], v96
    v_exp_f32 v27, v27
    v_exp_f32 v28, v28
    v_exp_f32 v29, v29
    v_mfma_f32_16x16x32_bf16 v[204:207], a[92:95], v[128:131], v[204:207]
    v_exp_f32 v30, v30
    v_exp_f32 v31, v31
    v_exp_f32 v32, v32
    v_exp_f32 v33, v33
    v_exp_f32 v34, v34
    v_smfmac_f32_32x32x32_bf16 v[224:239], v[92:95], v[24:31], v96
    s_waitcnt lgkmcnt(2)
    v_exp_f32 v35, v35
    v_exp_f32 v36, v36
    v_exp_f32 v37, v37
    v_mfma_f32_32x32x16_bf16 v[16:31], v[72:75], v[116:119], 0
    ds_read_b128 v[76:79], v127 offset:11264
    global_load_dwordx4 a[88:91], v1, s[64:65] offset:2048 sc1
    global_load_dwordx4 a[92:95], v1, s[64:65] offset:3072 sc1
    v_exp_f32 v38, v38
    v_exp_f32 v39, v39
    v_exp_f32 v40, v40
    v_mfma_f32_16x16x32_bf16 v[176:179], a[96:99], v[132:135], v[176:179]
    v_exp_f32 v41, v41
    v_exp_f32 v42, v42
    v_smfmac_f32_32x32x32_bf16 v[208:223], v[84:87], v[32:39], v96
    s_add_u32 s64, s64, 8192
    s_addc_u32 s65, s65, 0
    v_exp_f32 v43, v43
    v_exp_f32 v44, v44
    v_exp_f32 v45, v45
    v_mfma_f32_16x16x32_bf16 v[180:183], a[100:103], v[132:135], v[180:183]
    v_exp_f32 v46, v46
    v_exp_f32 v47, v47
    v_exp_f32 v16, v16
    v_exp_f32 v17, v17
    v_exp_f32 v18, v18
    v_smfmac_f32_32x32x32_bf16 v[208:223], v[92:95], v[40:47], v96
    s_waitcnt lgkmcnt(1)
    v_exp_f32 v19, v19
    v_exp_f32 v20, v20
    v_exp_f32 v21, v21
    v_mfma_f32_32x32x16_bf16 v[32:47], v[72:75], v[112:115], 0
    ds_read_b128 v[84:87], v97 offset:3072
    ds_read_b128 v[92:95], v97 offset:3584
    global_load_dwordx4 a[96:99], v1, s[64:65] offset:-4096 sc1
    ds_read_b128 v[128:131], v99 offset:2048
    global_load_dwordx4 a[100:103], v1, s[64:65] offset:-3072 sc1
    v_exp_f32 v22, v22
    v_exp_f32 v23, v23
    v_exp_f32 v24, v24
    v_mfma_f32_16x16x32_bf16 v[184:187], a[104:107], v[132:135], v[184:187]
    v_exp_f32 v25, v25
    v_exp_f32 v26, v26
    v_smfmac_f32_32x32x32_bf16 v[224:239], v[80:83], v[16:23], v96
    v_exp_f32 v27, v27
    v_exp_f32 v28, v28
    v_exp_f32 v29, v29
    v_mfma_f32_16x16x32_bf16 v[188:191], a[108:111], v[132:135], v[188:191]
    v_exp_f32 v30, v30
    v_exp_f32 v31, v31
    v_exp_f32 v32, v32
    v_exp_f32 v33, v33
    v_exp_f32 v34, v34
    v_smfmac_f32_32x32x32_bf16 v[224:239], v[88:91], v[24:31], v96
    s_waitcnt lgkmcnt(3)
    v_exp_f32 v35, v35
    v_exp_f32 v36, v36
    v_exp_f32 v37, v37
    v_mfma_f32_32x32x16_bf16 v[16:31], v[76:79], v[116:119], 0
    ds_read_b128 v[72:75], v127 offset:12288
    global_load_dwordx4 a[104:107], v1, s[64:65] offset:-2048 sc1
    global_load_dwordx4 a[108:111], v1, s[64:65] offset:-1024 sc1
    v_exp_f32 v38, v38
    v_exp_f32 v39, v39
    v_exp_f32 v40, v40
    v_mfma_f32_16x16x32_bf16 v[192:195], a[112:115], v[132:135], v[192:195]
    v_exp_f32 v41, v41
    v_exp_f32 v42, v42
    v_smfmac_f32_32x32x32_bf16 v[208:223], v[80:83], v[32:39], v96
    v_exp_f32 v43, v43
    v_exp_f32 v44, v44
    v_exp_f32 v45, v45
    v_mfma_f32_16x16x32_bf16 v[196:199], a[116:119], v[132:135], v[196:199]
    v_exp_f32 v46, v46
    v_exp_f32 v47, v47
    v_exp_f32 v16, v16
    v_exp_f32 v17, v17
    v_exp_f32 v18, v18
    v_smfmac_f32_32x32x32_bf16 v[208:223], v[88:91], v[40:47], v96
    s_waitcnt lgkmcnt(2)
    v_exp_f32 v19, v19
    v_exp_f32 v20, v20
    v_exp_f32 v21, v21
    v_mfma_f32_32x32x16_bf16 v[32:47], v[76:79], v[112:115], 0
    ds_read_b128 v[80:83], v97 offset:4096
    ds_read_b128 v[88:91], v97 offset:4608
    global_load_dwordx4 a[112:115], v1, s[64:65] offset:0 sc1
    global_load_dwordx4 a[116:119], v1, s[64:65] offset:1024 sc1
    v_exp_f32 v22, v22
    v_exp_f32 v23, v23
    v_exp_f32 v24, v24
    v_mfma_f32_16x16x32_bf16 v[200:203], a[120:123], v[132:135], v[200:203]
    v_exp_f32 v25, v25
    v_exp_f32 v26, v26
    v_smfmac_f32_32x32x32_bf16 v[224:239], v[84:87], v[16:23], v96
    v_exp_f32 v27, v27
    v_exp_f32 v28, v28
    v_exp_f32 v29, v29
    v_mfma_f32_16x16x32_bf16 v[204:207], a[124:127], v[132:135], v[204:207]
    v_exp_f32 v30, v30
    v_exp_f32 v31, v31
    v_exp_f32 v32, v32
    v_exp_f32 v33, v33
    v_exp_f32 v34, v34
    v_smfmac_f32_32x32x32_bf16 v[224:239], v[92:95], v[24:31], v96
    s_waitcnt lgkmcnt(2)
    v_exp_f32 v35, v35
    v_exp_f32 v36, v36
    v_exp_f32 v37, v37
    v_mfma_f32_32x32x16_bf16 v[16:31], v[72:75], v[116:119], 0
    ds_read_b128 v[76:79], v127 offset:13312
    global_load_dwordx4 a[120:123], v1, s[64:65] offset:2048 sc1
    global_load_dwordx4 a[124:127], v1, s[64:65] offset:3072 sc1
    v_exp_f32 v38, v38
    v_exp_f32 v39, v39
    v_exp_f32 v40, v40
    v_mfma_f32_16x16x32_bf16 v[176:179], a[128:131], v[128:131], v[176:179]
    v_exp_f32 v41, v41
    v_exp_f32 v42, v42
    v_smfmac_f32_32x32x32_bf16 v[208:223], v[84:87], v[32:39], v96
    s_add_u32 s64, s64, 8192
    s_addc_u32 s65, s65, 0
    v_exp_f32 v43, v43
    v_exp_f32 v44, v44
    v_exp_f32 v45, v45
    v_mfma_f32_16x16x32_bf16 v[180:183], a[132:135], v[128:131], v[180:183]
    v_exp_f32 v46, v46
    v_exp_f32 v47, v47
    v_exp_f32 v16, v16
    v_exp_f32 v17, v17
    v_exp_f32 v18, v18
    v_smfmac_f32_32x32x32_bf16 v[208:223], v[92:95], v[40:47], v96
    s_waitcnt lgkmcnt(1)
    v_exp_f32 v19, v19
    v_exp_f32 v20, v20
    v_exp_f32 v21, v21
    v_mfma_f32_32x32x16_bf16 v[32:47], v[72:75], v[112:115], 0
    ds_read_b128 v[84:87], v97 offset:5120
    ds_read_b128 v[92:95], v97 offset:5632
    global_load_dwordx4 a[128:131], v1, s[64:65] offset:-4096 sc1
    ds_read_b128 v[132:135], v99 offset:2560
    global_load_dwordx4 a[132:135], v1, s[64:65] offset:-3072 sc1
    v_exp_f32 v22, v22
    v_exp_f32 v23, v23
    v_exp_f32 v24, v24
    v_mfma_f32_16x16x32_bf16 v[184:187], a[136:139], v[128:131], v[184:187]
    v_exp_f32 v25, v25
    v_exp_f32 v26, v26
    v_smfmac_f32_32x32x32_bf16 v[224:239], v[80:83], v[16:23], v96
    v_exp_f32 v27, v27
    v_exp_f32 v28, v28
    v_exp_f32 v29, v29
    v_mfma_f32_16x16x32_bf16 v[188:191], a[140:143], v[128:131], v[188:191]
    v_exp_f32 v30, v30
    v_exp_f32 v31, v31
    v_exp_f32 v32, v32
    v_exp_f32 v33, v33
    v_exp_f32 v34, v34
    v_smfmac_f32_32x32x32_bf16 v[224:239], v[88:91], v[24:31], v96
    s_waitcnt lgkmcnt(3)
    v_exp_f32 v35, v35
    v_exp_f32 v36, v36
    v_exp_f32 v37, v37
    v_mfma_f32_32x32x16_bf16 v[16:31], v[76:79], v[116:119], 0
    ds_read_b128 v[72:75], v127 offset:14336
    global_load_dwordx4 a[136:139], v1, s[64:65] offset:-2048 sc1
    global_load_dwordx4 a[140:143], v1, s[64:65] offset:-1024 sc1
    v_exp_f32 v38, v38
    v_exp_f32 v39, v39
    v_exp_f32 v40, v40
    v_mfma_f32_16x16x32_bf16 v[192:195], a[144:147], v[128:131], v[192:195]
    v_exp_f32 v41, v41
    v_exp_f32 v42, v42
    v_smfmac_f32_32x32x32_bf16 v[208:223], v[80:83], v[32:39], v96
    v_exp_f32 v43, v43
    v_exp_f32 v44, v44
    v_exp_f32 v45, v45
    v_mfma_f32_16x16x32_bf16 v[196:199], a[148:151], v[128:131], v[196:199]
    v_exp_f32 v46, v46
    v_exp_f32 v47, v47
    v_exp_f32 v16, v16
    v_exp_f32 v17, v17
    v_exp_f32 v18, v18
    v_smfmac_f32_32x32x32_bf16 v[208:223], v[88:91], v[40:47], v96
    s_waitcnt lgkmcnt(2)
    v_exp_f32 v19, v19
    v_exp_f32 v20, v20
    v_exp_f32 v21, v21
    v_mfma_f32_32x32x16_bf16 v[32:47], v[76:79], v[112:115], 0
    ds_read_b128 v[80:83], v97 offset:6144
    ds_read_b128 v[88:91], v97 offset:6656
    global_load_dwordx4 a[144:147], v1, s[64:65] offset:0 sc1
    global_load_dwordx4 a[148:151], v1, s[64:65] offset:1024 sc1
    v_exp_f32 v22, v22
    v_exp_f32 v23, v23
    v_exp_f32 v24, v24
    v_mfma_f32_16x16x32_bf16 v[200:203], a[152:155], v[128:131], v[200:203]
    v_exp_f32 v25, v25
    v_exp_f32 v26, v26
    v_smfmac_f32_32x32x32_bf16 v[224:239], v[84:87], v[16:23], v96
    v_exp_f32 v27, v27
    v_exp_f32 v28, v28
    v_exp_f32 v29, v29
    v_mfma_f32_16x16x32_bf16 v[204:207], a[156:159], v[128:131], v[204:207]
    v_exp_f32 v30, v30
    v_exp_f32 v31, v31
    v_exp_f32 v32, v32
    v_exp_f32 v33, v33
    v_exp_f32 v34, v34
    v_smfmac_f32_32x32x32_bf16 v[224:239], v[92:95], v[24:31], v96
    s_waitcnt lgkmcnt(2)
    v_exp_f32 v35, v35
    v_exp_f32 v36, v36
    v_exp_f32 v37, v37
    v_mfma_f32_32x32x16_bf16 v[16:31], v[72:75], v[116:119], 0
    ds_read_b128 v[76:79], v127 offset:15360
    global_load_dwordx4 a[152:155], v1, s[64:65] offset:2048 sc1
    global_load_dwordx4 a[156:159], v1, s[64:65] offset:3072 sc1
    v_exp_f32 v38, v38
    v_exp_f32 v39, v39
    v_exp_f32 v40, v40
    v_mfma_f32_16x16x32_bf16 v[176:179], a[160:163], v[132:135], v[176:179]
    v_exp_f32 v41, v41
    v_exp_f32 v42, v42
    v_smfmac_f32_32x32x32_bf16 v[208:223], v[84:87], v[32:39], v96
    s_add_u32 s64, s64, 8192
    s_addc_u32 s65, s65, 0
    v_exp_f32 v43, v43
    v_exp_f32 v44, v44
    v_exp_f32 v45, v45
    v_mfma_f32_16x16x32_bf16 v[180:183], a[164:167], v[132:135], v[180:183]
    v_exp_f32 v46, v46
    v_exp_f32 v47, v47
    v_exp_f32 v16, v16
    v_exp_f32 v17, v17
    v_exp_f32 v18, v18
    v_smfmac_f32_32x32x32_bf16 v[208:223], v[92:95], v[40:47], v96
    s_waitcnt lgkmcnt(1)
    v_exp_f32 v19, v19
    v_exp_f32 v20, v20
    v_exp_f32 v21, v21
    v_mfma_f32_32x32x16_bf16 v[32:47], v[72:75], v[112:115], 0
    ds_read_b128 v[84:87], v97 offset:7168
    ds_read_b128 v[92:95], v97 offset:7680
    global_load_dwordx4 a[160:163], v1, s[64:65] offset:-4096 sc1
    ds_read_b128 v[128:131], v99 offset:3072
    global_load_dwordx4 a[164:167], v1, s[64:65] offset:-3072 sc1
    v_exp_f32 v22, v22
    v_exp_f32 v23, v23
    v_exp_f32 v24, v24
    v_mfma_f32_16x16x32_bf16 v[184:187], a[168:171], v[132:135], v[184:187]
    v_exp_f32 v25, v25
    v_exp_f32 v26, v26
    v_smfmac_f32_32x32x32_bf16 v[224:239], v[80:83], v[16:23], v96
    v_exp_f32 v27, v27
    v_exp_f32 v28, v28
    v_exp_f32 v29, v29
    v_mfma_f32_16x16x32_bf16 v[188:191], a[172:175], v[132:135], v[188:191]
    v_exp_f32 v30, v30
    v_exp_f32 v31, v31
    v_exp_f32 v32, v32
    v_exp_f32 v33, v33
    v_exp_f32 v34, v34
    v_smfmac_f32_32x32x32_bf16 v[224:239], v[88:91], v[24:31], v96
    s_waitcnt lgkmcnt(3)
    v_exp_f32 v35, v35
    v_exp_f32 v36, v36
    v_exp_f32 v37, v37
    v_mfma_f32_32x32x16_bf16 v[16:31], v[76:79], v[116:119], 0
    ds_read_b128 v[72:75], v127 offset:16384
    global_load_dwordx4 a[168:171], v1, s[64:65] offset:-2048 sc1
    global_load_dwordx4 a[172:175], v1, s[64:65] offset:-1024 sc1
    v_exp_f32 v38, v38
    v_exp_f32 v39, v39
    v_exp_f32 v40, v40
    v_mfma_f32_16x16x32_bf16 v[192:195], a[176:179], v[132:135], v[192:195]
    v_exp_f32 v41, v41
    v_exp_f32 v42, v42
    v_smfmac_f32_32x32x32_bf16 v[208:223], v[80:83], v[32:39], v96
    v_exp_f32 v43, v43
    v_exp_f32 v44, v44
    v_add_u32 v97, v97, v98
    v_exp_f32 v45, v45
    v_mfma_f32_16x16x32_bf16 v[196:199], a[180:183], v[132:135], v[196:199]
    v_exp_f32 v46, v46
    v_exp_f32 v47, v47
    v_exp_f32 v16, v16
    v_exp_f32 v17, v17
    v_exp_f32 v18, v18
    v_smfmac_f32_32x32x32_bf16 v[208:223], v[88:91], v[40:47], v96
    s_waitcnt lgkmcnt(2)
    v_exp_f32 v19, v19
    v_exp_f32 v20, v20
    v_exp_f32 v21, v21
    v_mfma_f32_32x32x16_bf16 v[32:47], v[76:79], v[112:115], 0
    ds_read_b128 v[80:83], v97 offset:0
    ds_read_b128 v[88:91], v97 offset:512
    global_load_dwordx4 a[176:179], v1, s[64:65] offset:0 sc1
    global_load_dwordx4 a[180:183], v1, s[64:65] offset:1024 sc1
    v_exp_f32 v22, v22
    v_exp_f32 v23, v23
    v_exp_f32 v24, v24
    v_mfma_f32_16x16x32_bf16 v[200:203], a[184:187], v[132:135], v[200:203]
    v_exp_f32 v25, v25
    v_exp_f32 v26, v26
    v_smfmac_f32_32x32x32_bf16 v[224:239], v[84:87], v[16:23], v96
    v_exp_f32 v27, v27
    v_exp_f32 v28, v28
    v_exp_f32 v29, v29
    v_mfma_f32_16x16x32_bf16 v[204:207], a[188:191], v[132:135], v[204:207]
    v_exp_f32 v30, v30
    v_exp_f32 v31, v31
    v_exp_f32 v32, v32
    v_exp_f32 v33, v33
    v_exp_f32 v34, v34
    v_smfmac_f32_32x32x32_bf16 v[224:239], v[92:95], v[24:31], v96
    s_waitcnt lgkmcnt(2)
    v_exp_f32 v35, v35
    v_exp_f32 v36, v36
    v_exp_f32 v37, v37
    v_mfma_f32_32x32x16_bf16 v[16:31], v[72:75], v[116:119], 0
    ds_read_b128 v[76:79], v127 offset:17408
    global_load_dwordx4 a[184:187], v1, s[64:65] offset:2048 sc1
    global_load_dwordx4 a[188:191], v1, s[64:65] offset:3072 sc1
    v_exp_f32 v38, v38
    v_exp_f32 v39, v39
    v_exp_f32 v40, v40
    v_mfma_f32_16x16x32_bf16 v[176:179], a[192:195], v[128:131], v[176:179]
    v_exp_f32 v41, v41
    v_exp_f32 v42, v42
    v_smfmac_f32_32x32x32_bf16 v[208:223], v[84:87], v[32:39], v96
    s_add_u32 s64, s64, 8192
    s_addc_u32 s65, s65, 0
    v_exp_f32 v43, v43
    v_exp_f32 v44, v44
    v_exp_f32 v45, v45
    v_mfma_f32_16x16x32_bf16 v[180:183], a[196:199], v[128:131], v[180:183]
    v_exp_f32 v46, v46
    v_exp_f32 v47, v47
    v_exp_f32 v16, v16
    v_exp_f32 v17, v17
    v_exp_f32 v18, v18
    v_smfmac_f32_32x32x32_bf16 v[208:223], v[92:95], v[40:47], v96
    s_waitcnt lgkmcnt(1)
    v_exp_f32 v19, v19
    v_exp_f32 v20, v20
    v_exp_f32 v21, v21
    v_mfma_f32_32x32x16_bf16 v[32:47], v[72:75], v[112:115], 0
    ds_read_b128 v[84:87], v97 offset:1024
    ds_read_b128 v[92:95], v97 offset:1536
    global_load_dwordx4 a[192:195], v1, s[64:65] offset:-4096 sc1
    ds_read_b128 v[132:135], v99 offset:3584
    global_load_dwordx4 a[196:199], v1, s[64:65] offset:-3072 sc1
    v_exp_f32 v22, v22
    v_exp_f32 v23, v23
    v_exp_f32 v24, v24
    v_mfma_f32_16x16x32_bf16 v[184:187], a[200:203], v[128:131], v[184:187]
    v_exp_f32 v25, v25
    v_exp_f32 v26, v26
    v_smfmac_f32_32x32x32_bf16 v[224:239], v[80:83], v[16:23], v96
    v_exp_f32 v27, v27
    v_exp_f32 v28, v28
    v_exp_f32 v29, v29
    v_mfma_f32_16x16x32_bf16 v[188:191], a[204:207], v[128:131], v[188:191]
    v_exp_f32 v30, v30
    v_exp_f32 v31, v31
    v_exp_f32 v32, v32
    v_exp_f32 v33, v33
    v_exp_f32 v34, v34
    v_smfmac_f32_32x32x32_bf16 v[224:239], v[88:91], v[24:31], v96
    s_waitcnt lgkmcnt(3)
    v_exp_f32 v35, v35
    v_exp_f32 v36, v36
    v_exp_f32 v37, v37
    v_mfma_f32_32x32x16_bf16 v[16:31], v[76:79], v[116:119], 0
    ds_read_b128 v[72:75], v127 offset:18432
    global_load_dwordx4 a[200:203], v1, s[64:65] offset:-2048 sc1
    global_load_dwordx4 a[204:207], v1, s[64:65] offset:-1024 sc1
    v_exp_f32 v38, v38
    v_exp_f32 v39, v39
    v_exp_f32 v40, v40
    v_mfma_f32_16x16x32_bf16 v[192:195], a[208:211], v[128:131], v[192:195]
    v_exp_f32 v41, v41
    v_exp_f32 v42, v42
    v_smfmac_f32_32x32x32_bf16 v[208:223], v[80:83], v[32:39], v96
    v_exp_f32 v43, v43
    v_exp_f32 v44, v44
    v_exp_f32 v45, v45
    v_mfma_f32_16x16x32_bf16 v[196:199], a[212:215], v[128:131], v[196:199]
    v_exp_f32 v46, v46
    v_exp_f32 v47, v47
    v_exp_f32 v16, v16
    v_exp_f32 v17, v17
    v_exp_f32 v18, v18
    v_smfmac_f32_32x32x32_bf16 v[208:223], v[88:91], v[40:47], v96
    s_waitcnt lgkmcnt(2)
    v_exp_f32 v19, v19
    v_exp_f32 v20, v20
    v_exp_f32 v21, v21
    v_mfma_f32_32x32x16_bf16 v[32:47], v[76:79], v[112:115], 0
    ds_read_b128 v[80:83], v97 offset:2048
    ds_read_b128 v[88:91], v97 offset:2560
    global_load_dwordx4 a[208:211], v1, s[64:65] offset:0 sc1
    global_load_dwordx4 a[212:215], v1, s[64:65] offset:1024 sc1
    v_exp_f32 v22, v22
    v_exp_f32 v23, v23
    v_exp_f32 v24, v24
    v_mfma_f32_16x16x32_bf16 v[200:203], a[216:219], v[128:131], v[200:203]
    v_exp_f32 v25, v25
    v_exp_f32 v26, v26
    v_smfmac_f32_32x32x32_bf16 v[224:239], v[84:87], v[16:23], v96
    v_exp_f32 v27, v27
    v_exp_f32 v28, v28
    v_exp_f32 v29, v29
    v_mfma_f32_16x16x32_bf16 v[204:207], a[220:223], v[128:131], v[204:207]
    v_exp_f32 v30, v30
    v_exp_f32 v31, v31
    v_exp_f32 v32, v32
    v_exp_f32 v33, v33
    v_exp_f32 v34, v34
    v_smfmac_f32_32x32x32_bf16 v[224:239], v[92:95], v[24:31], v96
    s_waitcnt lgkmcnt(2)
    v_exp_f32 v35, v35
    v_exp_f32 v36, v36
    v_exp_f32 v37, v37
    v_mfma_f32_32x32x16_bf16 v[16:31], v[72:75], v[116:119], 0
    ds_read_b128 v[76:79], v127 offset:19456
    global_load_dwordx4 a[216:219], v1, s[64:65] offset:2048 sc1
    global_load_dwordx4 a[220:223], v1, s[64:65] offset:3072 sc1
    v_exp_f32 v38, v38
    v_exp_f32 v39, v39
    v_exp_f32 v40, v40
    v_mfma_f32_16x16x32_bf16 v[176:179], a[224:227], v[132:135], v[176:179]
    v_exp_f32 v41, v41
    v_exp_f32 v42, v42
    v_smfmac_f32_32x32x32_bf16 v[208:223], v[84:87], v[32:39], v96
    s_add_u32 s64, s64, 8192
    s_addc_u32 s65, s65, 0
    v_exp_f32 v43, v43
    v_exp_f32 v44, v44
    v_exp_f32 v45, v45
    v_mfma_f32_16x16x32_bf16 v[180:183], a[228:231], v[132:135], v[180:183]
    v_exp_f32 v46, v46
    v_exp_f32 v47, v47
    v_exp_f32 v16, v16
    v_exp_f32 v17, v17
    v_exp_f32 v18, v18
    v_smfmac_f32_32x32x32_bf16 v[208:223], v[92:95], v[40:47], v96
    s_waitcnt lgkmcnt(1)
    v_exp_f32 v19, v19
    v_exp_f32 v20, v20
    v_exp_f32 v21, v21
    v_mfma_f32_32x32x16_bf16 v[32:47], v[72:75], v[112:115], 0
    ds_read_b128 v[84:87], v97 offset:3072
    ds_read_b128 v[92:95], v97 offset:3584
    global_load_dwordx4 a[224:227], v1, s[64:65] offset:-4096 sc1
    global_load_dwordx4 a[228:231], v1, s[64:65] offset:-3072 sc1
    v_exp_f32 v22, v22
    v_exp_f32 v23, v23
    v_exp_f32 v24, v24
    v_mfma_f32_16x16x32_bf16 v[184:187], a[232:235], v[132:135], v[184:187]
    v_exp_f32 v25, v25
    v_exp_f32 v26, v26
    v_smfmac_f32_32x32x32_bf16 v[224:239], v[80:83], v[16:23], v96
    v_exp_f32 v27, v27
    v_exp_f32 v28, v28
    v_exp_f32 v29, v29
    v_mfma_f32_16x16x32_bf16 v[188:191], a[236:239], v[132:135], v[188:191]
    v_exp_f32 v30, v30
    v_exp_f32 v31, v31
    v_exp_f32 v32, v32
    v_exp_f32 v33, v33
    v_exp_f32 v34, v34
    v_smfmac_f32_32x32x32_bf16 v[224:239], v[88:91], v[24:31], v96
    s_waitcnt lgkmcnt(2)
    v_exp_f32 v35, v35
    v_exp_f32 v36, v36
    v_exp_f32 v37, v37
    v_mfma_f32_32x32x16_bf16 v[16:31], v[76:79], v[116:119], 0
    ds_read_b128 v[72:75], v127 offset:20480
    global_load_dwordx4 a[232:235], v1, s[64:65] offset:-2048 sc1
    global_load_dwordx4 a[236:239], v1, s[64:65] offset:-1024 sc1
    v_exp_f32 v38, v38
    v_exp_f32 v39, v39
    v_exp_f32 v40, v40
    v_mfma_f32_16x16x32_bf16 v[192:195], a[240:243], v[132:135], v[192:195]
    v_exp_f32 v41, v41
    v_exp_f32 v42, v42
    v_smfmac_f32_32x32x32_bf16 v[208:223], v[80:83], v[32:39], v96
    v_exp_f32 v43, v43
    v_exp_f32 v44, v44
    v_exp_f32 v45, v45
    v_mfma_f32_16x16x32_bf16 v[196:199], a[244:247], v[132:135], v[196:199]
    v_exp_f32 v46, v46
    v_exp_f32 v47, v47
    v_exp_f32 v16, v16
    v_exp_f32 v17, v17
    v_exp_f32 v18, v18
    v_smfmac_f32_32x32x32_bf16 v[208:223], v[88:91], v[40:47], v96
    s_waitcnt lgkmcnt(1)
    v_exp_f32 v19, v19
    v_exp_f32 v20, v20
    v_exp_f32 v21, v21
    v_mfma_f32_32x32x16_bf16 v[32:47], v[76:79], v[112:115], 0
    ds_read_b128 v[80:83], v97 offset:4096
    ds_read_b128 v[88:91], v97 offset:4608
    global_load_dwordx4 a[240:243], v1, s[64:65] offset:0 sc1
    global_load_dwordx4 a[244:247], v1, s[64:65] offset:1024 sc1
    v_exp_f32 v22, v22
    v_exp_f32 v23, v23
    v_exp_f32 v24, v24
    v_mfma_f32_16x16x32_bf16 v[200:203], a[248:251], v[132:135], v[200:203]
    v_exp_f32 v25, v25
    v_exp_f32 v26, v26
    v_smfmac_f32_32x32x32_bf16 v[224:239], v[84:87], v[16:23], v96
    v_exp_f32 v27, v27
    v_exp_f32 v28, v28
    v_exp_f32 v29, v29
    v_mfma_f32_16x16x32_bf16 v[204:207], a[252:255], v[132:135], v[204:207]
    v_exp_f32 v30, v30
    v_exp_f32 v31, v31
    v_exp_f32 v32, v32
    v_exp_f32 v33, v33
    v_exp_f32 v34, v34
    v_smfmac_f32_32x32x32_bf16 v[224:239], v[92:95], v[24:31], v96
    s_waitcnt lgkmcnt(2)
    v_exp_f32 v35, v35
    v_exp_f32 v36, v36
    v_exp_f32 v37, v37
    v_mfma_f32_32x32x16_bf16 v[16:31], v[72:75], v[116:119], 0
    ds_read_b128 v[76:79], v127 offset:21504
    global_load_dwordx4 a[248:251], v1, s[64:65] offset:2048 sc1
    global_load_dwordx4 a[252:255], v1, s[64:65] offset:3072 sc1
    v_exp_f32 v38, v38
    v_exp_f32 v39, v39
    v_exp_f32 v40, v40
    v_exp_f32 v41, v41
    v_exp_f32 v42, v42
    v_smfmac_f32_32x32x32_bf16 v[208:223], v[84:87], v[32:39], v96
    v_exp_f32 v43, v43
    v_exp_f32 v44, v44
    v_exp_f32 v45, v45
    v_exp_f32 v46, v46
    v_exp_f32 v47, v47
    v_exp_f32 v16, v16
    v_exp_f32 v17, v17
    v_exp_f32 v18, v18
    v_smfmac_f32_32x32x32_bf16 v[208:223], v[92:95], v[40:47], v96
    s_waitcnt lgkmcnt(1)
    v_exp_f32 v19, v19
    v_exp_f32 v20, v20
    v_exp_f32 v21, v21
    v_mfma_f32_32x32x16_bf16 v[32:47], v[72:75], v[112:115], 0
    ds_read_b128 v[84:87], v97 offset:5120
    v_exp_f32 v22, v22
    v_exp_f32 v23, v23
    v_exp_f32 v24, v24
    v_exp_f32 v25, v25
    v_exp_f32 v26, v26
    v_smfmac_f32_32x32x32_bf16 v[224:239], v[80:83], v[16:23], v96
    s_add_u32 s66, s20, 4096
    s_add_u32 s66, s66, s30
    s_addc_u32 s67, s31, 0
    ds_read_b128 v[92:95], v97 offset:5632
    v_exp_f32 v27, v27
    v_exp_f32 v28, v28
    v_exp_f32 v29, v29
    v_exp_f32 v30, v30
    v_exp_f32 v31, v31
    v_exp_f32 v32, v32
    v_exp_f32 v33, v33
    v_exp_f32 v34, v34
    v_smfmac_f32_32x32x32_bf16 v[224:239], v[88:91], v[24:31], v96
    s_waitcnt lgkmcnt(2)
    v_exp_f32 v35, v35
    v_exp_f32 v36, v36
    v_exp_f32 v37, v37
    v_mfma_f32_32x32x16_bf16 v[16:31], v[76:79], v[116:119], 0
    ds_read_b128 v[72:75], v127 offset:22528
    global_load_dwordx4 v[48:51], v1, s[66:67] offset:-4096 sc1
    global_load_dwordx4 v[52:55], v1, s[66:67] offset:-3072 sc1
    v_exp_f32 v38, v38
    v_exp_f32 v39, v39
    v_exp_f32 v40, v40
    v_exp_f32 v41, v41
    v_exp_f32 v42, v42
    v_smfmac_f32_32x32x32_bf16 v[208:223], v[80:83], v[32:39], v96
    v_exp_f32 v43, v43
    v_exp_f32 v44, v44
    v_exp_f32 v45, v45
    v_exp_f32 v46, v46
    v_exp_f32 v47, v47
    v_exp_f32 v16, v16
    v_exp_f32 v17, v17
    v_exp_f32 v18, v18
    v_smfmac_f32_32x32x32_bf16 v[208:223], v[88:91], v[40:47], v96
    s_waitcnt lgkmcnt(1)
    v_exp_f32 v19, v19
    v_exp_f32 v20, v20
    v_exp_f32 v21, v21
    v_mfma_f32_32x32x16_bf16 v[32:47], v[76:79], v[112:115], 0
    ds_read_b128 v[80:83], v97 offset:6144
    ds_read_b128 v[88:91], v97 offset:6656
    global_load_dwordx4 v[56:59], v1, s[66:67] offset:-2048 sc1
    global_load_dwordx4 v[60:63], v1, s[66:67] offset:-1024 sc1
    v_exp_f32 v22, v22
    v_exp_f32 v23, v23
    v_exp_f32 v24, v24
    v_exp_f32 v25, v25
    v_exp_f32 v26, v26
    v_smfmac_f32_32x32x32_bf16 v[224:239], v[84:87], v[16:23], v96
    v_exp_f32 v27, v27
    v_exp_f32 v28, v28
    v_exp_f32 v29, v29
    v_exp_f32 v30, v30
    v_exp_f32 v31, v31
    v_exp_f32 v32, v32
    v_exp_f32 v33, v33
    v_exp_f32 v34, v34
    v_smfmac_f32_32x32x32_bf16 v[224:239], v[92:95], v[24:31], v96
    s_waitcnt lgkmcnt(2)
    v_exp_f32 v35, v35
    v_exp_f32 v36, v36
    v_exp_f32 v37, v37
    v_mfma_f32_32x32x16_bf16 v[16:31], v[72:75], v[116:119], 0
    ds_read_b128 v[76:79], v127 offset:23552
    global_load_dwordx4 v[160:163], v1, s[66:67] offset:0 sc1
    global_load_dwordx4 v[164:167], v1, s[66:67] offset:1024 sc1
    v_exp_f32 v38, v38
    v_exp_f32 v39, v39
    v_exp_f32 v40, v40
    v_exp_f32 v41, v41
    v_exp_f32 v42, v42
    v_smfmac_f32_32x32x32_bf16 v[208:223], v[84:87], v[32:39], v96
    v_exp_f32 v43, v43
    v_exp_f32 v44, v44
    v_exp_f32 v45, v45
    v_exp_f32 v46, v46
    v_exp_f32 v47, v47
    v_exp_f32 v16, v16
    v_exp_f32 v17, v17
    v_exp_f32 v18, v18
    v_smfmac_f32_32x32x32_bf16 v[208:223], v[92:95], v[40:47], v96
    s_waitcnt lgkmcnt(1)
    v_exp_f32 v19, v19
    v_exp_f32 v20, v20
    v_exp_f32 v21, v21
    v_mfma_f32_32x32x16_bf16 v[32:47], v[72:75], v[112:115], 0
    ds_read_b128 v[84:87], v97 offset:7168
    ds_read_b128 v[92:95], v97 offset:7680
    global_load_dwordx4 v[168:171], v1, s[66:67] offset:2048 sc1
    global_load_dwordx4 v[172:175], v1, s[66:67] offset:3072 sc1
    v_exp_f32 v22, v22
    v_exp_f32 v23, v23
    v_exp_f32 v24, v24
    v_exp_f32 v25, v25
    v_exp_f32 v26, v26
    v_smfmac_f32_32x32x32_bf16 v[224:239], v[80:83], v[16:23], v96
    s_add_u32 s66, s20, 12288
    s_add_u32 s66, s66, s30
    s_addc_u32 s67, s31, 0
    v_exp_f32 v27, v27
    v_exp_f32 v28, v28
    v_exp_f32 v29, v29
    v_exp_f32 v30, v30
    v_exp_f32 v31, v31
    v_exp_f32 v32, v32
    v_exp_f32 v33, v33
    v_exp_f32 v34, v34
    v_smfmac_f32_32x32x32_bf16 v[224:239], v[88:91], v[24:31], v96
    s_waitcnt lgkmcnt(2)
    v_exp_f32 v35, v35
    v_exp_f32 v36, v36
    v_exp_f32 v37, v37
    v_mfma_f32_32x32x16_bf16 v[16:31], v[76:79], v[116:119], 0
    ds_read_b128 v[72:75], v127 offset:24576
    global_load_dwordx4 v[136:139], v1, s[66:67] offset:-4096 sc1
    global_load_dwordx4 v[140:143], v1, s[66:67] offset:-3072 sc1
    v_exp_f32 v38, v38
    v_exp_f32 v39, v39
    v_exp_f32 v40, v40
    v_exp_f32 v41, v41
    v_exp_f32 v42, v42
    v_smfmac_f32_32x32x32_bf16 v[208:223], v[80:83], v[32:39], v96
    v_exp_f32 v43, v43
    v_exp_f32 v44, v44
    v_add_u32 v97, v97, v98
    v_exp_f32 v45, v45
    v_exp_f32 v46, v46
    v_exp_f32 v47, v47
    v_exp_f32 v16, v16
    v_exp_f32 v17, v17
    v_exp_f32 v18, v18
    v_smfmac_f32_32x32x32_bf16 v[208:223], v[88:91], v[40:47], v96
    s_waitcnt lgkmcnt(1)
    v_exp_f32 v19, v19
    v_exp_f32 v20, v20
    v_exp_f32 v21, v21
    v_mfma_f32_32x32x16_bf16 v[32:47], v[76:79], v[112:115], 0
    ds_read_b128 v[80:83], v97 offset:0
    ds_read_b128 v[88:91], v97 offset:512
    global_load_dwordx4 v[144:147], v1, s[66:67] offset:-2048 sc1
    global_load_dwordx4 v[148:151], v1, s[66:67] offset:-1024 sc1
    v_exp_f32 v22, v22
    v_exp_f32 v23, v23
    v_exp_f32 v24, v24
    v_exp_f32 v25, v25
    v_exp_f32 v26, v26
    v_smfmac_f32_32x32x32_bf16 v[224:239], v[84:87], v[16:23], v96
    v_exp_f32 v27, v27
    v_exp_f32 v28, v28
    v_exp_f32 v29, v29
    v_exp_f32 v30, v30
    v_exp_f32 v31, v31
    v_exp_f32 v32, v32
    v_exp_f32 v33, v33
    v_exp_f32 v34, v34
    v_smfmac_f32_32x32x32_bf16 v[224:239], v[92:95], v[24:31], v96
    s_waitcnt lgkmcnt(2)
    v_exp_f32 v35, v35
    v_exp_f32 v36, v36
    v_exp_f32 v37, v37
    v_mfma_f32_32x32x16_bf16 v[16:31], v[72:75], v[116:119], 0
    ds_read_b128 v[76:79], v127 offset:25600
    global_load_dwordx4 v[64:67], v1, s[66:67] offset:0 sc1
    global_load_dwordx4 v[68:71], v1, s[66:67] offset:1024 sc1
    v_exp_f32 v38, v38
    v_exp_f32 v39, v39
    v_exp_f32 v40, v40
    v_exp_f32 v41, v41
    v_exp_f32 v42, v42
    v_smfmac_f32_32x32x32_bf16 v[208:223], v[84:87], v[32:39], v96
    v_exp_f32 v43, v43
    v_exp_f32 v44, v44
    v_exp_f32 v45, v45
    v_exp_f32 v46, v46
    v_exp_f32 v47, v47
    v_exp_f32 v16, v16
    v_exp_f32 v17, v17
    v_exp_f32 v18, v18
    v_smfmac_f32_32x32x32_bf16 v[208:223], v[92:95], v[40:47], v96
    s_waitcnt lgkmcnt(1)
    v_exp_f32 v19, v19
    v_exp_f32 v20, v20
    v_exp_f32 v21, v21
    v_mfma_f32_32x32x16_bf16 v[32:47], v[72:75], v[112:115], 0
    s_barrier
    ds_read_b128 v[84:87], v97 offset:1024
    v_exp_f32 v22, v22
    v_exp_f32 v23, v23
    v_exp_f32 v24, v24
    v_exp_f32 v25, v25
    v_exp_f32 v26, v26
    v_smfmac_f32_32x32x32_bf16 v[224:239], v[80:83], v[16:23], v96
    s_add_u32 s66, s16, 0
    s_addc_u32 s67, s13, 0
    ds_read_b128 v[92:95], v97 offset:1536
    v_exp_f32 v27, v27
    v_exp_f32 v28, v28
    v_exp_f32 v29, v29
    v_exp_f32 v30, v30
    v_exp_f32 v31, v31
    v_exp_f32 v32, v32
    v_exp_f32 v33, v33
    v_exp_f32 v34, v34
    v_smfmac_f32_32x32x32_bf16 v[224:239], v[88:91], v[24:31], v96
    s_waitcnt lgkmcnt(2)
    v_exp_f32 v35, v35
    v_exp_f32 v36, v36
    v_exp_f32 v37, v37
    v_mfma_f32_32x32x16_bf16 v[16:31], v[76:79], v[116:119], 0
    s_add_u32 m0, s83, 0
    ds_read_b128 v[72:75], v127 offset:26624
    global_load_lds_dwordx4 v1, s[66:67] offset:0 sc1
    global_load_lds_dwordx4 v1, s[66:67] offset:1024 sc1
    v_exp_f32 v38, v38
    v_exp_f32 v39, v39
    v_exp_f32 v40, v40
    v_exp_f32 v41, v41
    v_exp_f32 v42, v42
    v_smfmac_f32_32x32x32_bf16 v[208:223], v[80:83], v[32:39], v96
    v_exp_f32 v43, v43
    v_exp_f32 v44, v44
    v_exp_f32 v45, v45
    v_exp_f32 v46, v46
    v_exp_f32 v47, v47
    v_exp_f32 v16, v16
    v_exp_f32 v17, v17
    v_exp_f32 v18, v18
    v_smfmac_f32_32x32x32_bf16 v[208:223], v[88:91], v[40:47], v96
    s_waitcnt lgkmcnt(1)
    v_exp_f32 v19, v19
    v_exp_f32 v20, v20
    v_exp_f32 v21, v21
    v_mfma_f32_32x32x16_bf16 v[32:47], v[76:79], v[112:115], 0
    ds_read_b128 v[80:83], v97 offset:2048
    ds_read_b128 v[88:91], v97 offset:2560
    global_load_lds_dwordx4 v1, s[66:67] offset:2048 sc1
    global_load_lds_dwordx4 v1, s[66:67] offset:3072 sc1
    v_exp_f32 v22, v22
    v_exp_f32 v23, v23
    v_exp_f32 v24, v24
    v_exp_f32 v25, v25
    v_exp_f32 v26, v26
    v_smfmac_f32_32x32x32_bf16 v[224:239], v[84:87], v[16:23], v96
    s_add_u32 s66, s16, 4096
    s_addc_u32 s67, s13, 0
    v_exp_f32 v27, v27
    v_exp_f32 v28, v28
    v_exp_f32 v29, v29
    v_exp_f32 v30, v30
    v_exp_f32 v31, v31
    v_exp_f32 v32, v32
    v_exp_f32 v33, v33
    v_exp_f32 v34, v34
    v_smfmac_f32_32x32x32_bf16 v[224:239], v[92:95], v[24:31], v96
    s_waitcnt lgkmcnt(2)
    v_exp_f32 v35, v35
    v_exp_f32 v36, v36
    v_exp_f32 v37, v37
    v_mfma_f32_32x32x16_bf16 v[16:31], v[72:75], v[116:119], 0
    s_add_u32 m0, s83, 4096
    ds_read_b128 v[76:79], v127 offset:27648
    global_load_lds_dwordx4 v1, s[66:67] offset:0 sc1
    global_load_lds_dwordx4 v1, s[66:67] offset:1024 sc1
    v_exp_f32 v38, v38
    v_exp_f32 v39, v39
    v_exp_f32 v40, v40
    v_exp_f32 v41, v41
    v_exp_f32 v42, v42
    v_smfmac_f32_32x32x32_bf16 v[208:223], v[84:87], v[32:39], v96
    v_exp_f32 v43, v43
    v_exp_f32 v44, v44
    v_exp_f32 v45, v45
    v_exp_f32 v46, v46
    v_exp_f32 v47, v47
    v_exp_f32 v16, v16
    v_exp_f32 v17, v17
    v_exp_f32 v18, v18
    v_smfmac_f32_32x32x32_bf16 v[208:223], v[92:95], v[40:47], v96
    s_waitcnt lgkmcnt(1)
    v_exp_f32 v19, v19
    v_exp_f32 v20, v20
    v_exp_f32 v21, v21
    v_mfma_f32_32x32x16_bf16 v[32:47], v[72:75], v[112:115], 0
    ds_read_b128 v[84:87], v97 offset:3072
    ds_read_b128 v[92:95], v97 offset:3584
    global_load_lds_dwordx4 v1, s[66:67] offset:2048 sc1
    global_load_lds_dwordx4 v1, s[66:67] offset:3072 sc1
    v_exp_f32 v22, v22
    v_exp_f32 v23, v23
    v_exp_f32 v24, v24
    v_exp_f32 v25, v25
    v_exp_f32 v26, v26
    v_smfmac_f32_32x32x32_bf16 v[224:239], v[80:83], v[16:23], v96
    s_add_u32 s66, s16, 32768
    s_addc_u32 s67, s13, 0
    v_exp_f32 v27, v27
    v_exp_f32 v28, v28
    v_exp_f32 v29, v29
    v_exp_f32 v30, v30
    v_exp_f32 v31, v31
    v_exp_f32 v32, v32
    v_exp_f32 v33, v33
    v_exp_f32 v34, v34
    v_smfmac_f32_32x32x32_bf16 v[224:239], v[88:91], v[24:31], v96
    s_waitcnt lgkmcnt(2)
    v_exp_f32 v35, v35
    v_exp_f32 v36, v36
    v_exp_f32 v37, v37
    v_mfma_f32_32x32x16_bf16 v[16:31], v[76:79], v[116:119], 0
    s_add_u32 m0, s83, 8192
    ds_read_b128 v[72:75], v127 offset:28672
    global_load_lds_dwordx4 v1, s[66:67] offset:0 sc1
    global_load_lds_dwordx4 v1, s[66:67] offset:1024 sc1
    v_exp_f32 v38, v38
    v_exp_f32 v39, v39
    v_exp_f32 v40, v40
    v_exp_f32 v41, v41
    v_exp_f32 v42, v42
    v_smfmac_f32_32x32x32_bf16 v[208:223], v[80:83], v[32:39], v96
    v_exp_f32 v43, v43
    v_exp_f32 v44, v44
    v_exp_f32 v45, v45
    v_exp_f32 v46, v46
    v_exp_f32 v47, v47
    v_exp_f32 v16, v16
    v_exp_f32 v17, v17
    v_exp_f32 v18, v18
    v_smfmac_f32_32x32x32_bf16 v[208:223], v[88:91], v[40:47], v96
    s_waitcnt lgkmcnt(1)
    v_exp_f32 v19, v19
    v_exp_f32 v20, v20
    v_exp_f32 v21, v21
    v_mfma_f32_32x32x16_bf16 v[32:47], v[76:79], v[112:115], 0
    ds_read_b128 v[80:83], v97 offset:4096
    ds_read_b128 v[88:91], v97 offset:4608
    global_load_lds_dwordx4 v1, s[66:67] offset:2048 sc1
    global_load_lds_dwordx4 v1, s[66:67] offset:3072 sc1
    v_exp_f32 v22, v22
    v_exp_f32 v23, v23
    v_exp_f32 v24, v24
    v_exp_f32 v25, v25
    v_exp_f32 v26, v26
    v_smfmac_f32_32x32x32_bf16 v[224:239], v[84:87], v[16:23], v96
    s_add_u32 s66, s16, 36864
    s_addc_u32 s67, s13, 0
    v_exp_f32 v27, v27
    v_exp_f32 v28, v28
    v_exp_f32 v29, v29
    v_exp_f32 v30, v30
    v_exp_f32 v31, v31
    v_exp_f32 v32, v32
    v_exp_f32 v33, v33
    v_exp_f32 v34, v34
    v_smfmac_f32_32x32x32_bf16 v[224:239], v[92:95], v[24:31], v96
    s_waitcnt lgkmcnt(2)
    v_exp_f32 v35, v35
    v_exp_f32 v36, v36
    v_exp_f32 v37, v37
    v_mfma_f32_32x32x16_bf16 v[16:31], v[72:75], v[116:119], 0
    s_add_u32 m0, s83, 12288
    ds_read_b128 v[76:79], v127 offset:29696
    global_load_lds_dwordx4 v1, s[66:67] offset:0 sc1
    global_load_lds_dwordx4 v1, s[66:67] offset:1024 sc1
    v_exp_f32 v38, v38
    v_exp_f32 v39, v39
    v_exp_f32 v40, v40
    v_exp_f32 v41, v41
    v_exp_f32 v42, v42
    v_smfmac_f32_32x32x32_bf16 v[208:223], v[84:87], v[32:39], v96
    v_exp_f32 v43, v43
    v_exp_f32 v44, v44
    v_exp_f32 v45, v45
    v_exp_f32 v46, v46
    v_exp_f32 v47, v47
    v_exp_f32 v16, v16
    v_exp_f32 v17, v17
    v_exp_f32 v18, v18
    v_smfmac_f32_32x32x32_bf16 v[208:223], v[92:95], v[40:47], v96
    s_waitcnt lgkmcnt(1)
    v_exp_f32 v19, v19
    v_exp_f32 v20, v20
    v_exp_f32 v21, v21
    v_mfma_f32_32x32x16_bf16 v[32:47], v[72:75], v[112:115], 0
    ds_read_b128 v[84:87], v97 offset:5120
    ds_read_b128 v[92:95], v97 offset:5632
    global_load_lds_dwordx4 v1, s[66:67] offset:2048 sc1
    global_load_lds_dwordx4 v1, s[66:67] offset:3072 sc1
    v_exp_f32 v22, v22
    v_exp_f32 v23, v23
    v_exp_f32 v24, v24
    v_exp_f32 v25, v25
    v_exp_f32 v26, v26
    v_smfmac_f32_32x32x32_bf16 v[224:239], v[80:83], v[16:23], v96
    s_add_u32 s66, s16, 65536
    s_addc_u32 s67, s13, 0
    v_exp_f32 v27, v27
    v_exp_f32 v28, v28
    v_exp_f32 v29, v29
    v_exp_f32 v30, v30
    v_exp_f32 v31, v31
    v_exp_f32 v32, v32
    v_exp_f32 v33, v33
    v_exp_f32 v34, v34
    v_smfmac_f32_32x32x32_bf16 v[224:239], v[88:91], v[24:31], v96
    s_waitcnt lgkmcnt(2)
    v_exp_f32 v35, v35
    v_exp_f32 v36, v36
    v_exp_f32 v37, v37
    v_mfma_f32_32x32x16_bf16 v[16:31], v[76:79], v[116:119], 0
    s_add_u32 m0, s83, 16384
    ds_read_b128 v[72:75], v127 offset:30720
    global_load_lds_dwordx4 v1, s[66:67] offset:0 sc1
    global_load_lds_dwordx4 v1, s[66:67] offset:1024 sc1
    v_exp_f32 v38, v38
    v_exp_f32 v39, v39
    v_exp_f32 v40, v40
    v_exp_f32 v41, v41
    v_exp_f32 v42, v42
    v_smfmac_f32_32x32x32_bf16 v[208:223], v[80:83], v[32:39], v96
    v_exp_f32 v43, v43
    v_exp_f32 v44, v44
    v_exp_f32 v45, v45
    v_exp_f32 v46, v46
    v_exp_f32 v47, v47
    v_exp_f32 v16, v16
    v_exp_f32 v17, v17
    v_exp_f32 v18, v18
    v_smfmac_f32_32x32x32_bf16 v[208:223], v[88:91], v[40:47], v96
    s_waitcnt lgkmcnt(1)
    v_exp_f32 v19, v19
    v_exp_f32 v20, v20
    v_exp_f32 v21, v21
    v_mfma_f32_32x32x16_bf16 v[32:47], v[76:79], v[112:115], 0
    ds_read_b128 v[80:83], v97 offset:6144
    ds_read_b128 v[88:91], v97 offset:6656
    global_load_lds_dwordx4 v1, s[66:67] offset:2048 sc1
    global_load_lds_dwordx4 v1, s[66:67] offset:3072 sc1
    v_exp_f32 v22, v22
    v_exp_f32 v23, v23
    v_exp_f32 v24, v24
    v_exp_f32 v25, v25
    v_exp_f32 v26, v26
    v_smfmac_f32_32x32x32_bf16 v[224:239], v[84:87], v[16:23], v96
    s_add_u32 s66, s16, 69632
    s_addc_u32 s67, s13, 0
    v_exp_f32 v27, v27
    v_exp_f32 v28, v28
    v_exp_f32 v29, v29
    v_exp_f32 v30, v30
    v_exp_f32 v31, v31
    v_exp_f32 v32, v32
    v_exp_f32 v33, v33
    v_exp_f32 v34, v34
    v_smfmac_f32_32x32x32_bf16 v[224:239], v[92:95], v[24:31], v96
    s_waitcnt lgkmcnt(2)
    v_exp_f32 v35, v35
    v_exp_f32 v36, v36
    v_exp_f32 v37, v37
    v_mfma_f32_32x32x16_bf16 v[16:31], v[72:75], v[116:119], 0
    s_add_u32 m0, s83, 20480
    ds_read_b128 v[76:79], v127 offset:31744
    global_load_lds_dwordx4 v1, s[66:67] offset:0 sc1
    global_load_lds_dwordx4 v1, s[66:67] offset:1024 sc1
    v_exp_f32 v38, v38
    v_exp_f32 v39, v39
    v_exp_f32 v40, v40
    v_exp_f32 v41, v41
    v_exp_f32 v42, v42
    v_smfmac_f32_32x32x32_bf16 v[208:223], v[84:87], v[32:39], v96
    v_exp_f32 v43, v43
    v_exp_f32 v44, v44
    v_exp_f32 v45, v45
    v_exp_f32 v46, v46
    v_exp_f32 v47, v47
    v_exp_f32 v16, v16
    v_exp_f32 v17, v17
    v_exp_f32 v18, v18
    v_smfmac_f32_32x32x32_bf16 v[208:223], v[92:95], v[40:47], v96
    s_waitcnt lgkmcnt(1)
    v_exp_f32 v19, v19
    v_exp_f32 v20, v20
    v_exp_f32 v21, v21
    v_mfma_f32_32x32x16_bf16 v[32:47], v[72:75], v[112:115], 0
    ds_read_b128 v[84:87], v97 offset:7168
    ds_read_b128 v[92:95], v97 offset:7680
    global_load_lds_dwordx4 v1, s[66:67] offset:2048 sc1
    global_load_lds_dwordx4 v1, s[66:67] offset:3072 sc1
    v_exp_f32 v22, v22
    v_exp_f32 v23, v23
    v_exp_f32 v24, v24
    v_exp_f32 v25, v25
    v_exp_f32 v26, v26
    v_smfmac_f32_32x32x32_bf16 v[224:239], v[80:83], v[16:23], v96
    v_exp_f32 v27, v27
    v_exp_f32 v28, v28
    v_exp_f32 v29, v29
    v_exp_f32 v30, v30
    v_exp_f32 v31, v31
    v_exp_f32 v32, v32
    v_exp_f32 v33, v33
    v_exp_f32 v34, v34
    v_smfmac_f32_32x32x32_bf16 v[224:239], v[88:91], v[24:31], v96
    s_waitcnt lgkmcnt(2)
    v_exp_f32 v35, v35
    v_exp_f32 v36, v36
    v_exp_f32 v37, v37
    v_mfma_f32_32x32x16_bf16 v[16:31], v[76:79], v[116:119], 0
    v_exp_f32 v38, v38
    v_exp_f32 v39, v39
    v_exp_f32 v40, v40
    v_exp_f32 v41, v41
    v_exp_f32 v42, v42
    v_smfmac_f32_32x32x32_bf16 v[208:223], v[80:83], v[32:39], v96
    v_exp_f32 v43, v43
    v_exp_f32 v44, v44
    v_exp_f32 v45, v45
    v_exp_f32 v46, v46
    v_exp_f32 v47, v47
    s_nop 0
    v_exp_f32 v16, v16
    v_exp_f32 v17, v17
    v_exp_f32 v18, v18
    v_smfmac_f32_32x32x32_bf16 v[208:223], v[88:91], v[40:47], v96
    s_waitcnt lgkmcnt(0)
    v_exp_f32 v19, v19
    v_exp_f32 v20, v20
    v_exp_f32 v21, v21
    v_mfma_f32_32x32x16_bf16 v[32:47], v[76:79], v[112:115], 0
    v_exp_f32 v22, v22
    v_exp_f32 v23, v23
    v_exp_f32 v24, v24
    v_exp_f32 v25, v25
    v_exp_f32 v26, v26
    v_smfmac_f32_32x32x32_bf16 v[224:239], v[84:87], v[16:23], v96
    v_exp_f32 v27, v27
    v_exp_f32 v28, v28
    v_exp_f32 v29, v29
    v_exp_f32 v30, v30
    v_exp_f32 v31, v31
    s_nop 0
    v_exp_f32 v32, v32
    v_exp_f32 v33, v33
    v_exp_f32 v34, v34
    v_smfmac_f32_32x32x32_bf16 v[224:239], v[92:95], v[24:31], v96
    v_exp_f32 v35, v35
    v_exp_f32 v36, v36
    v_exp_f32 v37, v37
    v_exp_f32 v38, v38
    v_exp_f32 v39, v39
    v_exp_f32 v40, v40
    v_exp_f32 v41, v41
    v_exp_f32 v42, v42
    v_smfmac_f32_32x32x32_bf16 v[208:223], v[84:87], v[32:39], v96
    s_nop 2
    ds_write_b128 v108, v[224:227]
    ds_write_b128 v108, v[228:231] offset:1024
    ds_write_b32 v108, v232 offset:2048
    v_exp_f32 v43, v43
    v_exp_f32 v44, v44
    v_exp_f32 v45, v45
    v_exp_f32 v46, v46
    v_exp_f32 v47, v47
    s_waitcnt lgkmcnt(0)
    s_nop 0
    v_smfmac_f32_32x32x32_bf16 v[208:223], v[92:95], v[40:47], v96
    s_barrier
    ds_read_b128 v[240:243], v109
    ds_read_b128 v[244:247], v109 offset:1024
    ds_read_b32 v248, v109 offset:2048
    v_bfe_u32 v5, v0, 3, 1
    v_cmp_eq_u32 s[84:85], 0, v5
    s_waitcnt lgkmcnt(0)
    s_nop 4
    v_add_f32 v216, v216, v248
    v_add_f32 v208, v208, v240
    v_fma_f32 v4, v208, 0, v216
    v_add_f32 v209, v209, v241
    v_fma_f32 v4, v209, 0, v4
    v_add_f32 v210, v210, v242
    v_fma_f32 v4, v210, 0, v4
    v_add_f32 v211, v211, v243
    v_fma_f32 v4, v211, 0, v4
    v_add_f32 v212, v212, v244
    v_fma_f32 v4, v212, 0, v4
    v_add_f32 v213, v213, v245
    v_fma_f32 v4, v213, 0, v4
    v_add_f32 v214, v214, v246
    v_fma_f32 v4, v214, 0, v4
    v_add_f32 v215, v215, v247
    v_fma_f32 v4, v215, 0, v4
    v_add_u32 v4, 0xde800000, v4
    v_cmp_lt_u32 vcc, 0x3c000000, v4
    s_cbranch_vccnz L_FB1
L_FBR1:
    v_rcp_f32 v4, v216
    s_nop 0
    v_mul_f32 v208, v4, v208
    v_mul_f32 v209, v4, v209
    v_mul_f32 v210, v4, v210
    v_mul_f32 v211, v4, v211
    v_mul_f32 v212, v4, v212
    v_mul_f32 v213, v4, v213
    v_mul_f32 v214, v4, v214
    v_mul_f32 v215, v4, v215
    v_cvt_pk_bf16_f32 v8, v208, v209
    v_cvt_pk_bf16_f32 v9, v210, v211
    v_cvt_pk_bf16_f32 v10, v212, v213
    v_cvt_pk_bf16_f32 v11, v214, v215
    ds_write_b128 v120, v[8:11] offset:4096
    v_and_b32 v6, 7, v0
    s_lshl_b32 s76, s3, 3
    s_add_u32 s76, s76, 163584
    v_lshl_add_u32 v13, v6, 5, s76
    v_lshlrev_b32 v6, 5, v6
    v_add_u32 v14, 163584, v6
    s_waitcnt lgkmcnt(0)
    s_waitcnt vmcnt(38)
    s_barrier
    ds_read_b128 v[208:211], v99 offset:4096
    ds_read_b128 v[212:215], v99 offset:4608
    ds_read_b128 v[216:219], v99 offset:5120
    ds_read_b128 v[220:223], v99 offset:5632
    ds_read_b128 v[224:227], v99 offset:6144
    ds_read_b128 v[228:231], v99 offset:6656
    ds_read_b128 v[232:235], v99 offset:7168
    ds_read_b128 v[236:239], v99 offset:7680
    s_waitcnt lgkmcnt(7)
    v_mfma_f32_16x16x32_bf16 v[176:179], a[0:3], v[208:211], v[176:179]
    v_mfma_f32_16x16x32_bf16 v[192:195], a[16:19], v[208:211], v[192:195]
    s_add_u32 m0, s83, 24576
    s_add_u32 s66, s16, 98304
    s_addc_u32 s67, s13, 0
    global_load_lds_dwordx4 v1, s[66:67] offset:0 sc1
    v_mfma_f32_16x16x32_bf16 v[180:183], a[4:7], v[208:211], v[180:183]
    v_mfma_f32_16x16x32_bf16 v[196:199], a[20:23], v[208:211], v[196:199]
    s_waitcnt lgkmcnt(6)
    v_mfma_f32_16x16x32_bf16 v[176:179], a[32:35], v[212:215], v[176:179]
    v_mfma_f32_16x16x32_bf16 v[192:195], a[48:51], v[212:215], v[192:195]
    v_mfma_f32_16x16x32_bf16 v[180:183], a[36:39], v[212:215], v[180:183]
    global_load_lds_dwordx4 v1, s[66:67] offset:1024 sc1
    v_mfma_f32_16x16x32_bf16 v[196:199], a[52:55], v[212:215], v[196:199]
    s_waitcnt lgkmcnt(5)
    v_mfma_f32_16x16x32_bf16 v[176:179], a[64:67], v[216:219], v[176:179]
    v_mfma_f32_16x16x32_bf16 v[192:195], a[80:83], v[216:219], v[192:195]
    v_mfma_f32_16x16x32_bf16 v[180:183], a[68:71], v[216:219], v[180:183]
    v_mfma_f32_16x16x32_bf16 v[196:199], a[84:87], v[216:219], v[196:199]
    global_load_lds_dwordx4 v1, s[66:67] offset:2048 sc1
    s_waitcnt lgkmcnt(4)
    v_mfma_f32_16x16x32_bf16 v[176:179], a[96:99], v[220:223], v[176:179]
    v_mfma_f32_16x16x32_bf16 v[192:195], a[112:115], v[220:223], v[192:195]
    v_mfma_f32_16x16x32_bf16 v[180:183], a[100:103], v[220:223], v[180:183]
    v_mfma_f32_16x16x32_bf16 v[196:199], a[116:119], v[220:223], v[196:199]
    s_waitcnt lgkmcnt(3)
    v_mfma_f32_16x16x32_bf16 v[176:179], a[128:131], v[224:227], v[176:179]
    global_load_lds_dwordx4 v1, s[66:67] offset:3072 sc1
    v_mfma_f32_16x16x32_bf16 v[192:195], a[144:147], v[224:227], v[192:195]
    v_mfma_f32_16x16x32_bf16 v[180:183], a[132:135], v[224:227], v[180:183]
    v_mfma_f32_16x16x32_bf16 v[196:199], a[148:151], v[224:227], v[196:199]
    s_waitcnt lgkmcnt(2)
    v_mfma_f32_16x16x32_bf16 v[176:179], a[160:163], v[228:231], v[176:179]
    v_mfma_f32_16x16x32_bf16 v[192:195], a[176:179], v[228:231], v[192:195]
    s_add_u32 m0, s83, 28672
    s_add_u32 s66, s16, 102400
    s_addc_u32 s67, s13, 0
    global_load_lds_dwordx4 v1, s[66:67] offset:0 sc1
    v_mfma_f32_16x16x32_bf16 v[180:183], a[164:167], v[228:231], v[180:183]
    v_mfma_f32_16x16x32_bf16 v[196:199], a[180:183], v[228:231], v[196:199]
    s_waitcnt lgkmcnt(1)
    v_mfma_f32_16x16x32_bf16 v[176:179], a[192:195], v[232:235], v[176:179]
    v_mfma_f32_16x16x32_bf16 v[192:195], a[208:211], v[232:235], v[192:195]
    v_mfma_f32_16x16x32_bf16 v[180:183], a[196:199], v[232:235], v[180:183]
    global_load_lds_dwordx4 v1, s[66:67] offset:1024 sc1
    v_mfma_f32_16x16x32_bf16 v[196:199], a[212:215], v[232:235], v[196:199]
    s_waitcnt lgkmcnt(0)
    v_mfma_f32_16x16x32_bf16 v[176:179], a[224:227], v[236:239], v[176:179]
    v_mfma_f32_16x16x32_bf16 v[192:195], a[240:243], v[236:239], v[192:195]
    v_mfma_f32_16x16x32_bf16 v[180:183], a[228:231], v[236:239], v[180:183]
    v_mfma_f32_16x16x32_bf16 v[196:199], a[244:247], v[236:239], v[196:199]
    global_load_lds_dwordx4 v1, s[66:67] offset:2048 sc1
    v_mfma_f32_16x16x32_bf16 v[184:187], a[8:11], v[208:211], v[184:187]
    v_mfma_f32_16x16x32_bf16 v[200:203], a[24:27], v[208:211], v[200:203]
    v_mfma_f32_16x16x32_bf16 v[184:187], a[40:43], v[212:215], v[184:187]
    v_mfma_f32_16x16x32_bf16 v[200:203], a[56:59], v[212:215], v[200:203]
    v_mfma_f32_16x16x32_bf16 v[184:187], a[72:75], v[216:219], v[184:187]
    global_load_lds_dwordx4 v1, s[66:67] offset:3072 sc1
    v_mfma_f32_16x16x32_bf16 v[200:203], a[88:91], v[216:219], v[200:203]
    v_cndmask_b32 v16, v192, v176, s[84:85]
    v_cndmask_b32 v17, v193, v177, s[84:85]
    v_mfma_f32_16x16x32_bf16 v[184:187], a[104:107], v[220:223], v[184:187]
    v_cndmask_b32 v18, v194, v178, s[84:85]
    v_cndmask_b32 v19, v195, v179, s[84:85]
    v_mfma_f32_16x16x32_bf16 v[200:203], a[120:123], v[220:223], v[200:203]
    v_mov_b32 v8, v16
    v_mul_f32 v9, v16, v16
    v_mfma_f32_16x16x32_bf16 v[184:187], a[136:139], v[224:227], v[184:187]
    v_add_f32 v8, v8, v17
    v_fmac_f32 v9, v17, v17
    v_mfma_f32_16x16x32_bf16 v[200:203], a[152:155], v[224:227], v[200:203]
    s_add_u32 s94, s20, 12288
    buffer_load_dwordx4 a[56:59], v1, s[48:51], s94 offen offset:2048 sc1
    v_mfma_f32_16x16x32_bf16 v[184:187], a[168:171], v[228:231], v[184:187]
    v_add_f32 v8, v8, v18
    v_fmac_f32 v9, v18, v18
    v_mfma_f32_16x16x32_bf16 v[200:203], a[184:187], v[228:231], v[200:203]
    v_add_f32 v8, v8, v19
    v_fmac_f32 v9, v19, v19
    v_mfma_f32_16x16x32_bf16 v[184:187], a[200:203], v[232:235], v[184:187]
    v_cvt_pk_bf16_f32 v32, v16, v17
    v_cvt_pk_bf16_f32 v33, v18, v19
    v_mfma_f32_16x16x32_bf16 v[200:203], a[216:219], v[232:235], v[200:203]
    v_cndmask_b32 v20, v196, v180, s[84:85]
    v_cndmask_b32 v21, v197, v181, s[84:85]
    v_mfma_f32_16x16x32_bf16 v[184:187], a[232:235], v[236:239], v[184:187]
    v_mfma_f32_16x16x32_bf16 v[200:203], a[248:251], v[236:239], v[200:203]
    v_cndmask_b32 v22, v198, v182, s[84:85]
    v_cndmask_b32 v23, v199, v183, s[84:85]
    v_mfma_f32_16x16x32_bf16 v[188:191], a[12:15], v[208:211], v[188:191]
    v_mfma_f32_16x16x32_bf16 v[204:207], a[28:31], v[208:211], v[204:207]
    v_mfma_f32_16x16x32_bf16 v[188:191], a[44:47], v[212:215], v[188:191]
    v_mfma_f32_16x16x32_bf16 v[204:207], a[60:63], v[212:215], v[204:207]
    v_mfma_f32_16x16x32_bf16 v[188:191], a[76:79], v[216:219], v[188:191]
    v_add_f32 v8, v8, v20
    v_fmac_f32 v9, v20, v20
    v_mfma_f32_16x16x32_bf16 v[204:207], a[92:95], v[216:219], v[204:207]
    v_add_f32 v8, v8, v21
    v_fmac_f32 v9, v21, v21
    v_mfma_f32_16x16x32_bf16 v[188:191], a[108:111], v[220:223], v[188:191]
    v_add_f32 v8, v8, v22
    v_fmac_f32 v9, v22, v22
    v_mfma_f32_16x16x32_bf16 v[204:207], a[124:127], v[220:223], v[204:207]
    v_add_f32 v8, v8, v23
    v_fmac_f32 v9, v23, v23
    v_mfma_f32_16x16x32_bf16 v[188:191], a[140:143], v[224:227], v[188:191]
    buffer_load_dwordx4 a[60:63], v1, s[48:51], s94 offen offset:3072 sc1
    v_mfma_f32_16x16x32_bf16 v[204:207], a[156:159], v[224:227], v[204:207]
    v_cvt_pk_bf16_f32 v34, v20, v21
    v_cvt_pk_bf16_f32 v35, v22, v23
    v_mfma_f32_16x16x32_bf16 v[188:191], a[172:175], v[228:231], v[188:191]
    v_cndmask_b32 v24, v200, v184, s[84:85]
    v_cndmask_b32 v25, v201, v185, s[84:85]
    v_mfma_f32_16x16x32_bf16 v[204:207], a[188:191], v[228:231], v[204:207]
    v_cndmask_b32 v26, v202, v186, s[84:85]
    v_cndmask_b32 v27, v203, v187, s[84:85]
    v_mfma_f32_16x16x32_bf16 v[188:191], a[204:207], v[232:235], v[188:191]
    v_add_f32 v8, v8, v24
    v_fmac_f32 v9, v24, v24
    v_mfma_f32_16x16x32_bf16 v[204:207], a[220:223], v[232:235], v[204:207]
    v_add_f32 v8, v8, v25
    v_fmac_f32 v9, v25, v25
    v_mfma_f32_16x16x32_bf16 v[188:191], a[236:239], v[236:239], v[188:191]
    v_add_f32 v8, v8, v26
    v_fmac_f32 v9, v26, v26
    v_mfma_f32_16x16x32_bf16 v[204:207], a[252:255], v[236:239], v[204:207]
    v_add_f32 v8, v8, v27
    v_fmac_f32 v9, v27, v27
    v_cvt_pk_bf16_f32 v36, v24, v25
    v_cvt_pk_bf16_f32 v37, v26, v27
    s_nop 3
    v_cndmask_b32 v28, v204, v188, s[84:85]
    v_cndmask_b32 v29, v205, v189, s[84:85]
    v_cndmask_b32 v30, v206, v190, s[84:85]
    v_cndmask_b32 v31, v207, v191, s[84:85]
    v_add_f32 v8, v8, v28
    v_fmac_f32 v9, v28, v28
    v_add_f32 v8, v8, v29
    v_fmac_f32 v9, v29, v29
    v_add_f32 v8, v8, v30
    v_fmac_f32 v9, v30, v30
    v_add_f32 v8, v8, v31
    v_fmac_f32 v9, v31, v31
    s_nop 0
    v_add_f32_dpp v8, v8, v8 row_ror:8 row_mask:0xf bank_mask:0xf
    v_add_f32_dpp v9, v9, v9 row_ror:8 row_mask:0xf bank_mask:0xf
    v_mov_b32 v10, v8
    v_mov_b32 v11, v9
    s_nop 0
    v_permlane16_swap_b32 v8, v10
    v_permlane16_swap_b32 v9, v11
    v_add_f32 v8, v8, v10
    v_add_f32 v9, v9, v11
    v_mov_b32 v10, v8
    v_mov_b32 v11, v9
    s_nop 0
    v_permlane32_swap_b32 v8, v10
    v_permlane32_swap_b32 v9, v11
    v_add_f32 v8, v8, v10
    v_add_f32 v9, v9, v11
    s_mov_b64 exec, 0xff
    ds_write_b64 v13, v[8:9]
    s_mov_b64 exec, -1
    v_cvt_pk_bf16_f32 v38, v28, v29
    v_cvt_pk_bf16_f32 v39, v30, v31
    s_mov_b32 s77, 0x300000
    buffer_store_dwordx4 v[32:35], v122, s[44:47], s77 offen sc1
    buffer_store_dwordx4 v[36:39], v122, s[44:47], s77 offen offset:2048 sc1
    s_waitcnt lgkmcnt(0)
    s_barrier
    ds_read_b128 v[40:43], v14
    ds_read_b128 v[44:47], v14 offset:16
    s_mov_b32 s77, 0x3b000000
    s_waitcnt lgkmcnt(0)
    v_add_f32 v8, v40, v42
    v_add_f32 v9, v41, v43
    v_add_f32 v10, v44, v46
    v_add_f32 v11, v45, v47
    v_add_f32 v8, v8, v10
    v_add_f32 v9, v9, v11
    v_mul_f32 v8, s77, v8
    v_mul_f32 v9, s77, v9
    v_fma_f32 v9, -v8, v8, v9
    v_max_f32 v9, 0, v9
    v_add_f32 v9, 0x3727c5ac, v9
    v_rsq_f32 v9, v9
    s_mov_b32 s77, 0x500000
    v_mul_f32 v8, v8, v9
    v_fma_f32 v16, v16, v9, -v8
    v_fma_f32 v17, v17, v9, -v8
    v_cvt_pk_bf16_f32 v40, v16, v17
    v_fma_f32 v18, v18, v9, -v8
    v_fma_f32 v19, v19, v9, -v8
    v_cvt_pk_bf16_f32 v41, v18, v19
    v_fma_f32 v20, v20, v9, -v8
    v_fma_f32 v21, v21, v9, -v8
    v_cvt_pk_bf16_f32 v42, v20, v21
    v_fma_f32 v22, v22, v9, -v8
    v_fma_f32 v23, v23, v9, -v8
    v_cvt_pk_bf16_f32 v43, v22, v23
    buffer_store_dwordx4 v[40:43], v122, s[44:47], s77 offen sc1
    v_fma_f32 v24, v24, v9, -v8
    v_fma_f32 v25, v25, v9, -v8
    v_cvt_pk_bf16_f32 v44, v24, v25
    v_fma_f32 v26, v26, v9, -v8
    v_fma_f32 v27, v27, v9, -v8
    v_cvt_pk_bf16_f32 v45, v26, v27
    v_fma_f32 v28, v28, v9, -v8
    v_fma_f32 v29, v29, v9, -v8
    v_cvt_pk_bf16_f32 v46, v28, v29
    v_fma_f32 v30, v30, v9, -v8
    v_fma_f32 v31, v31, v9, -v8
    v_cvt_pk_bf16_f32 v47, v30, v31
    buffer_store_dwordx4 v[44:47], v122, s[44:47], s77 offen offset:2048 sc1
    s_lshl_b32 m0, s3, 13
    s_add_u32 m0, m0, 131072
    s_add_u32 s66, s16, 131072
    s_addc_u32 s67, s13, 0
    global_load_lds_dwordx4 v1, s[66:67] offset:0 sc1
    global_load_lds_dwordx4 v1, s[66:67] offset:1024 sc1
    global_load_lds_dwordx4 v1, s[66:67] offset:2048 sc1
    global_load_lds_dwordx4 v1, s[66:67] offset:3072 sc1
    s_lshl_b32 m0, s3, 13
    s_add_u32 m0, m0, 135168
    s_add_u32 s66, s16, 135168
    s_addc_u32 s67, s13, 0
    global_load_lds_dwordx4 v1, s[66:67] offset:0 sc1
    global_load_lds_dwordx4 v1, s[66:67] offset:1024 sc1
    global_load_lds_dwordx4 v1, s[66:67] offset:2048 sc1
    v_and_b32 v5, 15, v0
    v_bfe_u32 v6, v0, 4, 2
    v_lshlrev_b32 v5, 4, v5
    v_lshl_add_u32 v13, v6, 9, v5
    v_lshrrev_b32 v6, 1, v6
    v_mul_u32_u24 v6, 6144, v6
    v_add_u32 v15, v6, v13
    v_and_b32 v7, 3, v0
    s_lshl_b32 s76, s71, 2
    s_add_u32 s76, s76, s3
    s_lshl_b32 s77, s76, 2
    s_lshl_b32 s18, s77, 7
    s_add_u32 s18, s18, 0x288000
    v_add_u32 v9, 0x10000, v1
    v_add_u32 v10, 0x20000, v1
    s_mul_i32 s78, s76, 112
    s_mul_i32 s77, s72, 7
    s_add_u32 s78, s78, s77
    s_lshl_b32 s78, s78, 10
    s_add_u32 s78, s78, 0x700000
    v_add_u32 v8, s78, v1
    s_lshl_b32 s76, s76, 15
    s_add_u32 s76, s76, 0x500000
    s_lshr_b32 s77, s68, 1
    s_lshl_b32 s77, s77, 2
    s_add_u32 s77, s77, s3
    s_lshl_b32 s77, s77, 2
    v_add_u32 v7, s77, v7
    v_lshlrev_b32 v7, 7, v7
    v_add_u32 v12, 0x2b0000, v7
    s_lshl_b32 s99, s77, 7
    s_add_u32 s99, s99, 0x290000
    s_waitcnt vmcnt(7)
    s_barrier
    s_cmp_lg_u32 s3, 0
    s_cbranch_scc1 L_pub_28
    s_lshl_b32 s82, s70, 7
    s_add_u32 s82, s82, 0x288000
    v_mov_b32 v4, 0
    s_mov_b64 exec, 1
    buffer_store_dword v2, v4, s[44:47], s82 offen sc1
    s_mov_b64 exec, -1
L_pub_28:
    global_load_lds_dwordx4 v1, s[66:67] offset:3072 sc1
    s_add_u32 s94, s94, 4096
    buffer_load_dwordx4 a[64:67], v1, s[48:51], s94 offen offset:0 sc1
    v_accvgpr_write_b32 a0, v48
    v_accvgpr_write_b32 a1, v49
    v_accvgpr_write_b32 a2, v50
    v_accvgpr_write_b32 a3, v51
    v_accvgpr_write_b32 a4, v52
    v_accvgpr_write_b32 a5, v53
    buffer_load_dwordx4 a[68:71], v1, s[48:51], s94 offen offset:1024 sc1
    v_accvgpr_write_b32 a6, v54
    v_accvgpr_write_b32 a7, v55
    v_accvgpr_write_b32 a8, v56
    v_accvgpr_write_b32 a9, v57
    v_accvgpr_write_b32 a10, v58
    v_accvgpr_write_b32 a11, v59
    buffer_load_dwordx4 a[72:75], v1, s[48:51], s94 offen offset:2048 sc1
    v_accvgpr_write_b32 a12, v60
    v_accvgpr_write_b32 a13, v61
    v_accvgpr_write_b32 a14, v62
    v_accvgpr_write_b32 a15, v63
    v_accvgpr_write_b32 a16, v160
    v_accvgpr_write_b32 a17, v161
    buffer_load_dwordx4 a[76:79], v1, s[48:51], s94 offen offset:3072 sc1
    v_accvgpr_write_b32 a18, v162
    v_accvgpr_write_b32 a19, v163
    v_accvgpr_write_b32 a20, v164
    v_accvgpr_write_b32 a21, v165
    v_accvgpr_write_b32 a22, v166
    v_accvgpr_write_b32 a23, v167
    s_add_u32 s94, s94, 4096
    buffer_load_dwordx4 a[80:83], v1, s[48:51], s94 offen offset:0 sc1
    v_accvgpr_write_b32 a24, v168
    v_accvgpr_write_b32 a25, v169
    v_accvgpr_write_b32 a26, v170
    v_accvgpr_write_b32 a27, v171
    v_accvgpr_write_b32 a28, v172
    v_accvgpr_write_b32 a29, v173
    s_buffer_load_dword s56, s[44:47], s18 offset:0 glc
    s_buffer_load_dword s57, s[44:47], s18 offset:128 glc
    s_buffer_load_dword s58, s[44:47], s18 offset:256 glc
    s_buffer_load_dword s59, s[44:47], s18 offset:384 glc
    buffer_load_dwordx4 a[84:87], v1, s[48:51], s94 offen offset:1024 sc1
    v_accvgpr_write_b32 a30, v174
    v_accvgpr_write_b32 a31, v175
    v_accvgpr_write_b32 a32, v136
    v_accvgpr_write_b32 a33, v137
    v_accvgpr_write_b32 a34, v138
    v_accvgpr_write_b32 a35, v139
    buffer_load_dwordx4 a[88:91], v1, s[48:51], s94 offen offset:2048 sc1
    v_accvgpr_write_b32 a36, v140
    v_accvgpr_write_b32 a37, v141
    v_accvgpr_write_b32 a38, v142
    v_accvgpr_write_b32 a39, v143
    v_accvgpr_write_b32 a40, v144
    v_accvgpr_write_b32 a41, v145
    buffer_load_dwordx4 a[92:95], v1, s[48:51], s94 offen offset:3072 sc1
    v_accvgpr_write_b32 a42, v146
    v_accvgpr_write_b32 a43, v147
    v_accvgpr_write_b32 a44, v148
    v_accvgpr_write_b32 a45, v149
    v_accvgpr_write_b32 a46, v150
    v_accvgpr_write_b32 a47, v151
    s_add_u32 s94, s94, 4096
    buffer_load_dwordx4 a[96:99], v1, s[48:51], s94 offen offset:0 sc1
    v_accvgpr_write_b32 a48, v64
    v_accvgpr_write_b32 a49, v65
    v_accvgpr_write_b32 a50, v66
    v_accvgpr_write_b32 a51, v67
    v_accvgpr_write_b32 a52, v68
    v_accvgpr_write_b32 a53, v69
    buffer_load_dwordx4 a[100:103], v1, s[48:51], s94 offen offset:1024 sc1
    v_accvgpr_write_b32 a54, v70
    v_accvgpr_write_b32 a55, v71
    s_mov_b32 s82, 200000
    s_branch L_spc_s2_31
L_sp_s2_29:
    s_buffer_load_dword s56, s[44:47], s18 offset:0 glc
    s_buffer_load_dword s57, s[44:47], s18 offset:128 glc
    s_buffer_load_dword s58, s[44:47], s18 offset:256 glc
    s_buffer_load_dword s59, s[44:47], s18 offset:384 glc
    s_sub_u32 s82, s82, 1
    s_cbranch_scc1 L_TIMEOUT
L_spc_s2_31:
    s_waitcnt lgkmcnt(0)
    s_xor_b32 s56, s56, s7
    s_xor_b32 s57, s57, s7
    s_xor_b32 s58, s58, s7
    s_xor_b32 s59, s59, s7
    s_or_b32 s56, s56, s58
    s_or_b32 s57, s57, s59
    s_or_b32 s56, s56, s57
    s_cbranch_scc1 L_sp_s2_29
    buffer_load_dwordx4 v[160:163], v13, s[44:47], s76 offen offset:0 sc1
    buffer_load_dwordx4 v[164:167], v13, s[44:47], s76 offen offset:256 sc1
    buffer_load_dwordx4 v[168:171], v13, s[44:47], s76 offen offset:2048 sc1
    buffer_load_dwordx4 v[172:175], v13, s[44:47], s76 offen offset:2304 sc1
    s_add_u32 s76, s76, 4096
    buffer_load_dwordx4 v[176:179], v13, s[44:47], s76 offen offset:0 sc1
    buffer_load_dwordx4 v[180:183], v13, s[44:47], s76 offen offset:256 sc1
    buffer_load_dwordx4 v[184:187], v13, s[44:47], s76 offen offset:2048 sc1
    buffer_load_dwordx4 v[188:191], v13, s[44:47], s76 offen offset:2304 sc1
    s_add_u32 s76, s76, 4096
    buffer_load_dwordx4 v[192:195], v13, s[44:47], s76 offen offset:0 sc1
    buffer_load_dwordx4 v[196:199], v13, s[44:47], s76 offen offset:256 sc1
    s_mov_b32 s77, 0
    ds_read_b128 v[80:83], v1 offset:0
    ds_read_b128 v[84:87], v1 offset:1024
    ds_read_b128 v[88:91], v1 offset:8192
    ds_read_b128 v[92:95], v1 offset:9216
    s_waitcnt vmcnt(8)
    s_waitcnt lgkmcnt(3)
    v_mfma_f32_16x16x32_bf16 v[16:19], v[80:83], v[160:163], 0
    ds_read_b128 v[96:99], v1 offset:16384
    v_mfma_f32_16x16x32_bf16 v[20:23], v[80:83], v[164:167], 0
    s_waitcnt lgkmcnt(3)
    buffer_load_dwordx4 v[200:203], v13, s[44:47], s76 offen offset:2048 sc1
    v_mfma_f32_16x16x32_bf16 v[24:27], v[84:87], v[160:163], 0
    ds_read_b128 v[80:83], v1 offset:17408
    v_mfma_f32_16x16x32_bf16 v[28:31], v[84:87], v[164:167], 0
    s_waitcnt lgkmcnt(3)
    v_mfma_f32_16x16x32_bf16 v[32:35], v[88:91], v[160:163], 0
    ds_read_b128 v[84:87], v1 offset:2048
    v_mfma_f32_16x16x32_bf16 v[36:39], v[88:91], v[164:167], 0
    s_waitcnt lgkmcnt(3)
    buffer_load_dwordx4 v[204:207], v13, s[44:47], s76 offen offset:2304 sc1
    v_mfma_f32_16x16x32_bf16 v[40:43], v[92:95], v[160:163], 0
    ds_read_b128 v[88:91], v1 offset:3072
    v_mfma_f32_16x16x32_bf16 v[44:47], v[92:95], v[164:167], 0
    s_waitcnt lgkmcnt(3)
    v_mfma_f32_16x16x32_bf16 v[48:51], v[96:99], v[160:163], 0
    ds_read_b128 v[92:95], v1 offset:10240
    v_mfma_f32_16x16x32_bf16 v[52:55], v[96:99], v[164:167], 0
    s_waitcnt lgkmcnt(3)
    s_add_u32 s76, s76, 4096
    buffer_load_dwordx4 v[208:211], v13, s[44:47], s76 offen offset:0 sc1
    v_mfma_f32_16x16x32_bf16 v[56:59], v[80:83], v[160:163], 0
    ds_read_b128 v[96:99], v1 offset:11264
    v_mfma_f32_16x16x32_bf16 v[60:63], v[80:83], v[164:167], 0
    s_waitcnt lgkmcnt(3)
    s_waitcnt vmcnt(9)
    v_mfma_f32_16x16x32_bf16 v[16:19], v[84:87], v[168:171], v[16:19]
    ds_read_b128 v[80:83], v1 offset:18432
    v_mfma_f32_16x16x32_bf16 v[20:23], v[84:87], v[172:175], v[20:23]
    s_waitcnt lgkmcnt(3)
    buffer_load_dwordx4 v[212:215], v13, s[44:47], s76 offen offset:256 sc1
    v_mfma_f32_16x16x32_bf16 v[24:27], v[88:91], v[168:171], v[24:27]
    ds_read_b128 v[84:87], v1 offset:19456
    v_mfma_f32_16x16x32_bf16 v[28:31], v[88:91], v[172:175], v[28:31]
    s_waitcnt lgkmcnt(3)
    v_mfma_f32_16x16x32_bf16 v[32:35], v[92:95], v[168:171], v[32:35]
    ds_read_b128 v[88:91], v1 offset:4096
    v_mfma_f32_16x16x32_bf16 v[36:39], v[92:95], v[172:175], v[36:39]
    s_waitcnt lgkmcnt(3)
    buffer_load_dwordx4 v[216:219], v13, s[44:47], s76 offen offset:2048 sc1
    v_mfma_f32_16x16x32_bf16 v[40:43], v[96:99], v[168:171], v[40:43]
    ds_read_b128 v[92:95], v1 offset:5120
    v_mfma_f32_16x16x32_bf16 v[44:47], v[96:99], v[172:175], v[44:47]
    s_waitcnt lgkmcnt(3)
    v_mfma_f32_16x16x32_bf16 v[48:51], v[80:83], v[168:171], v[48:51]
    ds_read_b128 v[96:99], v1 offset:12288
    v_mfma_f32_16x16x32_bf16 v[52:55], v[80:83], v[172:175], v[52:55]
    s_waitcnt lgkmcnt(3)
    buffer_load_dwordx4 v[220:223], v13, s[44:47], s76 offen offset:2304 sc1
    v_mfma_f32_16x16x32_bf16 v[56:59], v[84:87], v[168:171], v[56:59]
    ds_read_b128 v[80:83], v1 offset:13312
    v_mfma_f32_16x16x32_bf16 v[60:63], v[84:87], v[172:175], v[60:63]
    s_waitcnt lgkmcnt(3)
    s_waitcnt vmcnt(10)
    v_mfma_f32_16x16x32_bf16 v[16:19], v[88:91], v[176:179], v[16:19]
    ds_read_b128 v[84:87], v1 offset:20480
    v_mfma_f32_16x16x32_bf16 v[20:23], v[88:91], v[180:183], v[20:23]
    s_waitcnt lgkmcnt(3)
    s_add_u32 s76, s76, 4096
    buffer_load_dwordx4 v[224:227], v13, s[44:47], s76 offen offset:0 sc1
    v_mfma_f32_16x16x32_bf16 v[24:27], v[92:95], v[176:179], v[24:27]
    ds_read_b128 v[88:91], v1 offset:21504
    v_mfma_f32_16x16x32_bf16 v[28:31], v[92:95], v[180:183], v[28:31]
    s_waitcnt lgkmcnt(3)
    v_mfma_f32_16x16x32_bf16 v[32:35], v[96:99], v[176:179], v[32:35]
    ds_read_b128 v[92:95], v1 offset:6144
    v_mfma_f32_16x16x32_bf16 v[36:39], v[96:99], v[180:183], v[36:39]
    s_waitcnt lgkmcnt(3)
    buffer_load_dwordx4 v[228:231], v13, s[44:47], s76 offen offset:256 sc1
    v_mfma_f32_16x16x32_bf16 v[40:43], v[80:83], v[176:179], v[40:43]
    ds_read_b128 v[96:99], v1 offset:7168
    v_mfma_f32_16x16x32_bf16 v[44:47], v[80:83], v[180:183], v[44:47]
    s_waitcnt lgkmcnt(3)
    v_mfma_f32_16x16x32_bf16 v[48:51], v[84:87], v[176:179], v[48:51]
    ds_read_b128 v[80:83], v1 offset:14336
    v_mfma_f32_16x16x32_bf16 v[52:55], v[84:87], v[180:183], v[52:55]
    s_waitcnt lgkmcnt(3)
    buffer_load_dwordx4 v[232:235], v13, s[44:47], s76 offen offset:2048 sc1
    v_mfma_f32_16x16x32_bf16 v[56:59], v[88:91], v[176:179], v[56:59]
    ds_read_b128 v[84:87], v1 offset:15360
    v_mfma_f32_16x16x32_bf16 v[60:63], v[88:91], v[180:183], v[60:63]
    s_waitcnt lgkmcnt(3)
    s_waitcnt vmcnt(11)
    v_mfma_f32_16x16x32_bf16 v[16:19], v[92:95], v[184:187], v[16:19]
    ds_read_b128 v[88:91], v1 offset:22528
    v_mfma_f32_16x16x32_bf16 v[20:23], v[92:95], v[188:191], v[20:23]
    s_waitcnt lgkmcnt(3)
    buffer_load_dwordx4 v[236:239], v13, s[44:47], s76 offen offset:2304 sc1
    v_mfma_f32_16x16x32_bf16 v[24:27], v[96:99], v[184:187], v[24:27]
    ds_read_b128 v[92:95], v1 offset:23552
    v_mfma_f32_16x16x32_bf16 v[28:31], v[96:99], v[188:191], v[28:31]
    s_waitcnt lgkmcnt(3)
    v_mfma_f32_16x16x32_bf16 v[32:35], v[80:83], v[184:187], v[32:35]
    ds_read_b128 v[96:99], v1 offset:32768
    v_mfma_f32_16x16x32_bf16 v[36:39], v[80:83], v[188:191], v[36:39]
    s_waitcnt lgkmcnt(3)
    s_add_u32 s76, s76, 4096
    buffer_load_dwordx4 v[240:243], v13, s[44:47], s76 offen offset:0 sc1
    v_mfma_f32_16x16x32_bf16 v[40:43], v[84:87], v[184:187], v[40:43]
    ds_read_b128 v[80:83], v1 offset:33792
    v_mfma_f32_16x16x32_bf16 v[44:47], v[84:87], v[188:191], v[44:47]
    s_waitcnt lgkmcnt(3)
    v_mfma_f32_16x16x32_bf16 v[48:51], v[88:91], v[184:187], v[48:51]
    ds_read_b128 v[84:87], v1 offset:40960
    v_mfma_f32_16x16x32_bf16 v[52:55], v[88:91], v[188:191], v[52:55]
    s_waitcnt lgkmcnt(3)
    buffer_load_dwordx4 v[244:247], v13, s[44:47], s76 offen offset:256 sc1
    v_mfma_f32_16x16x32_bf16 v[56:59], v[92:95], v[184:187], v[56:59]
    ds_read_b128 v[88:91], v1 offset:41984
    v_mfma_f32_16x16x32_bf16 v[60:63], v[92:95], v[188:191], v[60:63]
    s_waitcnt lgkmcnt(3)
    s_waitcnt vmcnt(12)
    v_mfma_f32_16x16x32_bf16 v[16:19], v[96:99], v[192:195], v[16:19]
    ds_read_b128 v[92:95], v1 offset:49152
    v_mfma_f32_16x16x32_bf16 v[20:23], v[96:99], v[196:199], v[20:23]
    s_waitcnt lgkmcnt(3)
    buffer_load_dwordx4 v[248:251], v13, s[44:47], s76 offen offset:2048 sc1
    v_mfma_f32_16x16x32_bf16 v[24:27], v[80:83], v[192:195], v[24:27]
    ds_read_b128 v[96:99], v1 offset:50176
    v_mfma_f32_16x16x32_bf16 v[28:31], v[80:83], v[196:199], v[28:31]
    s_waitcnt lgkmcnt(3)
    v_mfma_f32_16x16x32_bf16 v[32:35], v[84:87], v[192:195], v[32:35]
    ds_read_b128 v[80:83], v1 offset:34816
    v_mfma_f32_16x16x32_bf16 v[36:39], v[84:87], v[196:199], v[36:39]
    s_waitcnt lgkmcnt(3)
    buffer_load_dwordx4 v[252:255], v13, s[44:47], s76 offen offset:2304 sc1
    v_mfma_f32_16x16x32_bf16 v[40:43], v[88:91], v[192:195], v[40:43]
    ds_read_b128 v[84:87], v1 offset:35840
    v_mfma_f32_16x16x32_bf16 v[44:47], v[88:91], v[196:199], v[44:47]
    s_waitcnt lgkmcnt(3)
    v_mfma_f32_16x16x32_bf16 v[48:51], v[92:95], v[192:195], v[48:51]
    ds_read_b128 v[88:91], v1 offset:43008
    v_mfma_f32_16x16x32_bf16 v[52:55], v[92:95], v[196:199], v[52:55]
    s_waitcnt lgkmcnt(3)
    s_add_u32 s76, s76, 4096
    buffer_load_dwordx4 a[224:227], v13, s[44:47], s76 offen offset:0 sc1
    v_mfma_f32_16x16x32_bf16 v[56:59], v[96:99], v[192:195], v[56:59]
    ds_read_b128 v[92:95], v1 offset:44032
    v_mfma_f32_16x16x32_bf16 v[60:63], v[96:99], v[196:199], v[60:63]
    s_waitcnt lgkmcnt(3)
    s_waitcnt vmcnt(13)
    v_mfma_f32_16x16x32_bf16 v[16:19], v[80:83], v[200:203], v[16:19]
    ds_read_b128 v[96:99], v1 offset:51200
    v_mfma_f32_16x16x32_bf16 v[20:23], v[80:83], v[204:207], v[20:23]
    s_waitcnt lgkmcnt(3)
    buffer_load_dwordx4 a[228:231], v13, s[44:47], s76 offen offset:256 sc1
    v_mfma_f32_16x16x32_bf16 v[24:27], v[84:87], v[200:203], v[24:27]
    ds_read_b128 v[80:83], v1 offset:52224
    v_mfma_f32_16x16x32_bf16 v[28:31], v[84:87], v[204:207], v[28:31]
    s_waitcnt lgkmcnt(3)
    v_mfma_f32_16x16x32_bf16 v[32:35], v[88:91], v[200:203], v[32:35]
    ds_read_b128 v[84:87], v1 offset:36864
    v_mfma_f32_16x16x32_bf16 v[36:39], v[88:91], v[204:207], v[36:39]
    s_waitcnt lgkmcnt(3)
    buffer_load_dwordx4 a[232:235], v13, s[44:47], s76 offen offset:2048 sc1
    v_mfma_f32_16x16x32_bf16 v[40:43], v[92:95], v[200:203], v[40:43]
    ds_read_b128 v[88:91], v1 offset:37888
    v_mfma_f32_16x16x32_bf16 v[44:47], v[92:95], v[204:207], v[44:47]
    s_waitcnt lgkmcnt(3)
    v_mfma_f32_16x16x32_bf16 v[48:51], v[96:99], v[200:203], v[48:51]
    ds_read_b128 v[92:95], v1 offset:45056
    v_mfma_f32_16x16x32_bf16 v[52:55], v[96:99], v[204:207], v[52:55]
    s_waitcnt lgkmcnt(3)
    buffer_load_dwordx4 a[236:239], v13, s[44:47], s76 offen offset:2304 sc1
    v_mfma_f32_16x16x32_bf16 v[56:59], v[80:83], v[200:203], v[56:59]
    ds_read_b128 v[96:99], v1 offset:46080
    v_mfma_f32_16x16x32_bf16 v[60:63], v[80:83], v[204:207], v[60:63]
    s_waitcnt lgkmcnt(3)
    s_waitcnt vmcnt(14)
    v_mfma_f32_16x16x32_bf16 v[16:19], v[84:87], v[208:211], v[16:19]
    ds_read_b128 v[80:83], v1 offset:53248
    v_mfma_f32_16x16x32_bf16 v[20:23], v[84:87], v[212:215], v[20:23]
    s_waitcnt lgkmcnt(3)
    s_add_u32 s76, s76, 4096
    buffer_load_dwordx4 a[240:243], v13, s[44:47], s76 offen offset:0 sc1
    v_mfma_f32_16x16x32_bf16 v[24:27], v[88:91], v[208:211], v[24:27]
    ds_read_b128 v[84:87], v1 offset:54272
    v_mfma_f32_16x16x32_bf16 v[28:31], v[88:91], v[212:215], v[28:31]
    s_waitcnt lgkmcnt(3)
    v_mfma_f32_16x16x32_bf16 v[32:35], v[92:95], v[208:211], v[32:35]
    ds_read_b128 v[88:91], v1 offset:38912
    v_mfma_f32_16x16x32_bf16 v[36:39], v[92:95], v[212:215], v[36:39]
    s_waitcnt lgkmcnt(3)
    buffer_load_dwordx4 a[244:247], v13, s[44:47], s76 offen offset:256 sc1
    v_mfma_f32_16x16x32_bf16 v[40:43], v[96:99], v[208:211], v[40:43]
    ds_read_b128 v[92:95], v1 offset:39936
    v_mfma_f32_16x16x32_bf16 v[44:47], v[96:99], v[212:215], v[44:47]
    s_waitcnt lgkmcnt(3)
    v_mfma_f32_16x16x32_bf16 v[48:51], v[80:83], v[208:211], v[48:51]
    ds_read_b128 v[96:99], v1 offset:47104
    v_mfma_f32_16x16x32_bf16 v[52:55], v[80:83], v[212:215], v[52:55]
    s_waitcnt lgkmcnt(3)
    buffer_load_dwordx4 a[248:251], v13, s[44:47], s76 offen offset:2048 sc1
    v_mfma_f32_16x16x32_bf16 v[56:59], v[84:87], v[208:211], v[56:59]
    ds_read_b128 v[80:83], v1 offset:48128
    v_mfma_f32_16x16x32_bf16 v[60:63], v[84:87], v[212:215], v[60:63]
    s_waitcnt lgkmcnt(3)
    s_waitcnt vmcnt(15)
    v_mfma_f32_16x16x32_bf16 v[16:19], v[88:91], v[216:219], v[16:19]
    ds_read_b128 v[84:87], v1 offset:55296
    v_mfma_f32_16x16x32_bf16 v[20:23], v[88:91], v[220:223], v[20:23]
    s_waitcnt lgkmcnt(3)
    buffer_load_dwordx4 a[252:255], v13, s[44:47], s76 offen offset:2304 sc1
    v_mfma_f32_16x16x32_bf16 v[24:27], v[92:95], v[216:219], v[24:27]
    ds_read_b128 v[88:91], v1 offset:56320
    v_mfma_f32_16x16x32_bf16 v[28:31], v[92:95], v[220:223], v[28:31]
    s_waitcnt lgkmcnt(3)
    v_mfma_f32_16x16x32_bf16 v[32:35], v[96:99], v[216:219], v[32:35]
    ds_read_b128 v[92:95], v9 offset:0
    v_mfma_f32_16x16x32_bf16 v[36:39], v[96:99], v[220:223], v[36:39]
    s_waitcnt lgkmcnt(3)
    v_mfma_f32_16x16x32_bf16 v[40:43], v[80:83], v[216:219], v[40:43]
    ds_read_b128 v[96:99], v9 offset:1024
    v_mfma_f32_16x16x32_bf16 v[44:47], v[80:83], v[220:223], v[44:47]
    s_waitcnt lgkmcnt(3)
    buffer_load_dwordx4 a[104:107], v1, s[48:51], s94 offen offset:2048 sc1
    v_mfma_f32_16x16x32_bf16 v[48:51], v[84:87], v[216:219], v[48:51]
    ds_read_b128 v[80:83], v9 offset:8192
    s_lshl_b32 s76, s3, 11
    v_mfma_f32_16x16x32_bf16 v[52:55], v[84:87], v[220:223], v[52:55]
    s_waitcnt lgkmcnt(3)
    v_add_u32 v153, s76, v1
    v_mfma_f32_16x16x32_bf16 v[56:59], v[88:91], v[216:219], v[56:59]
    ds_read_b128 v[84:87], v9 offset:9216
    s_lshl_b32 s76, s3, 13
    v_mfma_f32_16x16x32_bf16 v[60:63], v[88:91], v[220:223], v[60:63]
    s_waitcnt lgkmcnt(3)
    s_waitcnt vmcnt(15)
    v_add_u32 v154, s76, v1
    v_mfma_f32_16x16x32_bf16 v[16:19], v[92:95], v[224:227], v[16:19]
    ds_read_b128 v[88:91], v9 offset:16384
    s_lshl_b32 s78, s69, 2
    v_mfma_f32_16x16x32_bf16 v[20:23], v[92:95], v[228:231], v[20:23]
    s_waitcnt lgkmcnt(3)
    buffer_load_dwordx4 a[108:111], v1, s[48:51], s94 offen offset:3072 sc1
    v_mfma_f32_16x16x32_bf16 v[24:27], v[96:99], v[224:227], v[24:27]
    ds_read_b128 v[92:95], v9 offset:17408
    s_add_u32 s79, s3, s78
    v_mfma_f32_16x16x32_bf16 v[28:31], v[96:99], v[228:231], v[28:31]
    s_waitcnt lgkmcnt(3)
    s_lshl_b32 s76, s68, 16
    s_cmp_eq_u32 s6, 0
    s_cselect_b64 vcc, -1, 0
    s_cselect_b32 s78, 10, 5
    v_mfma_f32_16x16x32_bf16 v[32:35], v[80:83], v[224:227], v[32:35]
    ds_read_b128 v[96:99], v9 offset:2048
    s_lshl_b32 s79, s79, s78
    v_mfma_f32_16x16x32_bf16 v[36:39], v[80:83], v[228:231], v[36:39]
    s_waitcnt lgkmcnt(3)
    s_add_u32 s76, s76, s79
    v_mfma_f32_16x16x32_bf16 v[40:43], v[84:87], v[224:227], v[40:43]
    ds_read_b128 v[80:83], v9 offset:3072
    v_and_b32 v6, 31, v0
    v_mfma_f32_16x16x32_bf16 v[44:47], v[84:87], v[228:231], v[44:47]
    s_waitcnt lgkmcnt(3)
    s_add_u32 s94, s94, 4096
    buffer_load_dwordx4 a[112:115], v1, s[48:51], s94 offen offset:0 sc1
    v_mfma_f32_16x16x32_bf16 v[48:51], v[88:91], v[224:227], v[48:51]
    ds_read_b128 v[84:87], v9 offset:10240
    v_bfe_u32 v7, v0, 5, 1
    v_mfma_f32_16x16x32_bf16 v[52:55], v[88:91], v[228:231], v[52:55]
    s_waitcnt lgkmcnt(3)
    v_lshlrev_b32 v6, 10, v6
    v_lshl_add_u32 v6, v7, 4, v6
    v_mfma_f32_16x16x32_bf16 v[56:59], v[92:95], v[224:227], v[56:59]
    ds_read_b128 v[88:91], v9 offset:11264
    v_cndmask_b32 v6, v6, v1, vcc
    v_mfma_f32_16x16x32_bf16 v[60:63], v[92:95], v[228:231], v[60:63]
    s_waitcnt lgkmcnt(3)
    s_waitcnt vmcnt(15)
    v_add_u32 v152, s76, v6
    v_mfma_f32_16x16x32_bf16 v[16:19], v[96:99], v[232:235], v[16:19]
    ds_read_b128 v[92:95], v9 offset:18432
    v_mfma_f32_16x16x32_bf16 v[20:23], v[96:99], v[236:239], v[20:23]
    s_waitcnt lgkmcnt(3)
    buffer_load_dwordx4 a[116:119], v1, s[48:51], s94 offen offset:1024 sc1
    v_mfma_f32_16x16x32_bf16 v[24:27], v[80:83], v[232:235], v[24:27]
    ds_read_b128 v[96:99], v9 offset:19456
    v_mfma_f32_16x16x32_bf16 v[28:31], v[80:83], v[236:239], v[28:31]
    s_waitcnt lgkmcnt(3)
    v_mfma_f32_16x16x32_bf16 v[32:35], v[84:87], v[232:235], v[32:35]
    ds_read_b128 v[80:83], v9 offset:4096
    v_mfma_f32_16x16x32_bf16 v[36:39], v[84:87], v[236:239], v[36:39]
    s_waitcnt lgkmcnt(3)
    v_mfma_f32_16x16x32_bf16 v[40:43], v[88:91], v[232:235], v[40:43]
    ds_read_b128 v[84:87], v9 offset:5120
    v_mfma_f32_16x16x32_bf16 v[44:47], v[88:91], v[236:239], v[44:47]
    s_waitcnt lgkmcnt(3)
    buffer_load_dwordx4 a[120:123], v1, s[48:51], s94 offen offset:2048 sc1
    v_mfma_f32_16x16x32_bf16 v[48:51], v[92:95], v[232:235], v[48:51]
    ds_read_b128 v[88:91], v9 offset:12288
    v_and_b32 v4, 63, v0
    v_mfma_f32_16x16x32_bf16 v[52:55], v[92:95], v[236:239], v[52:55]
    s_waitcnt lgkmcnt(3)
    v_lshrrev_b32 v5, 3, v4
    v_mfma_f32_16x16x32_bf16 v[56:59], v[96:99], v[232:235], v[56:59]
    ds_read_b128 v[92:95], v9 offset:13312
    v_bfe_u32 v6, v4, 4, 1
    v_mfma_f32_16x16x32_bf16 v[60:63], v[96:99], v[236:239], v[60:63]
    s_waitcnt lgkmcnt(3)
    s_waitcnt vmcnt(15)
    v_lshlrev_b32 v6, 1, v6
    v_mfma_f32_16x16x32_bf16 v[16:19], v[80:83], v[240:243], v[16:19]
    ds_read_b128 v[96:99], v9 offset:20480
    v_and_b32 v4, 7, v4
    v_mfma_f32_16x16x32_bf16 v[20:23], v[80:83], v[244:247], v[20:23]
    s_waitcnt lgkmcnt(3)
    buffer_load_dwordx4 a[124:127], v1, s[48:51], s94 offen offset:3072 sc1
    v_mfma_f32_16x16x32_bf16 v[24:27], v[84:87], v[240:243], v[24:27]
    ds_read_b128 v[80:83], v9 offset:21504
    v_xor_b32 v4, v4, v6
    v_mfma_f32_16x16x32_bf16 v[28:31], v[84:87], v[244:247], v[28:31]
    s_waitcnt lgkmcnt(3)
    v_lshlrev_b32 v4, 4, v4
    v_lshl_add_u32 v11, v5, 10, v4
    v_mfma_f32_16x16x32_bf16 v[32:35], v[88:91], v[240:243], v[32:35]
    ds_read_b128 v[84:87], v9 offset:6144
    v_xor_b32 v155, 64, v11
    v_mfma_f32_16x16x32_bf16 v[36:39], v[88:91], v[244:247], v[36:39]
    s_waitcnt lgkmcnt(3)
    s_lshl_b32 s90, s3, 15
    v_mfma_f32_16x16x32_bf16 v[40:43], v[92:95], v[240:243], v[40:43]
    ds_read_b128 v[88:91], v9 offset:7168
    s_lshl_b32 s91, s69, 7
    v_mfma_f32_16x16x32_bf16 v[44:47], v[92:95], v[244:247], v[44:47]
    s_waitcnt lgkmcnt(3)
    s_add_u32 s94, s94, 4096
    buffer_load_dwordx4 a[128:131], v1, s[48:51], s94 offen offset:0 sc1
    v_mfma_f32_16x16x32_bf16 v[48:51], v[96:99], v[240:243], v[48:51]
    ds_read_b128 v[92:95], v9 offset:14336
    s_add_u32 s90, s90, s91
    v_mfma_f32_16x16x32_bf16 v[52:55], v[96:99], v[244:247], v[52:55]
    s_waitcnt lgkmcnt(3)
    s_lshl_b32 s91, s3, 12
    s_add_u32 s91, s91, 65536
    v_mfma_f32_16x16x32_bf16 v[56:59], v[80:83], v[240:243], v[56:59]
    ds_read_b128 v[96:99], v9 offset:15360
    v_mfma_f32_16x16x32_bf16 v[60:63], v[80:83], v[244:247], v[60:63]
    s_waitcnt lgkmcnt(3)
    s_waitcnt vmcnt(15)
    v_mfma_f32_16x16x32_bf16 v[16:19], v[84:87], v[248:251], v[16:19]
    ds_read_b128 v[80:83], v9 offset:22528
    v_mfma_f32_16x16x32_bf16 v[20:23], v[84:87], v[252:255], v[20:23]
    s_waitcnt lgkmcnt(3)
    buffer_load_dwordx4 a[132:135], v1, s[48:51], s94 offen offset:1024 sc1
    v_mfma_f32_16x16x32_bf16 v[24:27], v[88:91], v[248:251], v[24:27]
    ds_read_b128 v[84:87], v9 offset:23552
    v_mfma_f32_16x16x32_bf16 v[28:31], v[88:91], v[252:255], v[28:31]
    s_waitcnt lgkmcnt(3)
    v_mfma_f32_16x16x32_bf16 v[32:35], v[92:95], v[248:251], v[32:35]
    ds_read_b128 v[88:91], v9 offset:32768
    v_mfma_f32_16x16x32_bf16 v[36:39], v[92:95], v[252:255], v[36:39]
    s_waitcnt lgkmcnt(3)
    v_mfma_f32_16x16x32_bf16 v[40:43], v[96:99], v[248:251], v[40:43]
    ds_read_b128 v[92:95], v9 offset:33792
    v_mfma_f32_16x16x32_bf16 v[44:47], v[96:99], v[252:255], v[44:47]
    s_waitcnt lgkmcnt(3)
    buffer_load_dwordx4 a[136:139], v1, s[48:51], s94 offen offset:2048 sc1
    v_mfma_f32_16x16x32_bf16 v[48:51], v[80:83], v[248:251], v[48:51]
    ds_read_b128 v[96:99], v9 offset:40960
    v_mfma_f32_16x16x32_bf16 v[52:55], v[80:83], v[252:255], v[52:55]
    s_waitcnt lgkmcnt(3)
    v_mfma_f32_16x16x32_bf16 v[56:59], v[84:87], v[248:251], v[56:59]
    ds_read_b128 v[80:83], v9 offset:41984
    v_mfma_f32_16x16x32_bf16 v[60:63], v[84:87], v[252:255], v[60:63]
    s_waitcnt lgkmcnt(3)
    s_waitcnt vmcnt(15)
    v_mfma_f32_16x16x32_bf16 v[16:19], v[88:91], a[224:227], v[16:19]
    ds_read_b128 v[84:87], v9 offset:49152
    v_mfma_f32_16x16x32_bf16 v[20:23], v[88:91], a[228:231], v[20:23]
    s_waitcnt lgkmcnt(3)
    buffer_load_dwordx4 a[140:143], v1, s[48:51], s94 offen offset:3072 sc1
    v_mfma_f32_16x16x32_bf16 v[24:27], v[92:95], a[224:227], v[24:27]
    ds_read_b128 v[88:91], v9 offset:50176
    v_mfma_f32_16x16x32_bf16 v[28:31], v[92:95], a[228:231], v[28:31]
    s_waitcnt lgkmcnt(3)
    v_mfma_f32_16x16x32_bf16 v[32:35], v[96:99], a[224:227], v[32:35]
    ds_read_b128 v[92:95], v9 offset:34816
    v_mfma_f32_16x16x32_bf16 v[36:39], v[96:99], a[228:231], v[36:39]
    s_waitcnt lgkmcnt(3)
    v_mfma_f32_16x16x32_bf16 v[40:43], v[80:83], a[224:227], v[40:43]
    ds_read_b128 v[96:99], v9 offset:35840
    v_mfma_f32_16x16x32_bf16 v[44:47], v[80:83], a[228:231], v[44:47]
    s_waitcnt lgkmcnt(3)
    s_add_u32 s94, s94, 4096
    buffer_load_dwordx4 a[144:147], v1, s[48:51], s94 offen offset:0 sc1
    v_mfma_f32_16x16x32_bf16 v[48:51], v[84:87], a[224:227], v[48:51]
    ds_read_b128 v[80:83], v9 offset:43008
    v_mfma_f32_16x16x32_bf16 v[52:55], v[84:87], a[228:231], v[52:55]
    s_waitcnt lgkmcnt(3)
    v_mfma_f32_16x16x32_bf16 v[56:59], v[88:91], a[224:227], v[56:59]
    ds_read_b128 v[84:87], v9 offset:44032
    v_mfma_f32_16x16x32_bf16 v[60:63], v[88:91], a[228:231], v[60:63]
    s_waitcnt lgkmcnt(3)
    s_waitcnt vmcnt(15)
    v_mfma_f32_16x16x32_bf16 v[16:19], v[92:95], a[232:235], v[16:19]
    ds_read_b128 v[88:91], v9 offset:51200
    v_mfma_f32_16x16x32_bf16 v[20:23], v[92:95], a[236:239], v[20:23]
    s_waitcnt lgkmcnt(3)
    buffer_load_dwordx4 a[148:151], v1, s[48:51], s94 offen offset:1024 sc1
    v_mfma_f32_16x16x32_bf16 v[24:27], v[96:99], a[232:235], v[24:27]
    ds_read_b128 v[92:95], v9 offset:52224
    v_mfma_f32_16x16x32_bf16 v[28:31], v[96:99], a[236:239], v[28:31]
    s_waitcnt lgkmcnt(3)
    v_mfma_f32_16x16x32_bf16 v[32:35], v[80:83], a[232:235], v[32:35]
    ds_read_b128 v[96:99], v9 offset:36864
    v_mfma_f32_16x16x32_bf16 v[36:39], v[80:83], a[236:239], v[36:39]
    s_waitcnt lgkmcnt(3)
    v_mfma_f32_16x16x32_bf16 v[40:43], v[84:87], a[232:235], v[40:43]
    ds_read_b128 v[80:83], v9 offset:37888
    v_mfma_f32_16x16x32_bf16 v[44:47], v[84:87], a[236:239], v[44:47]
    s_waitcnt lgkmcnt(3)
    buffer_load_dwordx4 a[152:155], v1, s[48:51], s94 offen offset:2048 sc1
    v_mfma_f32_16x16x32_bf16 v[48:51], v[88:91], a[232:235], v[48:51]
    ds_read_b128 v[84:87], v9 offset:45056
    s_lshl_b32 s76, s68, 6
    v_mfma_f32_16x16x32_bf16 v[52:55], v[88:91], a[236:239], v[52:55]
    s_waitcnt lgkmcnt(3)
    s_lshl_b32 s78, s69, 2
    v_mfma_f32_16x16x32_bf16 v[56:59], v[92:95], a[232:235], v[56:59]
    ds_read_b128 v[88:91], v9 offset:46080
    s_add_u32 s76, s76, s78
    v_mfma_f32_16x16x32_bf16 v[60:63], v[92:95], a[236:239], v[60:63]
    s_waitcnt lgkmcnt(3)
    s_waitcnt vmcnt(15)
    s_add_u32 s76, s76, s3
    v_mfma_f32_16x16x32_bf16 v[16:19], v[96:99], a[240:243], v[16:19]
    ds_read_b128 v[92:95], v9 offset:53248
    s_lshl_b32 s76, s76, 10
    v_mfma_f32_16x16x32_bf16 v[20:23], v[96:99], a[244:247], v[20:23]
    s_waitcnt lgkmcnt(3)
    buffer_load_dwordx4 a[156:159], v1, s[48:51], s94 offen offset:3072 sc1
    v_mfma_f32_16x16x32_bf16 v[24:27], v[80:83], a[240:243], v[24:27]
    ds_read_b128 v[96:99], v9 offset:54272
    s_add_u32 s76, s76, 0x300000
    v_mfma_f32_16x16x32_bf16 v[28:31], v[80:83], a[244:247], v[28:31]
    s_waitcnt lgkmcnt(3)
    s_add_u32 s78, s76, 32768
    v_mfma_f32_16x16x32_bf16 v[32:35], v[84:87], a[240:243], v[32:35]
    ds_read_b128 v[80:83], v9 offset:38912
    v_mfma_f32_16x16x32_bf16 v[36:39], v[84:87], a[244:247], v[36:39]
    s_waitcnt lgkmcnt(3)
    v_mfma_f32_16x16x32_bf16 v[40:43], v[88:91], a[240:243], v[40:43]
    ds_read_b128 v[84:87], v9 offset:39936
    v_mfma_f32_16x16x32_bf16 v[44:47], v[88:91], a[244:247], v[44:47]
    s_waitcnt lgkmcnt(3)
    s_add_u32 s94, s94, 4096
    buffer_load_dwordx4 a[160:163], v1, s[48:51], s94 offen offset:0 sc1
    v_mfma_f32_16x16x32_bf16 v[48:51], v[92:95], a[240:243], v[48:51]
    ds_read_b128 v[88:91], v9 offset:47104
    v_mfma_f32_16x16x32_bf16 v[52:55], v[92:95], a[244:247], v[52:55]
    s_waitcnt lgkmcnt(3)
    v_mfma_f32_16x16x32_bf16 v[56:59], v[96:99], a[240:243], v[56:59]
    ds_read_b128 v[92:95], v9 offset:48128
    v_mfma_f32_16x16x32_bf16 v[60:63], v[96:99], a[244:247], v[60:63]
    s_waitcnt lgkmcnt(3)
    s_waitcnt vmcnt(15)
    v_mfma_f32_16x16x32_bf16 v[16:19], v[80:83], a[248:251], v[16:19]
    ds_read_b128 v[96:99], v9 offset:55296
    v_mfma_f32_16x16x32_bf16 v[20:23], v[80:83], a[252:255], v[20:23]
    s_waitcnt lgkmcnt(3)
    buffer_load_dwordx4 a[164:167], v1, s[48:51], s94 offen offset:1024 sc1
    v_mfma_f32_16x16x32_bf16 v[24:27], v[84:87], a[248:251], v[24:27]
    ds_read_b128 v[80:83], v9 offset:56320
    v_mfma_f32_16x16x32_bf16 v[28:31], v[84:87], a[252:255], v[28:31]
    s_waitcnt lgkmcnt(3)
    v_mfma_f32_16x16x32_bf16 v[32:35], v[88:91], a[248:251], v[32:35]
    s_barrier
    ds_read_b128 v[84:87], v1 offset:24576
    s_mov_b32 s79, 4096
    v_mfma_f32_16x16x32_bf16 v[36:39], v[88:91], a[252:255], v[36:39]
    s_waitcnt lgkmcnt(3)
    v_mfma_f32_16x16x32_bf16 v[40:43], v[92:95], a[248:251], v[40:43]
    ds_read_b128 v[88:91], v1 offset:25600
    v_mfma_f32_16x16x32_bf16 v[44:47], v[92:95], a[252:255], v[44:47]
    s_waitcnt lgkmcnt(3)
    buffer_load_dwordx4 a[168:171], v1, s[48:51], s94 offen offset:2048 sc1
    v_mfma_f32_16x16x32_bf16 v[48:51], v[96:99], a[248:251], v[48:51]
    ds_read_b128 v[92:95], v1 offset:26624
    v_mfma_f32_16x16x32_bf16 v[52:55], v[96:99], a[252:255], v[52:55]
    s_waitcnt lgkmcnt(3)
    v_mfma_f32_16x16x32_bf16 v[56:59], v[80:83], a[248:251], v[56:59]
    ds_read_b128 v[96:99], v1 offset:27648
    v_mfma_f32_16x16x32_bf16 v[60:63], v[80:83], a[252:255], v[60:63]
    s_waitcnt lgkmcnt(3)
    v_mfma_f32_16x16x32_bf16 v[64:67], v[84:87], v[160:163], 0
    s_barrier
    ds_read_b128 v[80:83], v1 offset:28672
    v_mfma_f32_16x16x32_bf16 v[68:71], v[84:87], v[164:167], 0
    s_waitcnt lgkmcnt(3)
    v_mfma_f32_16x16x32_bf16 v[72:75], v[88:91], v[160:163], 0
    ds_read_b128 v[84:87], v1 offset:29696
    v_mfma_f32_16x16x32_bf16 v[76:79], v[88:91], v[164:167], 0
    s_waitcnt lgkmcnt(3)
    s_add_u32 m0, s83, 0
    s_add_u32 s66, s16, 163840
    s_addc_u32 s67, s13, 0
    global_load_lds_dwordx4 v1, s[66:67] offset:0 sc1
    v_mfma_f32_16x16x32_bf16 v[64:67], v[92:95], v[168:171], v[64:67]
    ds_read_b128 v[88:91], v1 offset:30720
    v_max_f32 v16, 0, v16
    v_mfma_f32_16x16x32_bf16 v[68:71], v[92:95], v[172:175], v[68:71]
    s_waitcnt lgkmcnt(3)
    v_mul_f32 v16, v16, v24
    v_max_f32 v17, 0, v17
    v_mfma_f32_16x16x32_bf16 v[72:75], v[96:99], v[168:171], v[72:75]
    ds_read_b128 v[92:95], v1 offset:31744
    v_mul_f32 v17, v17, v25
    v_mfma_f32_16x16x32_bf16 v[76:79], v[96:99], v[172:175], v[76:79]
    s_waitcnt lgkmcnt(3)
    v_cvt_pk_bf16_f32 v120, v16, v17
    v_max_f32 v18, 0, v18
    v_mfma_f32_16x16x32_bf16 v[64:67], v[80:83], v[176:179], v[64:67]
    ds_read_b128 v[96:99], v1 offset:57344
    v_mul_f32 v18, v18, v26
    v_mfma_f32_16x16x32_bf16 v[68:71], v[80:83], v[180:183], v[68:71]
    s_waitcnt lgkmcnt(3)
    global_load_lds_dwordx4 v1, s[66:67] offset:1024 sc1
    v_mfma_f32_16x16x32_bf16 v[72:75], v[84:87], v[176:179], v[72:75]
    ds_read_b128 v[80:83], v1 offset:58368
    v_max_f32 v19, 0, v19
    v_mfma_f32_16x16x32_bf16 v[76:79], v[84:87], v[180:183], v[76:79]
    s_waitcnt lgkmcnt(3)
    v_mul_f32 v19, v19, v27
    v_cvt_pk_bf16_f32 v121, v18, v19
    v_mfma_f32_16x16x32_bf16 v[64:67], v[88:91], v[184:187], v[64:67]
    ds_read_b128 v[84:87], v1 offset:59392
    v_max_f32 v20, 0, v20
    v_mfma_f32_16x16x32_bf16 v[68:71], v[88:91], v[188:191], v[68:71]
    s_waitcnt lgkmcnt(3)
    v_mul_f32 v20, v20, v28
    v_max_f32 v21, 0, v21
    v_mfma_f32_16x16x32_bf16 v[72:75], v[92:95], v[184:187], v[72:75]
    ds_read_b128 v[88:91], v1 offset:60416
    v_mul_f32 v21, v21, v29
    v_mfma_f32_16x16x32_bf16 v[76:79], v[92:95], v[188:191], v[76:79]
    s_waitcnt lgkmcnt(3)
    global_load_lds_dwordx4 v1, s[66:67] offset:2048 sc1
    v_mfma_f32_16x16x32_bf16 v[64:67], v[96:99], v[192:195], v[64:67]
    ds_read_b128 v[92:95], v1 offset:61440
    v_cvt_pk_bf16_f32 v122, v20, v21
    v_mfma_f32_16x16x32_bf16 v[68:71], v[96:99], v[196:199], v[68:71]
    s_waitcnt lgkmcnt(3)
    v_max_f32 v22, 0, v22
    v_mul_f32 v22, v22, v30
    v_mfma_f32_16x16x32_bf16 v[72:75], v[80:83], v[192:195], v[72:75]
    ds_read_b128 v[96:99], v1 offset:62464
    v_max_f32 v23, 0, v23
    v_mfma_f32_16x16x32_bf16 v[76:79], v[80:83], v[196:199], v[76:79]
    s_waitcnt lgkmcnt(3)
    v_mul_f32 v23, v23, v31
    v_cvt_pk_bf16_f32 v123, v22, v23
    v_mfma_f32_16x16x32_bf16 v[64:67], v[84:87], v[200:203], v[64:67]
    ds_read_b128 v[80:83], v1 offset:63488
    v_permlane16_swap_b32 v120, v122
    v_mfma_f32_16x16x32_bf16 v[68:71], v[84:87], v[204:207], v[68:71]
    s_waitcnt lgkmcnt(3)
    global_load_lds_dwordx4 v1, s[66:67] offset:3072 sc1
    v_mfma_f32_16x16x32_bf16 v[72:75], v[88:91], v[200:203], v[72:75]
    ds_read_b128 v[84:87], v1 offset:64512
    v_permlane16_swap_b32 v121, v123
    v_mfma_f32_16x16x32_bf16 v[76:79], v[88:91], v[204:207], v[76:79]
    s_waitcnt lgkmcnt(3)
    buffer_store_dwordx4 v[120:123], v8, s[44:47], s77 offen offset:0 sc1
    v_mfma_f32_16x16x32_bf16 v[64:67], v[92:95], v[208:211], v[64:67]
    ds_read_b128 v[88:91], v9 offset:24576
    v_max_f32 v32, 0, v32
    v_mfma_f32_16x16x32_bf16 v[68:71], v[92:95], v[212:215], v[68:71]
    s_waitcnt lgkmcnt(3)
    v_mul_f32 v32, v32, v40
    v_max_f32 v33, 0, v33
    v_mfma_f32_16x16x32_bf16 v[72:75], v[96:99], v[208:211], v[72:75]
    ds_read_b128 v[92:95], v9 offset:25600
    v_mul_f32 v33, v33, v41
    v_mfma_f32_16x16x32_bf16 v[76:79], v[96:99], v[212:215], v[76:79]
    s_waitcnt lgkmcnt(3)
    s_add_u32 m0, s83, 4096
    s_add_u32 s66, s16, 167936
    s_addc_u32 s67, s13, 0
    global_load_lds_dwordx4 v1, s[66:67] offset:0 sc1
    v_mfma_f32_16x16x32_bf16 v[64:67], v[80:83], v[216:219], v[64:67]
    ds_read_b128 v[96:99], v9 offset:26624
    v_cvt_pk_bf16_f32 v124, v32, v33
    v_mfma_f32_16x16x32_bf16 v[68:71], v[80:83], v[220:223], v[68:71]
    s_waitcnt lgkmcnt(3)
    v_max_f32 v34, 0, v34
    v_mul_f32 v34, v34, v42
    v_mfma_f32_16x16x32_bf16 v[72:75], v[84:87], v[216:219], v[72:75]
    ds_read_b128 v[80:83], v9 offset:27648
    v_max_f32 v35, 0, v35
    v_mfma_f32_16x16x32_bf16 v[76:79], v[84:87], v[220:223], v[76:79]
    s_waitcnt lgkmcnt(3)
    v_mul_f32 v35, v35, v43
    v_cvt_pk_bf16_f32 v125, v34, v35
    v_mfma_f32_16x16x32_bf16 v[64:67], v[88:91], v[224:227], v[64:67]
    ds_read_b128 v[84:87], v9 offset:28672
    v_max_f32 v36, 0, v36
    v_mfma_f32_16x16x32_bf16 v[68:71], v[88:91], v[228:231], v[68:71]
    s_waitcnt lgkmcnt(3)
    global_load_lds_dwordx4 v1, s[66:67] offset:1024 sc1
    v_mfma_f32_16x16x32_bf16 v[72:75], v[92:95], v[224:227], v[72:75]
    ds_read_b128 v[88:91], v9 offset:29696
    v_mul_f32 v36, v36, v44
    v_mfma_f32_16x16x32_bf16 v[76:79], v[92:95], v[228:231], v[76:79]
    s_waitcnt lgkmcnt(3)
    v_max_f32 v37, 0, v37
    v_mul_f32 v37, v37, v45
    v_mfma_f32_16x16x32_bf16 v[64:67], v[96:99], v[232:235], v[64:67]
    ds_read_b128 v[92:95], v9 offset:30720
    v_cvt_pk_bf16_f32 v126, v36, v37
    v_mfma_f32_16x16x32_bf16 v[68:71], v[96:99], v[236:239], v[68:71]
    s_waitcnt lgkmcnt(3)
    v_max_f32 v38, 0, v38
    v_mul_f32 v38, v38, v46
    v_mfma_f32_16x16x32_bf16 v[72:75], v[80:83], v[232:235], v[72:75]
    ds_read_b128 v[96:99], v9 offset:31744
    v_max_f32 v39, 0, v39
    v_mfma_f32_16x16x32_bf16 v[76:79], v[80:83], v[236:239], v[76:79]
    s_waitcnt lgkmcnt(3)
    global_load_lds_dwordx4 v1, s[66:67] offset:2048 sc1
    v_mfma_f32_16x16x32_bf16 v[64:67], v[84:87], v[240:243], v[64:67]
    ds_read_b128 v[80:83], v9 offset:57344
    v_mul_f32 v39, v39, v47
    v_mfma_f32_16x16x32_bf16 v[68:71], v[84:87], v[244:247], v[68:71]
    s_waitcnt lgkmcnt(3)
    v_cvt_pk_bf16_f32 v127, v38, v39
    v_permlane16_swap_b32 v124, v126
    v_mfma_f32_16x16x32_bf16 v[72:75], v[88:91], v[240:243], v[72:75]
    ds_read_b128 v[84:87], v9 offset:58368
    v_permlane16_swap_b32 v125, v127
    v_mfma_f32_16x16x32_bf16 v[76:79], v[88:91], v[244:247], v[76:79]
    s_waitcnt lgkmcnt(3)
    buffer_store_dwordx4 v[124:127], v8, s[44:47], s77 offen offset:1024 sc1
    v_mfma_f32_16x16x32_bf16 v[64:67], v[92:95], v[248:251], v[64:67]
    ds_read_b128 v[88:91], v9 offset:59392
    v_max_f32 v48, 0, v48
    v_mfma_f32_16x16x32_bf16 v[68:71], v[92:95], v[252:255], v[68:71]
    s_waitcnt lgkmcnt(3)
    global_load_lds_dwordx4 v1, s[66:67] offset:3072 sc1
    v_mfma_f32_16x16x32_bf16 v[72:75], v[96:99], v[248:251], v[72:75]
    ds_read_b128 v[92:95], v9 offset:60416
    v_mul_f32 v48, v48, v56
    v_mfma_f32_16x16x32_bf16 v[76:79], v[96:99], v[252:255], v[76:79]
    s_waitcnt lgkmcnt(3)
    v_max_f32 v49, 0, v49
    v_mul_f32 v49, v49, v57
    v_mfma_f32_16x16x32_bf16 v[64:67], v[80:83], a[224:227], v[64:67]
    ds_read_b128 v[96:99], v9 offset:61440
    v_cvt_pk_bf16_f32 v120, v48, v49
    v_mfma_f32_16x16x32_bf16 v[68:71], v[80:83], a[228:231], v[68:71]
    s_waitcnt lgkmcnt(3)
    v_max_f32 v50, 0, v50
    v_mul_f32 v50, v50, v58
    v_mfma_f32_16x16x32_bf16 v[72:75], v[84:87], a[224:227], v[72:75]
    ds_read_b128 v[80:83], v9 offset:62464
    v_max_f32 v51, 0, v51
    v_mfma_f32_16x16x32_bf16 v[76:79], v[84:87], a[228:231], v[76:79]
    s_waitcnt lgkmcnt(3)
    s_add_u32 m0, s83, 8192
    s_add_u32 s66, s16, 196608
    s_addc_u32 s67, s13, 0
    global_load_lds_dwordx4 v1, s[66:67] offset:0 sc1
    v_mfma_f32_16x16x32_bf16 v[64:67], v[88:91], a[232:235], v[64:67]
    ds_read_b128 v[84:87], v9 offset:63488
    v_mul_f32 v51, v51, v59
    v_mfma_f32_16x16x32_bf16 v[68:71], v[88:91], a[236:239], v[68:71]
    s_waitcnt lgkmcnt(3)
    v_cvt_pk_bf16_f32 v121, v50, v51
    v_max_f32 v52, 0, v52
    v_mfma_f32_16x16x32_bf16 v[72:75], v[92:95], a[232:235], v[72:75]
    ds_read_b128 v[88:91], v9 offset:64512
    v_mul_f32 v52, v52, v60
    v_mfma_f32_16x16x32_bf16 v[76:79], v[92:95], a[236:239], v[76:79]
    s_waitcnt lgkmcnt(3)
    v_max_f32 v53, 0, v53
    v_mul_f32 v53, v53, v61
    v_mfma_f32_16x16x32_bf16 v[64:67], v[96:99], a[240:243], v[64:67]
    ds_read_b128 v[92:95], v10 offset:0
    v_cvt_pk_bf16_f32 v122, v52, v53
    v_mfma_f32_16x16x32_bf16 v[68:71], v[96:99], a[244:247], v[68:71]
    s_waitcnt lgkmcnt(3)
    global_load_lds_dwordx4 v1, s[66:67] offset:1024 sc1
    v_mfma_f32_16x16x32_bf16 v[72:75], v[80:83], a[240:243], v[72:75]
    ds_read_b128 v[96:99], v10 offset:1024
    v_max_f32 v54, 0, v54
    v_mfma_f32_16x16x32_bf16 v[76:79], v[80:83], a[244:247], v[76:79]
    s_waitcnt lgkmcnt(3)
    v_mul_f32 v54, v54, v62
    v_max_f32 v55, 0, v55
    v_mfma_f32_16x16x32_bf16 v[64:67], v[84:87], a[248:251], v[64:67]
    ds_read_b128 v[80:83], v10 offset:2048
    v_mul_f32 v55, v55, v63
    v_mfma_f32_16x16x32_bf16 v[68:71], v[84:87], a[252:255], v[68:71]
    s_waitcnt lgkmcnt(3)
    v_cvt_pk_bf16_f32 v123, v54, v55
    v_permlane16_swap_b32 v120, v122
    v_mfma_f32_16x16x32_bf16 v[72:75], v[88:91], a[248:251], v[72:75]
    ds_read_b128 v[84:87], v10 offset:3072
    v_permlane16_swap_b32 v121, v123
    v_mfma_f32_16x16x32_bf16 v[76:79], v[88:91], a[252:255], v[76:79]
    s_waitcnt lgkmcnt(3)
    buffer_store_dwordx4 v[120:123], v8, s[44:47], s77 offen offset:2048 sc1
    v_mfma_f32_16x16x32_bf16 v[16:19], v[92:95], v[160:163], 0
    ds_read_b128 v[88:91], v10 offset:4096
    v_mfma_f32_16x16x32_bf16 v[20:23], v[92:95], v[164:167], 0
    s_waitcnt lgkmcnt(3)
    global_load_lds_dwordx4 v1, s[66:67] offset:2048 sc1
    v_mfma_f32_16x16x32_bf16 v[24:27], v[96:99], v[160:163], 0
    ds_read_b128 v[92:95], v10 offset:5120
    v_mfma_f32_16x16x32_bf16 v[28:31], v[96:99], v[164:167], 0
    s_waitcnt lgkmcnt(3)
    v_mfma_f32_16x16x32_bf16 v[16:19], v[80:83], v[168:171], v[16:19]
    ds_read_b128 v[96:99], v10 offset:6144
    v_max_f32 v64, 0, v64
    v_mfma_f32_16x16x32_bf16 v[20:23], v[80:83], v[172:175], v[20:23]
    s_waitcnt lgkmcnt(3)
    global_load_lds_dwordx4 v1, s[66:67] offset:3072 sc1
    v_mfma_f32_16x16x32_bf16 v[24:27], v[84:87], v[168:171], v[24:27]
    ds_read_b128 v[80:83], v10 offset:7168
    v_mul_f32 v64, v64, v72
    v_mfma_f32_16x16x32_bf16 v[28:31], v[84:87], v[172:175], v[28:31]
    s_waitcnt lgkmcnt(3)
    v_max_f32 v65, 0, v65
    v_mul_f32 v65, v65, v73
    v_mfma_f32_16x16x32_bf16 v[16:19], v[88:91], v[176:179], v[16:19]
    ds_read_b128 v[84:87], v10 offset:8192
    v_cvt_pk_bf16_f32 v124, v64, v65
    v_mfma_f32_16x16x32_bf16 v[20:23], v[88:91], v[180:183], v[20:23]
    s_waitcnt lgkmcnt(3)
    v_max_f32 v66, 0, v66
    v_mul_f32 v66, v66, v74
    v_mfma_f32_16x16x32_bf16 v[24:27], v[92:95], v[176:179], v[24:27]
    ds_read_b128 v[88:91], v10 offset:9216
    v_max_f32 v67, 0, v67
    v_mfma_f32_16x16x32_bf16 v[28:31], v[92:95], v[180:183], v[28:31]
    s_waitcnt lgkmcnt(3)
    s_add_u32 m0, s83, 12288
    s_add_u32 s66, s16, 200704
    s_addc_u32 s67, s13, 0
    global_load_lds_dwordx4 v1, s[66:67] offset:0 sc1
    v_mfma_f32_16x16x32_bf16 v[16:19], v[96:99], v[184:187], v[16:19]
    ds_read_b128 v[92:95], v10 offset:10240
    v_mul_f32 v67, v67, v75
    v_mfma_f32_16x16x32_bf16 v[20:23], v[96:99], v[188:191], v[20:23]
    s_waitcnt lgkmcnt(3)
    v_cvt_pk_bf16_f32 v125, v66, v67
    v_max_f32 v68, 0, v68
    v_mfma_f32_16x16x32_bf16 v[24:27], v[80:83], v[184:187], v[24:27]
    ds_read_b128 v[96:99], v10 offset:11264
    v_mul_f32 v68, v68, v76
    v_mfma_f32_16x16x32_bf16 v[28:31], v[80:83], v[188:191], v[28:31]
    s_waitcnt lgkmcnt(3)
    v_max_f32 v69, 0, v69
    v_mul_f32 v69, v69, v77
    v_mfma_f32_16x16x32_bf16 v[16:19], v[84:87], v[192:195], v[16:19]
    ds_read_b128 v[80:83], v10 offset:12288
    v_cvt_pk_bf16_f32 v126, v68, v69
    v_mfma_f32_16x16x32_bf16 v[20:23], v[84:87], v[196:199], v[20:23]
    s_waitcnt lgkmcnt(3)
    global_load_lds_dwordx4 v1, s[66:67] offset:1024 sc1
    v_mfma_f32_16x16x32_bf16 v[24:27], v[88:91], v[192:195], v[24:27]
    ds_read_b128 v[84:87], v10 offset:13312
    v_max_f32 v70, 0, v70
    v_mfma_f32_16x16x32_bf16 v[28:31], v[88:91], v[196:199], v[28:31]
    s_waitcnt lgkmcnt(3)
    v_mul_f32 v70, v70, v78
    v_max_f32 v71, 0, v71
    v_mfma_f32_16x16x32_bf16 v[16:19], v[92:95], v[200:203], v[16:19]
    ds_read_b128 v[88:91], v10 offset:14336
    v_mul_f32 v71, v71, v79
    v_mfma_f32_16x16x32_bf16 v[20:23], v[92:95], v[204:207], v[20:23]
    s_waitcnt lgkmcnt(3)
    v_cvt_pk_bf16_f32 v127, v70, v71
    v_permlane16_swap_b32 v124, v126
    v_mfma_f32_16x16x32_bf16 v[24:27], v[96:99], v[200:203], v[24:27]
    ds_read_b128 v[92:95], v10 offset:15360
    v_permlane16_swap_b32 v125, v127
    v_mfma_f32_16x16x32_bf16 v[28:31], v[96:99], v[204:207], v[28:31]
    s_waitcnt lgkmcnt(3)
    buffer_store_dwordx4 v[124:127], v8, s[44:47], s77 offen offset:3072 sc1
    v_mfma_f32_16x16x32_bf16 v[16:19], v[80:83], v[208:211], v[16:19]
    ds_read_b128 v[96:99], v10 offset:16384
    v_mfma_f32_16x16x32_bf16 v[20:23], v[80:83], v[212:215], v[20:23]
    s_waitcnt lgkmcnt(3)
    global_load_lds_dwordx4 v1, s[66:67] offset:2048 sc1
    v_mfma_f32_16x16x32_bf16 v[24:27], v[84:87], v[208:211], v[24:27]
    ds_read_b128 v[80:83], v10 offset:17408
    v_mfma_f32_16x16x32_bf16 v[28:31], v[84:87], v[212:215], v[28:31]
    s_waitcnt lgkmcnt(3)
    v_mfma_f32_16x16x32_bf16 v[16:19], v[88:91], v[216:219], v[16:19]
    ds_read_b128 v[84:87], v10 offset:18432
    v_mfma_f32_16x16x32_bf16 v[20:23], v[88:91], v[220:223], v[20:23]
    s_waitcnt lgkmcnt(3)
    global_load_lds_dwordx4 v1, s[66:67] offset:3072 sc1
    v_mfma_f32_16x16x32_bf16 v[24:27], v[92:95], v[216:219], v[24:27]
    ds_read_b128 v[88:91], v10 offset:19456
    v_mfma_f32_16x16x32_bf16 v[28:31], v[92:95], v[220:223], v[28:31]
    s_waitcnt lgkmcnt(3)
    v_mfma_f32_16x16x32_bf16 v[16:19], v[96:99], v[224:227], v[16:19]
    ds_read_b128 v[92:95], v10 offset:20480
    v_mfma_f32_16x16x32_bf16 v[20:23], v[96:99], v[228:231], v[20:23]
    s_waitcnt lgkmcnt(3)
    v_mfma_f32_16x16x32_bf16 v[24:27], v[80:83], v[224:227], v[24:27]
    ds_read_b128 v[96:99], v10 offset:21504
    v_mfma_f32_16x16x32_bf16 v[28:31], v[80:83], v[228:231], v[28:31]
    s_waitcnt lgkmcnt(3)
    v_mfma_f32_16x16x32_bf16 v[16:19], v[84:87], v[232:235], v[16:19]
    ds_read_b128 v[80:83], v10 offset:22528
    v_mfma_f32_16x16x32_bf16 v[20:23], v[84:87], v[236:239], v[20:23]
    s_waitcnt lgkmcnt(3)
    v_mfma_f32_16x16x32_bf16 v[24:27], v[88:91], v[232:235], v[24:27]
    ds_read_b128 v[84:87], v10 offset:23552
    v_mfma_f32_16x16x32_bf16 v[28:31], v[88:91], v[236:239], v[28:31]
    s_waitcnt lgkmcnt(3)
    v_mfma_f32_16x16x32_bf16 v[16:19], v[92:95], v[240:243], v[16:19]
    ds_read_b128 v[88:91], v10 offset:24576
    v_mfma_f32_16x16x32_bf16 v[20:23], v[92:95], v[244:247], v[20:23]
    s_waitcnt lgkmcnt(3)
    v_mfma_f32_16x16x32_bf16 v[24:27], v[96:99], v[240:243], v[24:27]
    ds_read_b128 v[92:95], v10 offset:25600
    v_mfma_f32_16x16x32_bf16 v[28:31], v[96:99], v[244:247], v[28:31]
    s_waitcnt lgkmcnt(3)
    v_mfma_f32_16x16x32_bf16 v[16:19], v[80:83], v[248:251], v[16:19]
    ds_read_b128 v[96:99], v10 offset:26624
    v_mfma_f32_16x16x32_bf16 v[20:23], v[80:83], v[252:255], v[20:23]
    s_waitcnt lgkmcnt(3)
    v_mfma_f32_16x16x32_bf16 v[24:27], v[84:87], v[248:251], v[24:27]
    ds_read_b128 v[80:83], v10 offset:27648
    v_mfma_f32_16x16x32_bf16 v[28:31], v[84:87], v[252:255], v[28:31]
    s_waitcnt lgkmcnt(3)
    v_mfma_f32_16x16x32_bf16 v[16:19], v[88:91], a[224:227], v[16:19]
    ds_read_b128 v[84:87], v10 offset:28672
    v_mfma_f32_16x16x32_bf16 v[20:23], v[88:91], a[228:231], v[20:23]
    s_waitcnt lgkmcnt(3)
    buffer_load_dwordx4 a[172:175], v1, s[48:51], s94 offen offset:3072 sc1
    v_mfma_f32_16x16x32_bf16 v[24:27], v[92:95], a[224:227], v[24:27]
    ds_read_b128 v[88:91], v10 offset:29696
    v_mfma_f32_16x16x32_bf16 v[28:31], v[92:95], a[228:231], v[28:31]
    s_waitcnt lgkmcnt(3)
    v_mfma_f32_16x16x32_bf16 v[16:19], v[96:99], a[232:235], v[16:19]
    ds_read_b128 v[92:95], v10 offset:30720
    v_mfma_f32_16x16x32_bf16 v[20:23], v[96:99], a[236:239], v[20:23]
    s_waitcnt lgkmcnt(3)
    v_mfma_f32_16x16x32_bf16 v[24:27], v[80:83], a[232:235], v[24:27]
    ds_read_b128 v[96:99], v10 offset:31744
    v_mfma_f32_16x16x32_bf16 v[28:31], v[80:83], a[236:239], v[28:31]
    s_waitcnt lgkmcnt(3)
    v_mfma_f32_16x16x32_bf16 v[16:19], v[84:87], a[240:243], v[16:19]
    s_waitcnt vmcnt(11)
    s_barrier
    s_cmp_lg_u32 s3, 0
    s_cbranch_scc1 L_pub_32
    s_lshl_b32 s82, s73, 7
    s_add_u32 s82, s82, 0x2b0000
    v_mov_b32 v4, 0
    s_mov_b64 exec, 1
    buffer_store_dword v2, v4, s[44:47], s82 offen sc1
    s_mov_b64 exec, -1
L_pub_32:
    ds_read_b128 v[80:83], v1 offset:0
    s_mul_i32 s18, s68, 224
    v_mfma_f32_16x16x32_bf16 v[20:23], v[84:87], a[244:247], v[20:23]
    s_waitcnt lgkmcnt(3)
    s_add_u32 s94, s94, 4096
    buffer_load_dwordx4 a[176:179], v1, s[48:51], s94 offen offset:0 sc1
    v_mfma_f32_16x16x32_bf16 v[24:27], v[88:91], a[240:243], v[24:27]
    ds_read_b128 v[84:87], v1 offset:1024
    s_mul_i32 s19, s3, 28
    v_mfma_f32_16x16x32_bf16 v[28:31], v[88:91], a[244:247], v[28:31]
    s_waitcnt lgkmcnt(3)
    s_add_u32 s18, s18, s19
    s_lshl_b32 s18, s18, 10
    v_mfma_f32_16x16x32_bf16 v[16:19], v[92:95], a[248:251], v[16:19]
    ds_read_b128 v[88:91], v1 offset:2048
    s_add_u32 s18, s18, 0x700000
    v_mfma_f32_16x16x32_bf16 v[20:23], v[92:95], a[252:255], v[20:23]
    s_waitcnt lgkmcnt(3)
    s_mov_b32 s60, 0
    v_mfma_f32_16x16x32_bf16 v[24:27], v[96:99], a[248:251], v[24:27]
    ds_read_b128 v[92:95], v1 offset:3072
    s_and_b32 s60, s60, 3
    v_mfma_f32_16x16x32_bf16 v[28:31], v[96:99], a[252:255], v[28:31]
    s_waitcnt lgkmcnt(3)
    s_mul_i32 s60, s60, 7168
    v_mfma_f32_16x16x32_bf16 v[32:35], v[80:83], v[160:163], 0
    ds_read_b128 v[96:99], v1 offset:4096
    s_add_u32 s60, s60, s18
    v_mfma_f32_16x16x32_bf16 v[36:39], v[80:83], v[164:167], 0
    s_waitcnt lgkmcnt(3)
    buffer_load_dwordx4 a[180:183], v1, s[48:51], s94 offen offset:1024 sc1
    v_mfma_f32_16x16x32_bf16 v[40:43], v[84:87], v[160:163], 0
    ds_read_b128 v[80:83], v1 offset:5120
    s_mov_b32 s61, 1
    v_mfma_f32_16x16x32_bf16 v[44:47], v[84:87], v[164:167], 0
    s_waitcnt lgkmcnt(3)
    s_and_b32 s61, s61, 3
    s_mul_i32 s61, s61, 7168
    v_mfma_f32_16x16x32_bf16 v[32:35], v[88:91], v[168:171], v[32:35]
    ds_read_b128 v[84:87], v1 offset:6144
    v_max_f32 v16, 0, v16
    v_mfma_f32_16x16x32_bf16 v[36:39], v[88:91], v[172:175], v[36:39]
    s_waitcnt lgkmcnt(3)
    v_mul_f32 v16, v16, v24
    v_max_f32 v17, 0, v17
    v_mfma_f32_16x16x32_bf16 v[40:43], v[92:95], v[168:171], v[40:43]
    ds_read_b128 v[88:91], v1 offset:7168
    v_mul_f32 v17, v17, v25
    v_mfma_f32_16x16x32_bf16 v[44:47], v[92:95], v[172:175], v[44:47]
    s_waitcnt lgkmcnt(3)
    v_cvt_pk_bf16_f32 v120, v16, v17
    v_max_f32 v18, 0, v18
    v_mfma_f32_16x16x32_bf16 v[32:35], v[96:99], v[176:179], v[32:35]
    ds_read_b128 v[92:95], v1 offset:32768
    v_mul_f32 v18, v18, v26
    v_mfma_f32_16x16x32_bf16 v[36:39], v[96:99], v[180:183], v[36:39]
    s_waitcnt lgkmcnt(3)
    buffer_load_dwordx4 a[184:187], v1, s[48:51], s94 offen offset:2048 sc1
    v_mfma_f32_16x16x32_bf16 v[40:43], v[80:83], v[176:179], v[40:43]
    ds_read_b128 v[96:99], v1 offset:33792
    v_max_f32 v19, 0, v19
    v_mfma_f32_16x16x32_bf16 v[44:47], v[80:83], v[180:183], v[44:47]
    s_waitcnt lgkmcnt(3)
    v_mul_f32 v19, v19, v27
    v_cvt_pk_bf16_f32 v121, v18, v19
    v_mfma_f32_16x16x32_bf16 v[32:35], v[84:87], v[184:187], v[32:35]
    ds_read_b128 v[80:83], v1 offset:34816
    v_max_f32 v20, 0, v20
    v_mfma_f32_16x16x32_bf16 v[36:39], v[84:87], v[188:191], v[36:39]
    s_waitcnt lgkmcnt(3)
    v_mul_f32 v20, v20, v28
    v_max_f32 v21, 0, v21
    v_mfma_f32_16x16x32_bf16 v[40:43], v[88:91], v[184:187], v[40:43]
    ds_read_b128 v[84:87], v1 offset:35840
    v_mul_f32 v21, v21, v29
    v_mfma_f32_16x16x32_bf16 v[44:47], v[88:91], v[188:191], v[44:47]
    s_waitcnt lgkmcnt(3)
    v_cvt_pk_bf16_f32 v122, v20, v21
    v_max_f32 v22, 0, v22
    v_mfma_f32_16x16x32_bf16 v[32:35], v[92:95], v[192:195], v[32:35]
    ds_read_b128 v[88:91], v1 offset:36864
    v_mul_f32 v22, v22, v30
    v_mfma_f32_16x16x32_bf16 v[36:39], v[92:95], v[196:199], v[36:39]
    s_waitcnt lgkmcnt(3)
    v_max_f32 v23, 0, v23
    v_mul_f32 v23, v23, v31
    v_mfma_f32_16x16x32_bf16 v[40:43], v[96:99], v[192:195], v[40:43]
    ds_read_b128 v[92:95], v1 offset:37888
    v_cvt_pk_bf16_f32 v123, v22, v23
    v_mfma_f32_16x16x32_bf16 v[44:47], v[96:99], v[196:199], v[44:47]
    s_waitcnt lgkmcnt(3)
    buffer_load_dwordx4 a[188:191], v1, s[48:51], s94 offen offset:3072 sc1
    v_mfma_f32_16x16x32_bf16 v[32:35], v[80:83], v[200:203], v[32:35]
    ds_read_b128 v[96:99], v1 offset:38912
    v_permlane16_swap_b32 v120, v122
    v_mfma_f32_16x16x32_bf16 v[36:39], v[80:83], v[204:207], v[36:39]
    s_waitcnt lgkmcnt(3)
    v_permlane16_swap_b32 v121, v123
    v_mfma_f32_16x16x32_bf16 v[40:43], v[84:87], v[200:203], v[40:43]
    ds_read_b128 v[80:83], v1 offset:39936
    v_mfma_f32_16x16x32_bf16 v[44:47], v[84:87], v[204:207], v[44:47]
    s_waitcnt lgkmcnt(3)
    buffer_store_dwordx4 v[120:123], v8, s[44:47], s79 offen offset:0 sc1
    v_mfma_f32_16x16x32_bf16 v[32:35], v[88:91], v[208:211], v[32:35]
    ds_read_b128 v[84:87], v9 offset:0
    s_add_u32 s61, s61, s18
    v_mfma_f32_16x16x32_bf16 v[36:39], v[88:91], v[212:215], v[36:39]
    s_waitcnt lgkmcnt(3)
    s_mov_b32 s62, 2
    s_and_b32 s62, s62, 3
    v_mfma_f32_16x16x32_bf16 v[40:43], v[92:95], v[208:211], v[40:43]
    ds_read_b128 v[88:91], v9 offset:1024
    s_mul_i32 s62, s62, 7168
    v_mfma_f32_16x16x32_bf16 v[44:47], v[92:95], v[212:215], v[44:47]
    s_waitcnt lgkmcnt(3)
    s_add_u32 s94, s94, 4096
    buffer_load_dwordx4 a[192:195], v1, s[48:51], s94 offen offset:0 sc1
    v_mfma_f32_16x16x32_bf16 v[32:35], v[96:99], v[216:219], v[32:35]
    ds_read_b128 v[92:95], v9 offset:2048
    s_add_u32 s62, s62, s18
    v_mfma_f32_16x16x32_bf16 v[36:39], v[96:99], v[220:223], v[36:39]
    s_waitcnt lgkmcnt(3)
    s_mov_b32 s63, 3
    s_and_b32 s63, s63, 3
    v_mfma_f32_16x16x32_bf16 v[40:43], v[80:83], v[216:219], v[40:43]
    ds_read_b128 v[96:99], v9 offset:3072
    s_mul_i32 s63, s63, 7168
    v_mfma_f32_16x16x32_bf16 v[44:47], v[80:83], v[220:223], v[44:47]
    s_waitcnt lgkmcnt(3)
    s_add_u32 s63, s63, s18
    v_mfma_f32_16x16x32_bf16 v[32:35], v[84:87], v[224:227], v[32:35]
    ds_read_b128 v[80:83], v9 offset:4096
    v_mfma_f32_16x16x32_bf16 v[36:39], v[84:87], v[228:231], v[36:39]
    s_waitcnt lgkmcnt(3)
    v_mfma_f32_16x16x32_bf16 v[40:43], v[88:91], v[224:227], v[40:43]
    ds_read_b128 v[84:87], v9 offset:5120
    v_mfma_f32_16x16x32_bf16 v[44:47], v[88:91], v[228:231], v[44:47]
    s_waitcnt lgkmcnt(3)
    buffer_load_dwordx4 a[196:199], v1, s[48:51], s94 offen offset:1024 sc1
    v_mfma_f32_16x16x32_bf16 v[32:35], v[92:95], v[232:235], v[32:35]
    ds_read_b128 v[88:91], v9 offset:6144
    v_mfma_f32_16x16x32_bf16 v[36:39], v[92:95], v[236:239], v[36:39]
    s_waitcnt lgkmcnt(3)
    v_mfma_f32_16x16x32_bf16 v[40:43], v[96:99], v[232:235], v[40:43]
    ds_read_b128 v[92:95], v9 offset:7168
    v_mfma_f32_16x16x32_bf16 v[44:47], v[96:99], v[236:239], v[44:47]
    s_waitcnt lgkmcnt(3)
    v_mfma_f32_16x16x32_bf16 v[32:35], v[80:83], v[240:243], v[32:35]
    ds_read_b128 v[96:99], v9 offset:32768
    v_mfma_f32_16x16x32_bf16 v[36:39], v[80:83], v[244:247], v[36:39]
    s_waitcnt lgkmcnt(3)
    v_mfma_f32_16x16x32_bf16 v[40:43], v[84:87], v[240:243], v[40:43]
    ds_read_b128 v[80:83], v9 offset:33792
    v_mfma_f32_16x16x32_bf16 v[44:47], v[84:87], v[244:247], v[44:47]
    s_waitcnt lgkmcnt(3)
    v_mfma_f32_16x16x32_bf16 v[32:35], v[88:91], v[248:251], v[32:35]
    ds_read_b128 v[84:87], v9 offset:34816
    v_mfma_f32_16x16x32_bf16 v[36:39], v[88:91], v[252:255], v[36:39]
    s_waitcnt lgkmcnt(3)
    buffer_load_dwordx4 a[200:203], v1, s[48:51], s94 offen offset:2048 sc1
    v_mfma_f32_16x16x32_bf16 v[40:43], v[92:95], v[248:251], v[40:43]
    ds_read_b128 v[88:91], v9 offset:35840
    v_mfma_f32_16x16x32_bf16 v[44:47], v[92:95], v[252:255], v[44:47]
    s_waitcnt lgkmcnt(3)
    v_mfma_f32_16x16x32_bf16 v[32:35], v[96:99], a[224:227], v[32:35]
    ds_read_b128 v[92:95], v9 offset:36864
    v_mfma_f32_16x16x32_bf16 v[36:39], v[96:99], a[228:231], v[36:39]
    s_waitcnt lgkmcnt(3)
    v_mfma_f32_16x16x32_bf16 v[40:43], v[80:83], a[224:227], v[40:43]
    ds_read_b128 v[96:99], v9 offset:37888
    v_mfma_f32_16x16x32_bf16 v[44:47], v[80:83], a[228:231], v[44:47]
    s_waitcnt lgkmcnt(3)
    v_mfma_f32_16x16x32_bf16 v[32:35], v[84:87], a[232:235], v[32:35]
    ds_read_b128 v[80:83], v9 offset:38912
    v_mfma_f32_16x16x32_bf16 v[36:39], v[84:87], a[236:239], v[36:39]
    s_waitcnt lgkmcnt(3)
    buffer_load_dwordx4 a[204:207], v1, s[48:51], s94 offen offset:3072 sc1
    v_mfma_f32_16x16x32_bf16 v[40:43], v[88:91], a[232:235], v[40:43]
    ds_read_b128 v[84:87], v9 offset:39936
    v_mfma_f32_16x16x32_bf16 v[44:47], v[88:91], a[236:239], v[44:47]
    s_waitcnt lgkmcnt(3)
    v_mfma_f32_16x16x32_bf16 v[32:35], v[92:95], a[240:243], v[32:35]
    s_waitcnt vmcnt(10)
    s_barrier
    ds_read_b128 v[88:91], v1 offset:8192
    v_mfma_f32_16x16x32_bf16 v[36:39], v[92:95], a[244:247], v[36:39]
    s_waitcnt lgkmcnt(3)
    v_mfma_f32_16x16x32_bf16 v[40:43], v[96:99], a[240:243], v[40:43]
    ds_read_b128 v[92:95], v1 offset:9216
    v_mfma_f32_16x16x32_bf16 v[44:47], v[96:99], a[244:247], v[44:47]
    s_waitcnt lgkmcnt(3)
    v_mfma_f32_16x16x32_bf16 v[32:35], v[80:83], a[248:251], v[32:35]
    ds_read_b128 v[96:99], v1 offset:10240
    v_mfma_f32_16x16x32_bf16 v[36:39], v[80:83], a[252:255], v[36:39]
    s_waitcnt lgkmcnt(3)
    s_add_u32 s94, s94, 4096
    buffer_load_dwordx4 a[208:211], v1, s[48:51], s94 offen offset:0 sc1
    v_mfma_f32_16x16x32_bf16 v[40:43], v[84:87], a[248:251], v[40:43]
    ds_read_b128 v[80:83], v1 offset:11264
    v_mfma_f32_16x16x32_bf16 v[44:47], v[84:87], a[252:255], v[44:47]
    s_waitcnt lgkmcnt(3)
    v_mfma_f32_16x16x32_bf16 v[48:51], v[88:91], v[160:163], 0
    ds_read_b128 v[84:87], v1 offset:12288
    v_mfma_f32_16x16x32_bf16 v[52:55], v[88:91], v[164:167], 0
    s_waitcnt lgkmcnt(3)
    v_mfma_f32_16x16x32_bf16 v[56:59], v[92:95], v[160:163], 0
    ds_read_b128 v[88:91], v1 offset:13312
    v_mfma_f32_16x16x32_bf16 v[60:63], v[92:95], v[164:167], 0
    s_waitcnt lgkmcnt(3)
    v_mfma_f32_16x16x32_bf16 v[48:51], v[96:99], v[168:171], v[48:51]
    ds_read_b128 v[92:95], v1 offset:14336
    v_max_f32 v32, 0, v32
    v_mfma_f32_16x16x32_bf16 v[52:55], v[96:99], v[172:175], v[52:55]
    s_waitcnt lgkmcnt(3)
    v_mul_f32 v32, v32, v40
    v_max_f32 v33, 0, v33
    v_mfma_f32_16x16x32_bf16 v[56:59], v[80:83], v[168:171], v[56:59]
    ds_read_b128 v[96:99], v1 offset:15360
    v_mul_f32 v33, v33, v41
    v_mfma_f32_16x16x32_bf16 v[60:63], v[80:83], v[172:175], v[60:63]
    s_waitcnt lgkmcnt(3)
    buffer_load_dwordx4 a[212:215], v1, s[48:51], s94 offen offset:1024 sc1
    v_mfma_f32_16x16x32_bf16 v[48:51], v[84:87], v[176:179], v[48:51]
    ds_read_b128 v[80:83], v1 offset:40960
    v_cvt_pk_bf16_f32 v124, v32, v33
    v_mfma_f32_16x16x32_bf16 v[52:55], v[84:87], v[180:183], v[52:55]
    s_waitcnt lgkmcnt(3)
    buffer_load_dword v14, v12, s[44:47], 0 offen sc1
    v_mfma_f32_16x16x32_bf16 v[56:59], v[88:91], v[176:179], v[56:59]
    ds_read_b128 v[84:87], v1 offset:41984
    v_max_f32 v34, 0, v34
    v_mfma_f32_16x16x32_bf16 v[60:63], v[88:91], v[180:183], v[60:63]
    s_waitcnt lgkmcnt(3)
    v_mul_f32 v34, v34, v42
    v_max_f32 v35, 0, v35
    v_mfma_f32_16x16x32_bf16 v[48:51], v[92:95], v[184:187], v[48:51]
    ds_read_b128 v[88:91], v1 offset:43008
    v_mul_f32 v35, v35, v43
    v_mfma_f32_16x16x32_bf16 v[52:55], v[92:95], v[188:191], v[52:55]
    s_waitcnt lgkmcnt(3)
    s_waitcnt vmcnt(7)
    s_barrier
    s_cmp_lg_u32 s3, 0
    s_cbranch_scc1 L_pub_33
    s_lshl_b32 s82, s73, 7
    s_add_u32 s82, s82, 0x2a0000
    v_mov_b32 v4, 0
    s_mov_b64 exec, 1
    buffer_store_dword v2, v4, s[44:47], s82 offen sc1
    s_mov_b64 exec, -1
L_pub_33:
    v_mfma_f32_16x16x32_bf16 v[56:59], v[96:99], v[184:187], v[56:59]
    ds_read_b128 v[92:95], v1 offset:44032
    v_cvt_pk_bf16_f32 v125, v34, v35
    v_mfma_f32_16x16x32_bf16 v[60:63], v[96:99], v[188:191], v[60:63]
    s_waitcnt lgkmcnt(3)
    buffer_load_dwordx4 a[216:219], v1, s[48:51], s94 offen offset:2048 sc1
    v_mfma_f32_16x16x32_bf16 v[48:51], v[80:83], v[192:195], v[48:51]
    ds_read_b128 v[96:99], v1 offset:45056
    v_max_f32 v36, 0, v36
    v_mfma_f32_16x16x32_bf16 v[52:55], v[80:83], v[196:199], v[52:55]
    s_waitcnt lgkmcnt(3)
    v_mul_f32 v36, v36, v44
    v_max_f32 v37, 0, v37
    v_mfma_f32_16x16x32_bf16 v[56:59], v[84:87], v[192:195], v[56:59]
    ds_read_b128 v[80:83], v1 offset:46080
    v_mul_f32 v37, v37, v45
    v_mfma_f32_16x16x32_bf16 v[60:63], v[84:87], v[196:199], v[60:63]
    s_waitcnt lgkmcnt(3)
    v_cvt_pk_bf16_f32 v126, v36, v37
    v_max_f32 v38, 0, v38
    v_mfma_f32_16x16x32_bf16 v[48:51], v[88:91], v[200:203], v[48:51]
    ds_read_b128 v[84:87], v1 offset:47104
    v_mul_f32 v38, v38, v46
    v_mfma_f32_16x16x32_bf16 v[52:55], v[88:91], v[204:207], v[52:55]
    s_waitcnt lgkmcnt(3)
    v_max_f32 v39, 0, v39
    v_mul_f32 v39, v39, v47
    v_mfma_f32_16x16x32_bf16 v[56:59], v[92:95], v[200:203], v[56:59]
    ds_read_b128 v[88:91], v1 offset:48128
    v_cvt_pk_bf16_f32 v127, v38, v39
    v_mfma_f32_16x16x32_bf16 v[60:63], v[92:95], v[204:207], v[60:63]
    s_waitcnt lgkmcnt(3)
    buffer_load_dwordx4 a[220:223], v1, s[48:51], s94 offen offset:3072 sc1
    v_mfma_f32_16x16x32_bf16 v[48:51], v[96:99], v[208:211], v[48:51]
    ds_read_b128 v[92:95], v9 offset:8192
    v_permlane16_swap_b32 v124, v126
    v_mfma_f32_16x16x32_bf16 v[52:55], v[96:99], v[212:215], v[52:55]
    s_waitcnt lgkmcnt(3)
    v_permlane16_swap_b32 v125, v127
    v_mfma_f32_16x16x32_bf16 v[56:59], v[80:83], v[208:211], v[56:59]
    ds_read_b128 v[96:99], v9 offset:9216
    v_mfma_f32_16x16x32_bf16 v[60:63], v[80:83], v[212:215], v[60:63]
    s_waitcnt lgkmcnt(3)
    buffer_store_dwordx4 v[124:127], v8, s[44:47], s79 offen offset:1024 sc1
    v_mfma_f32_16x16x32_bf16 v[48:51], v[84:87], v[216:219], v[48:51]
    ds_read_b128 v[80:83], v9 offset:10240
    v_mfma_f32_16x16x32_bf16 v[52:55], v[84:87], v[220:223], v[52:55]
    s_waitcnt lgkmcnt(3)
    v_mfma_f32_16x16x32_bf16 v[56:59], v[88:91], v[216:219], v[56:59]
    ds_read_b128 v[84:87], v9 offset:11264
    v_mfma_f32_16x16x32_bf16 v[60:63], v[88:91], v[220:223], v[60:63]
    s_waitcnt lgkmcnt(3)
    v_mfma_f32_16x16x32_bf16 v[48:51], v[92:95], v[224:227], v[48:51]
    ds_read_b128 v[88:91], v9 offset:12288
    v_mfma_f32_16x16x32_bf16 v[52:55], v[92:95], v[228:231], v[52:55]
    s_waitcnt lgkmcnt(3)
    v_mfma_f32_16x16x32_bf16 v[56:59], v[96:99], v[224:227], v[56:59]
    ds_read_b128 v[92:95], v9 offset:13312
    v_mfma_f32_16x16x32_bf16 v[60:63], v[96:99], v[228:231], v[60:63]
    s_waitcnt lgkmcnt(3)
    v_mfma_f32_16x16x32_bf16 v[48:51], v[80:83], v[232:235], v[48:51]
    ds_read_b128 v[96:99], v9 offset:14336
    v_mfma_f32_16x16x32_bf16 v[52:55], v[80:83], v[236:239], v[52:55]
    s_waitcnt lgkmcnt(3)
    s_waitcnt vmcnt(3)
    v_cmp_ne_u32 vcc, v14, v2
    s_cbranch_vccz L_ok_s3a_34
    s_mov_b32 s82, 200000
L_poll_s3a_35:
    buffer_load_dword v14, v12, s[44:47], 0 offen sc1
    s_waitcnt vmcnt(0)
    v_cmp_ne_u32 vcc, v14, v2
    s_cbranch_vccz L_polld_s3a_36
    s_sub_u32 s82, s82, 1
    s_cmp_lg_u32 s82, 0
    s_cbranch_scc1 L_poll_s3a_35
    s_branch L_TIMEOUT
L_polld_s3a_36:
L_ok_s3a_34:
    v_mfma_f32_16x16x32_bf16 v[56:59], v[84:87], v[232:235], v[56:59]
    ds_read_b128 v[80:83], v9 offset:15360
    v_mfma_f32_16x16x32_bf16 v[60:63], v[84:87], v[236:239], v[60:63]
    s_waitcnt lgkmcnt(3)
    s_add_u32 s19, s60, 0
    buffer_load_dwordx4 v[156:159], v13, s[44:47], s19 offen offset:0 sc1
    v_mfma_f32_16x16x32_bf16 v[48:51], v[88:91], v[240:243], v[48:51]
    ds_read_b128 v[84:87], v9 offset:40960
    v_mfma_f32_16x16x32_bf16 v[52:55], v[88:91], v[244:247], v[52:55]
    s_waitcnt lgkmcnt(3)
    v_mfma_f32_16x16x32_bf16 v[56:59], v[92:95], v[240:243], v[56:59]
    ds_read_b128 v[88:91], v9 offset:41984
    v_mfma_f32_16x16x32_bf16 v[60:63], v[92:95], v[244:247], v[60:63]
    s_waitcnt lgkmcnt(3)
    buffer_load_dwordx4 v[160:163], v13, s[44:47], s19 offen offset:256 sc1
    v_mfma_f32_16x16x32_bf16 v[48:51], v[96:99], v[248:251], v[48:51]
    ds_read_b128 v[92:95], v9 offset:43008
    v_mfma_f32_16x16x32_bf16 v[52:55], v[96:99], v[252:255], v[52:55]
    s_waitcnt lgkmcnt(3)
    v_mfma_f32_16x16x32_bf16 v[56:59], v[80:83], v[248:251], v[56:59]
    ds_read_b128 v[96:99], v9 offset:44032
    v_mfma_f32_16x16x32_bf16 v[60:63], v[80:83], v[252:255], v[60:63]
    s_waitcnt lgkmcnt(3)
    s_add_u32 s19, s61, 0
    buffer_load_dwordx4 v[164:167], v13, s[44:47], s19 offen offset:0 sc1
    v_mfma_f32_16x16x32_bf16 v[48:51], v[84:87], a[224:227], v[48:51]
    ds_read_b128 v[80:83], v9 offset:45056
    v_mfma_f32_16x16x32_bf16 v[52:55], v[84:87], a[228:231], v[52:55]
    s_waitcnt lgkmcnt(3)
    v_mfma_f32_16x16x32_bf16 v[56:59], v[88:91], a[224:227], v[56:59]
    ds_read_b128 v[84:87], v9 offset:46080
    v_mfma_f32_16x16x32_bf16 v[60:63], v[88:91], a[228:231], v[60:63]
    s_waitcnt lgkmcnt(3)
    buffer_load_dwordx4 v[168:171], v13, s[44:47], s19 offen offset:256 sc1
    v_mfma_f32_16x16x32_bf16 v[48:51], v[92:95], a[232:235], v[48:51]
    ds_read_b128 v[88:91], v9 offset:47104
    v_mfma_f32_16x16x32_bf16 v[52:55], v[92:95], a[236:239], v[52:55]
    s_waitcnt lgkmcnt(3)
    v_mfma_f32_16x16x32_bf16 v[56:59], v[96:99], a[232:235], v[56:59]
    ds_read_b128 v[92:95], v9 offset:48128
    v_mfma_f32_16x16x32_bf16 v[60:63], v[96:99], a[236:239], v[60:63]
    s_waitcnt lgkmcnt(3)
    s_add_u32 s19, s62, 0
    buffer_load_dwordx4 v[172:175], v13, s[44:47], s19 offen offset:0 sc1
    v_mfma_f32_16x16x32_bf16 v[48:51], v[80:83], a[240:243], v[48:51]
    v_mfma_f32_16x16x32_bf16 v[52:55], v[80:83], a[244:247], v[52:55]
    s_waitcnt lgkmcnt(2)
    v_mfma_f32_16x16x32_bf16 v[56:59], v[84:87], a[240:243], v[56:59]
    v_mfma_f32_16x16x32_bf16 v[60:63], v[84:87], a[244:247], v[60:63]
    s_waitcnt lgkmcnt(1)
    buffer_load_dwordx4 v[176:179], v13, s[44:47], s19 offen offset:256 sc1
    v_mfma_f32_16x16x32_bf16 v[48:51], v[88:91], a[248:251], v[48:51]
    v_mfma_f32_16x16x32_bf16 v[52:55], v[88:91], a[252:255], v[52:55]
    s_waitcnt lgkmcnt(0)
    v_mfma_f32_16x16x32_bf16 v[56:59], v[92:95], a[248:251], v[56:59]
    v_mfma_f32_16x16x32_bf16 v[60:63], v[92:95], a[252:255], v[60:63]
    s_add_u32 s19, s63, 0
    buffer_load_dwordx4 v[180:183], v13, s[44:47], s19 offen offset:0 sc1
    s_nop 1
    v_max_f32 v48, 0, v48
    s_nop 1
    v_mul_f32 v48, v48, v56
    v_max_f32 v49, 0, v49
    v_mul_f32 v49, v49, v57
    v_cvt_pk_bf16_f32 v120, v48, v49
    v_max_f32 v50, 0, v50
    v_mul_f32 v50, v50, v58
    v_max_f32 v51, 0, v51
    v_mul_f32 v51, v51, v59
    v_cvt_pk_bf16_f32 v121, v50, v51
    v_max_f32 v52, 0, v52
    v_mul_f32 v52, v52, v60
    v_max_f32 v53, 0, v53
    v_mul_f32 v53, v53, v61
    v_cvt_pk_bf16_f32 v122, v52, v53
    v_max_f32 v54, 0, v54
    v_mul_f32 v54, v54, v62
    v_max_f32 v55, 0, v55
    v_mul_f32 v55, v55, v63
    v_cvt_pk_bf16_f32 v123, v54, v55
    v_permlane16_swap_b32 v120, v122
    s_nop 0
    v_permlane16_swap_b32 v121, v123
    buffer_store_dwordx4 v[120:123], v8, s[44:47], s79 offen offset:2048 sc1
    buffer_load_dwordx4 v[184:187], v13, s[44:47], s19 offen offset:256 sc1
    s_add_u32 s19, s60, 114688
    buffer_load_dwordx4 v[188:191], v13, s[44:47], s19 offen offset:0 sc1
    buffer_load_dwordx4 v[192:195], v13, s[44:47], s19 offen offset:256 sc1
    buffer_load_dwordx4 v[128:131], v1, s[44:47], s76 offen sc1
    buffer_load_dwordx4 v[132:135], v1, s[44:47], s78 offen sc1
    s_add_u32 s79, s99, 65536
    s_buffer_load_dword s56, s[44:47], s79 offset:0 glc
    s_buffer_load_dword s57, s[44:47], s79 offset:128 glc
    s_buffer_load_dword s58, s[44:47], s79 offset:256 glc
    s_buffer_load_dword s59, s[44:47], s79 offset:384 glc
    s_waitcnt vmcnt(12)
    v_mfma_f32_16x16x32_bf16 v[16:19], a[0:3], v[156:159], 0
    s_add_u32 s19, s61, 114688
    buffer_load_dwordx4 v[196:199], v13, s[44:47], s19 offen offset:0 sc1
    v_mfma_f32_16x16x32_bf16 v[24:27], a[4:7], v[156:159], 0
    v_mfma_f32_16x16x32_bf16 v[32:35], a[8:11], v[156:159], 0
    v_mfma_f32_16x16x32_bf16 v[40:43], a[12:15], v[156:159], 0
    s_waitcnt vmcnt(12)
    v_mfma_f32_16x16x32_bf16 v[20:23], a[0:3], v[160:163], 0
    buffer_load_dwordx4 v[200:203], v13, s[44:47], s19 offen offset:256 sc1
    v_mfma_f32_16x16x32_bf16 v[28:31], a[4:7], v[160:163], 0
    v_and_b32 v4, 63, v0
    v_and_b32 v5, 15, v4
    v_mfma_f32_16x16x32_bf16 v[36:39], a[8:11], v[160:163], 0
    v_lshrrev_b32 v6, 4, v4
    v_lshlrev_b32 v5, 4, v5
    v_mfma_f32_16x16x32_bf16 v[44:47], a[12:15], v[160:163], 0
    s_waitcnt vmcnt(12)
    v_lshl_add_u32 v5, v6, 9, v5
    s_lshl_b32 s76, s68, 16
    v_mfma_f32_16x16x32_bf16 v[16:19], a[32:35], v[164:167], v[16:19]
    s_add_u32 s19, s62, 114688
    buffer_load_dwordx4 v[204:207], v13, s[44:47], s19 offen offset:0 sc1
    v_mfma_f32_16x16x32_bf16 v[24:27], a[36:39], v[164:167], v[24:27]
    s_and_b32 s77, s3, 1
    s_lshl_b32 s77, s77, 8
    v_mfma_f32_16x16x32_bf16 v[32:35], a[40:43], v[164:167], v[32:35]
    s_add_u32 s76, s76, s77
    s_lshr_b32 s77, s3, 1
    v_mfma_f32_16x16x32_bf16 v[40:43], a[44:47], v[164:167], v[40:43]
    s_waitcnt vmcnt(12)
    s_lshl_b32 s77, s77, 13
    s_add_u32 s76, s76, s77
    v_mfma_f32_16x16x32_bf16 v[20:23], a[32:35], v[168:171], v[20:23]
    buffer_load_dwordx4 v[208:211], v13, s[44:47], s19 offen offset:256 sc1
    v_mfma_f32_16x16x32_bf16 v[28:31], a[36:39], v[168:171], v[28:31]
    v_add_u32 v12, s76, v5
    s_lshr_b32 s21, s3, 1
    v_mfma_f32_16x16x32_bf16 v[36:39], a[40:43], v[168:171], v[36:39]
    s_and_b32 s22, s3, 1
    v_and_b32 v4, 63, v0
    v_mfma_f32_16x16x32_bf16 v[44:47], a[44:47], v[168:171], v[44:47]
    s_waitcnt vmcnt(12)
    v_and_b32 v5, 15, v4
    v_lshrrev_b32 v6, 4, v4
    s_waitcnt vmcnt(9)
    s_barrier
    s_cmp_lg_u32 s3, 0
    s_cbranch_scc1 L_pub_37
    s_lshl_b32 s82, s73, 7
    s_add_u32 s82, s82, 0x290000
    v_mov_b32 v125, 0
    s_mov_b64 exec, 1
    buffer_store_dword v2, v125, s[44:47], s82 offen sc1
    s_mov_b64 exec, -1
L_pub_37:
    v_mfma_f32_16x16x32_bf16 v[16:19], a[64:67], v[172:175], v[16:19]
    s_add_u32 s19, s63, 114688
    buffer_load_dwordx4 v[212:215], v13, s[44:47], s19 offen offset:0 sc1
    v_mfma_f32_16x16x32_bf16 v[24:27], a[68:71], v[172:175], v[24:27]
    v_mov_b32 v7, v1
    s_lshl_b32 s76, s22, 14
    v_mfma_f32_16x16x32_bf16 v[32:35], a[72:75], v[172:175], v[32:35]
    s_lshl_b32 s77, s21, 10
    s_add_u32 s76, s76, s77
    v_mfma_f32_16x16x32_bf16 v[40:43], a[76:79], v[172:175], v[40:43]
    v_add_u32 v108, s76, v7
    v_xor_b32 v109, 0x400, v108
    v_mfma_f32_16x16x32_bf16 v[20:23], a[64:67], v[176:179], v[20:23]
    buffer_load_dwordx4 v[216:219], v13, s[44:47], s19 offen offset:256 sc1
    v_mfma_f32_16x16x32_bf16 v[28:31], a[68:71], v[176:179], v[28:31]
    v_xor_b32 v110, 0x4000, v108
    v_xor_b32 v111, 0x4400, v108
    v_mfma_f32_16x16x32_bf16 v[36:39], a[72:75], v[176:179], v[36:39]
    s_lshl_b32 s76, s22, 8
    s_add_u32 s76, s76, 147456
    v_mfma_f32_16x16x32_bf16 v[44:47], a[76:79], v[176:179], v[44:47]
    v_lshl_add_u32 v113, v5, 4, s76
    v_xor_b32 v114, 0x100, v113
    v_mfma_f32_16x16x32_bf16 v[16:19], a[96:99], v[180:183], v[16:19]
    s_mov_b32 s82, 200000
    s_branch L_spc_s3e_40
L_sp_s3e_38:
    s_buffer_load_dword s56, s[44:47], s79 offset:0 glc
    s_buffer_load_dword s57, s[44:47], s79 offset:128 glc
    s_buffer_load_dword s58, s[44:47], s79 offset:256 glc
    s_buffer_load_dword s59, s[44:47], s79 offset:384 glc
    s_sub_u32 s82, s82, 1
    s_cbranch_scc1 L_TIMEOUT
L_spc_s3e_40:
    s_waitcnt lgkmcnt(0)
    s_xor_b32 s56, s56, s7
    s_xor_b32 s57, s57, s7
    s_xor_b32 s58, s58, s7
    s_xor_b32 s59, s59, s7
    s_or_b32 s56, s56, s58
    s_or_b32 s57, s57, s59
    s_or_b32 s56, s56, s57
    s_cbranch_scc1 L_sp_s3e_38
    s_add_u32 s19, s60, 2048
    buffer_load_dwordx4 v[220:223], v13, s[44:47], s19 offen offset:0 sc1
    v_mfma_f32_16x16x32_bf16 v[24:27], a[100:103], v[180:183], v[24:27]
    s_lshl_b32 s77, s21, 3
    v_add_u32 v112, s77, v113
    v_mfma_f32_16x16x32_bf16 v[32:35], a[104:107], v[180:183], v[32:35]
    v_lshrrev_b32 v7, 2, v5
    v_cmp_eq_u32 vcc, v6, v7
    v_mfma_f32_16x16x32_bf16 v[40:43], a[108:111], v[180:183], v[40:43]
    s_waitcnt vmcnt(11)
    v_lshlrev_b32 v7, 3, v4
    v_add_u32 v7, 148480, v7
    v_mfma_f32_16x16x32_bf16 v[20:23], a[96:99], v[184:187], v[20:23]
    buffer_load_dwordx4 v[224:227], v13, s[44:47], s19 offen offset:256 sc1
    v_mfma_f32_16x16x32_bf16 v[28:31], a[100:103], v[184:187], v[28:31]
    v_cndmask_b32 v112, v7, v112, vcc
    v_and_b32 v7, 3, v4
    v_mfma_f32_16x16x32_bf16 v[36:39], a[104:107], v[184:187], v[36:39]
    v_cmp_eq_u32 s[84:85], 1, v7
    v_cmp_eq_u32 s[86:87], 2, v7
    v_mfma_f32_16x16x32_bf16 v[44:47], a[108:111], v[184:187], v[44:47]
    s_waitcnt vmcnt(11)
    v_cmp_eq_u32 s[88:89], 3, v7
    s_lshl_b32 s76, s3, 10
    v_mfma_f32_16x16x32_bf16 v[48:51], a[0:3], v[188:191], 0
    s_add_u32 s19, s61, 2048
    buffer_load_dwordx4 v[228:231], v13, s[44:47], s19 offen offset:0 sc1
    v_mfma_f32_16x16x32_bf16 v[56:59], a[4:7], v[188:191], 0
    s_add_u32 s76, s76, 151552
    v_add_u32 v122, s76, v1
    v_mfma_f32_16x16x32_bf16 v[64:67], a[8:11], v[188:191], 0
    v_xor_b32 v119, 0x800, v122
    s_lshl_b32 s76, s3, 9
    v_mfma_f32_16x16x32_bf16 v[72:75], a[12:15], v[188:191], 0
    s_waitcnt vmcnt(11)
    s_add_u32 s76, s76, 155648
    v_lshl_add_u32 v117, v5, 5, s76
    v_mfma_f32_16x16x32_bf16 v[52:55], a[0:3], v[192:195], 0
    buffer_load_dwordx4 v[156:159], v13, s[44:47], s19 offen offset:256 sc1
    v_mfma_f32_16x16x32_bf16 v[60:63], a[4:7], v[192:195], 0
    v_lshl_add_u32 v117, v6, 3, v117
    v_lshrrev_b32 v7, 2, v5
    v_mfma_f32_16x16x32_bf16 v[68:71], a[8:11], v[192:195], 0
    v_lshl_add_u32 v7, v6, 2, v7
    v_lshl_add_u32 v118, v7, 5, s76
    v_mfma_f32_16x16x32_bf16 v[76:79], a[12:15], v[192:195], 0
    s_waitcnt vmcnt(9)
    v_and_b32 v7, 1, v4
    v_lshl_add_u32 v118, v7, 4, v118
    v_mfma_f32_16x16x32_bf16 v[48:51], a[32:35], v[196:199], v[48:51]
    s_add_u32 s19, s62, 2048
    buffer_load_dwordx4 v[160:163], v13, s[44:47], s19 offen offset:0 sc1
    v_mfma_f32_16x16x32_bf16 v[56:59], a[36:39], v[196:199], v[56:59]
    v_bfe_u32 v7, v4, 1, 1
    v_lshl_add_u32 v118, v7, 3, v118
    v_mfma_f32_16x16x32_bf16 v[64:67], a[40:43], v[196:199], v[64:67]
    s_lshl_b32 s76, s68, 11
    s_lshl_b32 s77, s21, 10
    v_mfma_f32_16x16x32_bf16 v[72:75], a[44:47], v[196:199], v[72:75]
    s_waitcnt vmcnt(9)
    s_add_u32 s101, s76, s77
    s_lshl_b32 s77, s22, 8
    v_mfma_f32_16x16x32_bf16 v[52:55], a[32:35], v[200:203], v[52:55]
    buffer_load_dwordx4 v[164:167], v13, s[44:47], s19 offen offset:256 sc1
    v_mfma_f32_16x16x32_bf16 v[60:63], a[36:39], v[200:203], v[60:63]
    s_add_u32 s101, s101, s77
    s_lshl_b32 s77, s3, 9
    v_mfma_f32_16x16x32_bf16 v[68:71], a[40:43], v[200:203], v[68:71]
    s_add_u32 s76, s76, s77
    s_add_u32 s76, s76, 0x10000
    v_mfma_f32_16x16x32_bf16 v[76:79], a[44:47], v[200:203], v[76:79]
    s_waitcnt vmcnt(9)
    s_cmp_eq_u32 s69, 0
    s_cselect_b32 s101, s101, s76
    s_cselect_b32 s77, 9, 8
    s_add_u32 s101, s101, 0x200000
    v_mfma_f32_16x16x32_bf16 v[48:51], a[64:67], v[204:207], v[48:51]
    s_add_u32 s19, s63, 2048
    buffer_load_dwordx4 v[168:171], v13, s[44:47], s19 offen offset:0 sc1
    v_mfma_f32_16x16x32_bf16 v[56:59], a[68:71], v[204:207], v[56:59]
    v_lshrrev_b32 v7, 1, v6
    v_lshlrev_b32 v7, s77, v7
    v_mfma_f32_16x16x32_bf16 v[64:67], a[72:75], v[204:207], v[64:67]
    v_lshl_add_u32 v116, v5, 4, v7
    v_and_b32 v7, 1, v6
    v_mfma_f32_16x16x32_bf16 v[72:75], a[76:79], v[204:207], v[72:75]
    s_waitcnt vmcnt(9)
    v_xor_b32 v7, s22, v7
    v_lshlrev_b32 v115, 14, v7
    v_mfma_f32_16x16x32_bf16 v[52:55], a[64:67], v[208:211], v[52:55]
    buffer_load_dwordx4 v[172:175], v13, s[44:47], s19 offen offset:256 sc1
    v_mfma_f32_16x16x32_bf16 v[60:63], a[68:71], v[208:211], v[60:63]
    v_lshrrev_b32 v7, 3, v5
    v_lshl_add_u32 v115, v7, 13, v115
    v_mfma_f32_16x16x32_bf16 v[68:71], a[72:75], v[208:211], v[68:71]
    v_lshrrev_b32 v7, 1, v6
    v_lshl_add_u32 v115, v7, 9, v115
    v_mfma_f32_16x16x32_bf16 v[76:79], a[76:79], v[208:211], v[76:79]
    s_waitcnt vmcnt(9)
    v_and_b32 v7, 7, v5
    v_lshl_add_u32 v115, v7, 4, v115
    v_mfma_f32_16x16x32_bf16 v[48:51], a[96:99], v[212:215], v[48:51]
    s_add_u32 s19, s18, 4096
    buffer_load_dwordx4 v[176:179], v15, s[44:47], s19 offen offset:0 sc1
    v_mfma_f32_16x16x32_bf16 v[56:59], a[100:103], v[212:215], v[56:59]
    s_lshl_b32 s100, s68, 16
    s_lshl_b32 s76, s69, 10
    v_mfma_f32_16x16x32_bf16 v[64:67], a[104:107], v[212:215], v[64:67]
    s_add_u32 s100, s100, s76
    s_lshl_b32 s76, s3, 7
    v_mfma_f32_16x16x32_bf16 v[72:75], a[108:111], v[212:215], v[72:75]
    s_waitcnt vmcnt(9)
    s_add_u32 s100, s100, s76
    v_lshrrev_b32 v7, 2, v5
    s_buffer_load_dword s56, s[44:47], s99 offset:0 glc
    s_buffer_load_dword s57, s[44:47], s99 offset:128 glc
    s_buffer_load_dword s58, s[44:47], s99 offset:256 glc
    s_buffer_load_dword s59, s[44:47], s99 offset:384 glc
    v_mfma_f32_16x16x32_bf16 v[52:55], a[96:99], v[216:219], v[52:55]
    buffer_load_dwordx4 v[180:183], v15, s[44:47], s19 offen offset:256 sc1
    v_mfma_f32_16x16x32_bf16 v[60:63], a[100:103], v[216:219], v[60:63]
    v_lshl_add_u32 v7, v6, 3, v7
    v_and_b32 v4, 3, v4
    v_mfma_f32_16x16x32_bf16 v[68:71], a[104:107], v[216:219], v[68:71]
    s_lshl_b32 s76, s21, 10
    s_add_u32 s76, s76, 131072
    v_mfma_f32_16x16x32_bf16 v[76:79], a[108:111], v[216:219], v[76:79]
    s_waitcnt vmcnt(9)
    v_lshl_add_u32 v120, v7, 5, s76
    v_lshl_add_u32 v120, v4, 3, v120
    v_mfma_f32_16x16x32_bf16 v[16:19], a[16:19], v[220:223], v[16:19]
    s_add_u32 s19, s18, 18432
    buffer_load_dwordx4 v[184:187], v15, s[44:47], s19 offen offset:0 sc1
    v_mfma_f32_16x16x32_bf16 v[24:27], a[20:23], v[220:223], v[24:27]
    v_xor_b32 v121, 0x400, v120
    v_lshrrev_b32 v5, 3, v5
    v_mfma_f32_16x16x32_bf16 v[32:35], a[24:27], v[220:223], v[32:35]
    v_and_b32 v6, 1, v6
    v_lshl_add_u32 v5, v6, 1, v5
    v_mfma_f32_16x16x32_bf16 v[40:43], a[28:31], v[220:223], v[40:43]
    s_waitcnt vmcnt(9)
    v_xor_b32 v5, s3, v5
    s_lshl_b32 s76, s21, 12
    v_mfma_f32_16x16x32_bf16 v[20:23], a[16:19], v[224:227], v[20:23]
    buffer_load_dwordx4 v[188:191], v15, s[44:47], s19 offen offset:256 sc1
    v_mfma_f32_16x16x32_bf16 v[28:31], a[20:23], v[224:227], v[28:31]
    s_add_u32 s76, s76, 65536
    v_lshl_add_u32 v8, v7, 7, s76
    v_mfma_f32_16x16x32_bf16 v[36:39], a[24:27], v[224:227], v[36:39]
    v_lshl_add_u32 v8, v5, 5, v8
    v_lshl_add_u32 v8, v4, 3, v8
    v_mfma_f32_16x16x32_bf16 v[44:47], a[28:31], v[224:227], v[44:47]
    s_waitcnt vmcnt(9)
    v_xor_b32 v9, 0x1000, v8
    s_cmp_eq_u32 s21, 1
    s_cselect_b64 s[24:25], -1, 0
    v_mfma_f32_16x16x32_bf16 v[16:19], a[48:51], v[228:231], v[16:19]
    s_add_u32 s19, s60, 116736
    buffer_load_dwordx4 v[192:195], v13, s[44:47], s19 offen offset:0 sc1
    v_mfma_f32_16x16x32_bf16 v[24:27], a[52:55], v[228:231], v[24:27]
    v_mfma_f32_16x16x32_bf16 v[32:35], a[56:59], v[228:231], v[32:35]
    v_mfma_f32_16x16x32_bf16 v[40:43], a[60:63], v[228:231], v[40:43]
    s_waitcnt vmcnt(9)
    v_mfma_f32_16x16x32_bf16 v[20:23], a[48:51], v[156:159], v[20:23]
    buffer_load_dwordx4 v[196:199], v13, s[44:47], s19 offen offset:256 sc1
    v_mfma_f32_16x16x32_bf16 v[28:31], a[52:55], v[156:159], v[28:31]
    v_mfma_f32_16x16x32_bf16 v[36:39], a[56:59], v[156:159], v[36:39]
    v_mfma_f32_16x16x32_bf16 v[44:47], a[60:63], v[156:159], v[44:47]
    s_waitcnt vmcnt(9)
    v_mfma_f32_16x16x32_bf16 v[16:19], a[80:83], v[160:163], v[16:19]
    s_add_u32 s19, s61, 116736
    buffer_load_dwordx4 v[200:203], v13, s[44:47], s19 offen offset:0 sc1
    v_mfma_f32_16x16x32_bf16 v[24:27], a[84:87], v[160:163], v[24:27]
    v_lshlrev_b32 v136, 16, v128
    v_and_b32 v137, 0xffff0000, v128
    v_mfma_f32_16x16x32_bf16 v[32:35], a[88:91], v[160:163], v[32:35]
    v_lshlrev_b32 v138, 16, v129
    v_and_b32 v139, 0xffff0000, v129
    v_mfma_f32_16x16x32_bf16 v[40:43], a[92:95], v[160:163], v[40:43]
    s_waitcnt vmcnt(9)
    v_lshlrev_b32 v140, 16, v130
    v_and_b32 v141, 0xffff0000, v130
    v_mfma_f32_16x16x32_bf16 v[20:23], a[80:83], v[164:167], v[20:23]
    buffer_load_dwordx4 v[204:207], v13, s[44:47], s19 offen offset:256 sc1
    v_mfma_f32_16x16x32_bf16 v[28:31], a[84:87], v[164:167], v[28:31]
    v_lshlrev_b32 v142, 16, v131
    v_and_b32 v143, 0xffff0000, v131
    v_mfma_f32_16x16x32_bf16 v[36:39], a[88:91], v[164:167], v[36:39]
    v_lshlrev_b32 v144, 16, v132
    v_and_b32 v145, 0xffff0000, v132
    v_mfma_f32_16x16x32_bf16 v[44:47], a[92:95], v[164:167], v[44:47]
    s_waitcnt vmcnt(9)
    v_lshlrev_b32 v146, 16, v133
    v_and_b32 v147, 0xffff0000, v133
    v_mfma_f32_16x16x32_bf16 v[16:19], a[112:115], v[168:171], v[16:19]
    s_mov_b32 s82, 200000
    s_branch L_spc_s3f_43
L_sp_s3f_41:
    s_buffer_load_dword s56, s[44:47], s99 offset:0 glc
    s_buffer_load_dword s57, s[44:47], s99 offset:128 glc
    s_buffer_load_dword s58, s[44:47], s99 offset:256 glc
    s_buffer_load_dword s59, s[44:47], s99 offset:384 glc
    s_sub_u32 s82, s82, 1
    s_cbranch_scc1 L_TIMEOUT
L_spc_s3f_43:
    s_waitcnt lgkmcnt(0)
    s_xor_b32 s56, s56, s7
    s_xor_b32 s57, s57, s7
    s_xor_b32 s58, s58, s7
    s_xor_b32 s59, s59, s7
    s_or_b32 s56, s56, s58
    s_or_b32 s57, s57, s59
    s_or_b32 s56, s56, s57
    s_cbranch_scc1 L_sp_s3f_41
    s_add_u32 s19, s60, 5120
    buffer_load_dwordx4 v[208:211], v13, s[44:47], s19 offen offset:0 sc1
    v_mfma_f32_16x16x32_bf16 v[24:27], a[116:119], v[168:171], v[24:27]
    v_lshlrev_b32 v148, 16, v134
    v_and_b32 v149, 0xffff0000, v134
    v_mfma_f32_16x16x32_bf16 v[32:35], a[120:123], v[168:171], v[32:35]
    v_lshlrev_b32 v150, 16, v135
    v_and_b32 v151, 0xffff0000, v135
    v_mfma_f32_16x16x32_bf16 v[40:43], a[124:127], v[168:171], v[40:43]
    s_waitcnt vmcnt(9)
    v_permlane16_swap_b32 v136, v140
    v_permlane16_swap_b32 v137, v141
    v_mfma_f32_16x16x32_bf16 v[20:23], a[112:115], v[172:175], v[20:23]
    buffer_load_dwordx4 v[212:215], v13, s[44:47], s19 offen offset:256 sc1
    v_mfma_f32_16x16x32_bf16 v[28:31], a[116:119], v[172:175], v[28:31]
    v_permlane16_swap_b32 v138, v142
    v_permlane16_swap_b32 v139, v143
    v_mfma_f32_16x16x32_bf16 v[36:39], a[120:123], v[172:175], v[36:39]
    v_permlane16_swap_b32 v144, v148
    v_permlane16_swap_b32 v145, v149
    v_mfma_f32_16x16x32_bf16 v[44:47], a[124:127], v[172:175], v[44:47]
    s_waitcnt vmcnt(9)
    v_permlane16_swap_b32 v146, v150
    v_permlane16_swap_b32 v147, v151
    v_mfma_f32_16x16x32_bf16 v[16:19], a[128:131], v[176:179], v[16:19]
    s_add_u32 s19, s61, 5120
    buffer_load_dwordx4 v[216:219], v13, s[44:47], s19 offen offset:0 sc1
    v_mfma_f32_16x16x32_bf16 v[24:27], a[132:135], v[176:179], v[24:27]
    s_and_b32 s99, s3, 1
    s_lshl_b32 s99, s99, 14
    s_lshr_b32 s95, s3, 1
    s_lshl_b32 s95, s95, 12
    s_add_u32 s99, s99, s95
    v_mfma_f32_16x16x32_bf16 v[32:35], a[136:139], v[176:179], v[32:35]
    v_mfma_f32_16x16x32_bf16 v[40:43], a[140:143], v[176:179], v[40:43]
    s_waitcnt vmcnt(9)
    v_mfma_f32_16x16x32_bf16 v[20:23], a[128:131], v[180:183], v[20:23]
    buffer_load_dwordx4 v[220:223], v13, s[44:47], s19 offen offset:256 sc1
    v_mfma_f32_16x16x32_bf16 v[28:31], a[132:135], v[180:183], v[28:31]
    v_mfma_f32_16x16x32_bf16 v[36:39], a[136:139], v[180:183], v[36:39]
    v_mfma_f32_16x16x32_bf16 v[44:47], a[140:143], v[180:183], v[44:47]
    s_waitcnt vmcnt(9)
    v_mfma_f32_16x16x32_bf16 v[16:19], a[144:147], v[184:187], v[16:19]
    s_add_u32 s19, s62, 5120
    buffer_load_dwordx4 v[224:227], v13, s[44:47], s19 offen offset:0 sc1
    v_mfma_f32_16x16x32_bf16 v[24:27], a[148:151], v[184:187], v[24:27]
    v_mfma_f32_16x16x32_bf16 v[32:35], a[152:155], v[184:187], v[32:35]
    v_mfma_f32_16x16x32_bf16 v[40:43], a[156:159], v[184:187], v[40:43]
    s_waitcnt vmcnt(9)
    v_mfma_f32_16x16x32_bf16 v[20:23], a[144:147], v[188:191], v[20:23]
    buffer_load_dwordx4 v[228:231], v13, s[44:47], s19 offen offset:256 sc1
    v_mfma_f32_16x16x32_bf16 v[28:31], a[148:151], v[188:191], v[28:31]
    v_mfma_f32_16x16x32_bf16 v[36:39], a[152:155], v[188:191], v[36:39]
    v_mfma_f32_16x16x32_bf16 v[44:47], a[156:159], v[188:191], v[44:47]
    s_waitcnt vmcnt(9)
    v_mfma_f32_16x16x32_bf16 v[48:51], a[16:19], v[192:195], v[48:51]
    s_add_u32 s19, s63, 5120
    buffer_load_dwordx4 v[156:159], v13, s[44:47], s19 offen offset:0 sc1
    v_mfma_f32_16x16x32_bf16 v[56:59], a[20:23], v[192:195], v[56:59]
    v_mfma_f32_16x16x32_bf16 v[64:67], a[24:27], v[192:195], v[64:67]
    v_mfma_f32_16x16x32_bf16 v[72:75], a[28:31], v[192:195], v[72:75]
    s_waitcnt vmcnt(9)
    v_mfma_f32_16x16x32_bf16 v[52:55], a[16:19], v[196:199], v[52:55]
    buffer_load_dwordx4 v[160:163], v13, s[44:47], s19 offen offset:256 sc1
    v_mfma_f32_16x16x32_bf16 v[60:63], a[20:23], v[196:199], v[60:63]
    v_mfma_f32_16x16x32_bf16 v[68:71], a[24:27], v[196:199], v[68:71]
    v_mfma_f32_16x16x32_bf16 v[76:79], a[28:31], v[196:199], v[76:79]
    s_waitcnt vmcnt(9)
    v_mfma_f32_16x16x32_bf16 v[48:51], a[48:51], v[200:203], v[48:51]
    s_add_u32 s19, s62, 116736
    buffer_load_dwordx4 v[164:167], v13, s[44:47], s19 offen offset:0 sc1
    v_mfma_f32_16x16x32_bf16 v[56:59], a[52:55], v[200:203], v[56:59]
    s_sub_u32 s78, s3, 0
    s_and_b32 s78, s78, 3
    v_mfma_f32_16x16x32_bf16 v[64:67], a[56:59], v[200:203], v[64:67]
    s_lshl_b32 s78, s78, 11
    v_add_u32 v128, s78, v1
    v_mfma_f32_16x16x32_bf16 v[72:75], a[60:63], v[200:203], v[72:75]
    s_waitcnt vmcnt(9)
    v_mfma_f32_16x16x32_bf16 v[52:55], a[48:51], v[204:207], v[52:55]
    buffer_load_dwordx4 v[168:171], v13, s[44:47], s19 offen offset:256 sc1
    v_mfma_f32_16x16x32_bf16 v[60:63], a[52:55], v[204:207], v[60:63]
    s_sub_u32 s78, s3, 1
    s_and_b32 s78, s78, 3
    v_mfma_f32_16x16x32_bf16 v[68:71], a[56:59], v[204:207], v[68:71]
    s_lshl_b32 s78, s78, 11
    v_add_u32 v129, s78, v1
    v_mfma_f32_16x16x32_bf16 v[76:79], a[60:63], v[204:207], v[76:79]
    s_waitcnt vmcnt(9)
    v_mfma_f32_16x16x32_bf16 v[16:19], a[160:163], v[208:211], v[16:19]
    s_add_u32 s19, s63, 116736
    buffer_load_dwordx4 v[172:175], v13, s[44:47], s19 offen offset:0 sc1
    v_mfma_f32_16x16x32_bf16 v[24:27], a[164:167], v[208:211], v[24:27]
    s_sub_u32 s78, s3, 2
    s_and_b32 s78, s78, 3
    v_mfma_f32_16x16x32_bf16 v[32:35], a[168:171], v[208:211], v[32:35]
    s_lshl_b32 s78, s78, 11
    v_add_u32 v130, s78, v1
    v_mfma_f32_16x16x32_bf16 v[40:43], a[172:175], v[208:211], v[40:43]
    s_waitcnt vmcnt(9)
    v_mfma_f32_16x16x32_bf16 v[20:23], a[160:163], v[212:215], v[20:23]
    buffer_load_dwordx4 v[176:179], v13, s[44:47], s19 offen offset:256 sc1
    v_mfma_f32_16x16x32_bf16 v[28:31], a[164:167], v[212:215], v[28:31]
    s_sub_u32 s78, s3, 3
    s_and_b32 s78, s78, 3
    v_mfma_f32_16x16x32_bf16 v[36:39], a[168:171], v[212:215], v[36:39]
    s_lshl_b32 s78, s78, 11
    v_add_u32 v131, s78, v1
    v_mfma_f32_16x16x32_bf16 v[44:47], a[172:175], v[212:215], v[44:47]
    s_waitcnt vmcnt(9)
    v_mfma_f32_16x16x32_bf16 v[16:19], a[176:179], v[216:219], v[16:19]
    s_add_u32 s19, s18, 118784
    buffer_load_dwordx4 v[180:183], v15, s[44:47], s19 offen offset:0 sc1
    v_mfma_f32_16x16x32_bf16 v[24:27], a[180:183], v[216:219], v[24:27]
    v_mfma_f32_16x16x32_bf16 v[32:35], a[184:187], v[216:219], v[32:35]
    v_mfma_f32_16x16x32_bf16 v[40:43], a[188:191], v[216:219], v[40:43]
    s_waitcnt vmcnt(9)
    v_mfma_f32_16x16x32_bf16 v[20:23], a[176:179], v[220:223], v[20:23]
    buffer_load_dwordx4 v[184:187], v15, s[44:47], s19 offen offset:256 sc1
    v_mfma_f32_16x16x32_bf16 v[28:31], a[180:183], v[220:223], v[28:31]
    v_mfma_f32_16x16x32_bf16 v[36:39], a[184:187], v[220:223], v[36:39]
    v_mfma_f32_16x16x32_bf16 v[44:47], a[188:191], v[220:223], v[44:47]
    s_waitcnt vmcnt(9)
    v_mfma_f32_16x16x32_bf16 v[16:19], a[192:195], v[224:227], v[16:19]
    s_add_u32 s19, s18, 133120
    buffer_load_dwordx4 v[188:191], v15, s[44:47], s19 offen offset:0 sc1
    v_mfma_f32_16x16x32_bf16 v[24:27], a[196:199], v[224:227], v[24:27]
    v_mfma_f32_16x16x32_bf16 v[32:35], a[200:203], v[224:227], v[32:35]
    v_mfma_f32_16x16x32_bf16 v[40:43], a[204:207], v[224:227], v[40:43]
    s_waitcnt vmcnt(9)
    v_mfma_f32_16x16x32_bf16 v[20:23], a[192:195], v[228:231], v[20:23]
    buffer_load_dwordx4 v[192:195], v15, s[44:47], s19 offen offset:256 sc1
    v_mfma_f32_16x16x32_bf16 v[28:31], a[196:199], v[228:231], v[28:31]
    v_mfma_f32_16x16x32_bf16 v[36:39], a[200:203], v[228:231], v[36:39]
    v_mfma_f32_16x16x32_bf16 v[44:47], a[204:207], v[228:231], v[44:47]
    s_waitcnt vmcnt(9)
    v_mfma_f32_16x16x32_bf16 v[16:19], a[208:211], v[156:159], v[16:19]
    s_add_u32 s19, s60, 119808
    buffer_load_dwordx4 v[196:199], v13, s[44:47], s19 offen offset:0 sc1
    v_mfma_f32_16x16x32_bf16 v[24:27], a[212:215], v[156:159], v[24:27]
    v_mfma_f32_16x16x32_bf16 v[32:35], a[216:219], v[156:159], v[32:35]
    v_mfma_f32_16x16x32_bf16 v[40:43], a[220:223], v[156:159], v[40:43]
    s_waitcnt vmcnt(9)
    v_mfma_f32_16x16x32_bf16 v[20:23], a[208:211], v[160:163], v[20:23]
    s_add_u32 s19, s61, 119808
    buffer_load_dwordx4 v[200:203], v13, s[44:47], s19 offen offset:0 sc1
    v_mfma_f32_16x16x32_bf16 v[28:31], a[212:215], v[160:163], v[28:31]
    v_mfma_f32_16x16x32_bf16 v[36:39], a[216:219], v[160:163], v[36:39]
    v_mfma_f32_16x16x32_bf16 v[44:47], a[220:223], v[160:163], v[44:47]
    s_waitcnt vmcnt(9)
    v_mfma_f32_16x16x32_bf16 v[48:51], a[80:83], v[164:167], v[48:51]
    s_add_u32 s19, s62, 119808
    buffer_load_dwordx4 v[204:207], v13, s[44:47], s19 offen offset:0 sc1
    v_mfma_f32_16x16x32_bf16 v[56:59], a[84:87], v[164:167], v[56:59]
    v_mfma_f32_16x16x32_bf16 v[64:67], a[88:91], v[164:167], v[64:67]
    v_mfma_f32_16x16x32_bf16 v[72:75], a[92:95], v[164:167], v[72:75]
    s_waitcnt vmcnt(9)
    v_mfma_f32_16x16x32_bf16 v[52:55], a[80:83], v[168:171], v[52:55]
    s_add_u32 s19, s63, 119808
    buffer_load_dwordx4 v[208:211], v13, s[44:47], s19 offen offset:0 sc1
    v_mfma_f32_16x16x32_bf16 v[60:63], a[84:87], v[168:171], v[60:63]
    ds_write_b128 v153, v[16:19] offset:0
    v_mfma_f32_16x16x32_bf16 v[68:71], a[88:91], v[168:171], v[68:71]
    ds_write_b128 v153, v[20:23] offset:1024
    v_mfma_f32_16x16x32_bf16 v[76:79], a[92:95], v[168:171], v[76:79]
    s_waitcnt vmcnt(9)
    v_mfma_f32_16x16x32_bf16 v[48:51], a[112:115], v[172:175], v[48:51]
    s_add_u32 s19, s60, 119808
    buffer_load_dwordx4 v[212:215], v13, s[44:47], s19 offen offset:256 sc1
    v_mfma_f32_16x16x32_bf16 v[56:59], a[116:119], v[172:175], v[56:59]
    ds_write_b128 v153, v[24:27] offset:8192
    v_mfma_f32_16x16x32_bf16 v[64:67], a[120:123], v[172:175], v[64:67]
    ds_write_b128 v153, v[28:31] offset:9216
    v_mfma_f32_16x16x32_bf16 v[72:75], a[124:127], v[172:175], v[72:75]
    s_waitcnt vmcnt(9)
    v_mfma_f32_16x16x32_bf16 v[52:55], a[112:115], v[176:179], v[52:55]
    s_add_u32 s19, s61, 119808
    buffer_load_dwordx4 v[216:219], v13, s[44:47], s19 offen offset:256 sc1
    v_mfma_f32_16x16x32_bf16 v[60:63], a[116:119], v[176:179], v[60:63]
    ds_write_b128 v153, v[32:35] offset:16384
    v_mfma_f32_16x16x32_bf16 v[68:71], a[120:123], v[176:179], v[68:71]
    ds_write_b128 v153, v[36:39] offset:17408
    v_mfma_f32_16x16x32_bf16 v[76:79], a[124:127], v[176:179], v[76:79]
    s_waitcnt vmcnt(9)
    v_mfma_f32_16x16x32_bf16 v[48:51], a[128:131], v[180:183], v[48:51]
    s_add_u32 s19, s62, 119808
    buffer_load_dwordx4 v[220:223], v13, s[44:47], s19 offen offset:256 sc1
    v_mfma_f32_16x16x32_bf16 v[56:59], a[132:135], v[180:183], v[56:59]
    ds_write_b128 v153, v[40:43] offset:24576
    v_mfma_f32_16x16x32_bf16 v[64:67], a[136:139], v[180:183], v[64:67]
    ds_write_b128 v153, v[44:47] offset:25600
    v_mfma_f32_16x16x32_bf16 v[72:75], a[140:143], v[180:183], v[72:75]
    s_waitcnt vmcnt(9)
    v_mfma_f32_16x16x32_bf16 v[52:55], a[128:131], v[184:187], v[52:55]
    s_add_u32 s19, s63, 119808
    buffer_load_dwordx4 v[224:227], v13, s[44:47], s19 offen offset:256 sc1
    v_mfma_f32_16x16x32_bf16 v[60:63], a[132:135], v[184:187], v[60:63]
    v_mfma_f32_16x16x32_bf16 v[68:71], a[136:139], v[184:187], v[68:71]
    v_mfma_f32_16x16x32_bf16 v[76:79], a[140:143], v[184:187], v[76:79]
    s_waitcnt vmcnt(9)
    s_cmp_eq_u32 s6, 0
    s_cbranch_scc1 L_TAIL0
    v_mfma_f32_16x16x32_bf16 v[48:51], a[144:147], v[188:191], v[48:51]
    s_waitcnt lgkmcnt(0)
    s_barrier
    v_mfma_f32_16x16x32_bf16 v[56:59], a[148:151], v[188:191], v[56:59]
    ds_read_b128 v[232:235], v154 offset:0
    v_mfma_f32_16x16x32_bf16 v[64:67], a[152:155], v[188:191], v[64:67]
    ds_read_b128 v[236:239], v154 offset:1024
    v_mfma_f32_16x16x32_bf16 v[72:75], a[156:159], v[188:191], v[72:75]
    s_waitcnt vmcnt(8)
    ds_read_b128 v[240:243], v154 offset:2048
    v_mfma_f32_16x16x32_bf16 v[52:55], a[144:147], v[192:195], v[52:55]
    ds_read_b128 v[244:247], v154 offset:3072
    v_mfma_f32_16x16x32_bf16 v[60:63], a[148:151], v[192:195], v[60:63]
    ds_read_b128 v[248:251], v154 offset:4096
    v_mfma_f32_16x16x32_bf16 v[68:71], a[152:155], v[192:195], v[68:71]
    ds_read_b128 v[252:255], v154 offset:5120
    v_mfma_f32_16x16x32_bf16 v[76:79], a[156:159], v[192:195], v[76:79]
    s_waitcnt vmcnt(7)
    ds_read_b128 v[84:87], v154 offset:6144
    v_mfma_f32_16x16x32_bf16 v[48:51], a[160:163], v[196:199], v[48:51]
    ds_read_b128 v[88:91], v154 offset:7168
    v_mfma_f32_16x16x32_bf16 v[56:59], a[164:167], v[196:199], v[56:59]
    s_waitcnt lgkmcnt(0)
    v_add_f32 v232, v232, v240
    v_mfma_f32_16x16x32_bf16 v[64:67], a[168:171], v[196:199], v[64:67]
    v_add_f32 v84, v84, v248
    v_add_f32 v232, v232, v136
    v_mfma_f32_16x16x32_bf16 v[72:75], a[172:175], v[196:199], v[72:75]
    s_waitcnt vmcnt(6)
    v_add_f32 v233, v233, v241
    v_add_f32 v85, v85, v249
    v_mfma_f32_16x16x32_bf16 v[48:51], a[176:179], v[200:203], v[48:51]
    v_add_f32 v233, v233, v137
    v_add_f32 v234, v234, v242
    v_mfma_f32_16x16x32_bf16 v[56:59], a[180:183], v[200:203], v[56:59]
    v_add_f32 v86, v86, v250
    v_add_f32 v234, v234, v138
    v_mfma_f32_16x16x32_bf16 v[64:67], a[184:187], v[200:203], v[64:67]
    v_add_f32 v235, v235, v243
    v_add_f32 v87, v87, v251
    v_mfma_f32_16x16x32_bf16 v[72:75], a[188:191], v[200:203], v[72:75]
    s_waitcnt vmcnt(5)
    v_add_f32 v235, v235, v139
    v_add_f32 v236, v236, v244
    v_mfma_f32_16x16x32_bf16 v[48:51], a[192:195], v[204:207], v[48:51]
    v_add_f32 v88, v88, v252
    v_add_f32 v236, v236, v140
    v_mfma_f32_16x16x32_bf16 v[56:59], a[196:199], v[204:207], v[56:59]
    v_add_f32 v237, v237, v245
    v_add_f32 v89, v89, v253
    v_mfma_f32_16x16x32_bf16 v[64:67], a[200:203], v[204:207], v[64:67]
    v_add_f32 v237, v237, v141
    v_add_f32 v238, v238, v246
    v_mfma_f32_16x16x32_bf16 v[72:75], a[204:207], v[204:207], v[72:75]
    s_waitcnt vmcnt(4)
    v_add_f32 v90, v90, v254
    v_add_f32 v238, v238, v142
    v_mfma_f32_16x16x32_bf16 v[48:51], a[208:211], v[208:211], v[48:51]
    v_add_f32 v239, v239, v247
    v_add_f32 v91, v91, v255
    v_mfma_f32_16x16x32_bf16 v[56:59], a[212:215], v[208:211], v[56:59]
    v_add_f32 v239, v239, v143
    v_add_f32 v232, v232, v84
    v_mfma_f32_16x16x32_bf16 v[64:67], a[216:219], v[208:211], v[64:67]
    v_add_f32 v233, v233, v85
    v_cvt_pk_bf16_f32 v92, v232, v233
    v_mfma_f32_16x16x32_bf16 v[72:75], a[220:223], v[208:211], v[72:75]
    s_waitcnt vmcnt(3)
    v_add_f32 v234, v234, v86
    v_add_f32 v235, v235, v87
    v_mfma_f32_16x16x32_bf16 v[52:55], a[160:163], v[212:215], v[52:55]
    v_cvt_pk_bf16_f32 v93, v234, v235
    v_add_f32 v236, v236, v88
    v_mfma_f32_16x16x32_bf16 v[60:63], a[164:167], v[212:215], v[60:63]
    v_add_f32 v237, v237, v89
    v_cvt_pk_bf16_f32 v94, v236, v237
    v_mfma_f32_16x16x32_bf16 v[68:71], a[168:171], v[212:215], v[68:71]
    v_add_f32 v238, v238, v90
    v_add_f32 v239, v239, v91
    v_mfma_f32_16x16x32_bf16 v[76:79], a[172:175], v[212:215], v[76:79]
    s_waitcnt vmcnt(2)
    v_cvt_pk_bf16_f32 v95, v238, v239
    s_nop 0
    v_permlane16_swap_b32 v92, v94
    v_permlane16_swap_b32 v93, v95
    v_mfma_f32_16x16x32_bf16 v[52:55], a[176:179], v[216:219], v[52:55]
    ds_write_b128 v128, v[48:51] offset:32768
    v_mfma_f32_16x16x32_bf16 v[60:63], a[180:183], v[216:219], v[60:63]
    ds_write_b128 v129, v[56:59] offset:40960
    v_mfma_f32_16x16x32_bf16 v[68:71], a[184:187], v[216:219], v[68:71]
    s_mov_b32 s78, 0
    buffer_store_dwordx4 v[92:95], v152, s[52:55], s78 offen
    v_mfma_f32_16x16x32_bf16 v[76:79], a[188:191], v[216:219], v[76:79]
    s_waitcnt vmcnt(2)
    v_mfma_f32_16x16x32_bf16 v[52:55], a[192:195], v[220:223], v[52:55]
    ds_write_b128 v130, v[64:67] offset:49152
    v_mfma_f32_16x16x32_bf16 v[60:63], a[196:199], v[220:223], v[60:63]
    ds_write_b128 v131, v[72:75] offset:57344
    v_mfma_f32_16x16x32_bf16 v[68:71], a[200:203], v[220:223], v[68:71]
    v_mfma_f32_16x16x32_bf16 v[76:79], a[204:207], v[220:223], v[76:79]
    s_waitcnt vmcnt(1)
    v_mfma_f32_16x16x32_bf16 v[52:55], a[208:211], v[224:227], v[52:55]
    v_mfma_f32_16x16x32_bf16 v[60:63], a[212:215], v[224:227], v[60:63]
    v_mfma_f32_16x16x32_bf16 v[68:71], a[216:219], v[224:227], v[68:71]
    v_mfma_f32_16x16x32_bf16 v[76:79], a[220:223], v[224:227], v[76:79]
    s_nop 5
    s_cmp_eq_u32 s3, 1
    s_cbranch_scc1 L_rlw_46
    s_cmp_eq_u32 s3, 2
    s_cbranch_scc1 L_rlw_47
    s_cmp_eq_u32 s3, 3
    s_cbranch_scc1 L_rlw_48
L_rlw_45:
    ds_write_b128 v1, v[60:63] offset:48128
    ds_write_b128 v1, v[68:71] offset:54272
    ds_write_b128 v1, v[76:79] offset:60416
    v_add_f32 v84, v48, v144
    v_add_f32 v85, v49, v145
    v_add_f32 v86, v50, v146
    v_add_f32 v87, v51, v147
    v_add_f32 v88, v52, v148
    v_add_f32 v89, v53, v149
    v_add_f32 v90, v54, v150
    v_add_f32 v91, v55, v151
    s_branch L_rl_44
L_rlw_46:
    ds_write_b128 v1, v[68:71] offset:56320
    ds_write_b128 v1, v[76:79] offset:62464
    ds_write_b128 v1, v[52:55] offset:35840
    v_add_f32 v84, v56, v144
    v_add_f32 v85, v57, v145
    v_add_f32 v86, v58, v146
    v_add_f32 v87, v59, v147
    v_add_f32 v88, v60, v148
    v_add_f32 v89, v61, v149
    v_add_f32 v90, v62, v150
    v_add_f32 v91, v63, v151
    s_branch L_rl_44
L_rlw_47:
    ds_write_b128 v1, v[76:79] offset:64512
    ds_write_b128 v1, v[52:55] offset:37888
    ds_write_b128 v1, v[60:63] offset:44032
    v_add_f32 v84, v64, v144
    v_add_f32 v85, v65, v145
    v_add_f32 v86, v66, v146
    v_add_f32 v87, v67, v147
    v_add_f32 v88, v68, v148
    v_add_f32 v89, v69, v149
    v_add_f32 v90, v70, v150
    v_add_f32 v91, v71, v151
    s_branch L_rl_44
L_rlw_48:
    ds_write_b128 v1, v[52:55] offset:39936
    ds_write_b128 v1, v[60:63] offset:46080
    ds_write_b128 v1, v[68:71] offset:52224
    v_add_f32 v84, v72, v144
    v_add_f32 v85, v73, v145
    v_add_f32 v86, v74, v146
    v_add_f32 v87, v75, v147
    v_add_f32 v88, v76, v148
    v_add_f32 v89, v77, v149
    v_add_f32 v90, v78, v150
    v_add_f32 v91, v79, v151
L_rl_44:
    s_waitcnt lgkmcnt(0)
    s_barrier
    ds_read_b128 v[232:235], v154 offset:34816
    ds_read_b128 v[236:239], v154 offset:35840
    ds_read_b128 v[240:243], v154 offset:36864
    ds_read_b128 v[244:247], v154 offset:37888
    ds_read_b128 v[248:251], v154 offset:38912
    ds_read_b128 v[252:255], v154 offset:39936
    s_waitcnt lgkmcnt(4)
    v_add_f32 v84, v84, v232
    v_add_f32 v85, v85, v233
    v_add_f32 v86, v86, v234
    v_add_f32 v87, v87, v235
    v_add_f32 v88, v88, v236
    v_add_f32 v89, v89, v237
    v_add_f32 v90, v90, v238
    v_add_f32 v91, v91, v239
    s_waitcnt lgkmcnt(2)
    v_add_f32 v84, v84, v240
    v_add_f32 v85, v85, v241
    v_add_f32 v86, v86, v242
    v_add_f32 v87, v87, v243
    v_add_f32 v88, v88, v244
    v_add_f32 v89, v89, v245
    v_add_f32 v90, v90, v246
    v_add_f32 v91, v91, v247
    s_waitcnt lgkmcnt(0)
    v_add_f32 v84, v84, v248
    v_add_f32 v85, v85, v249
    v_cvt_pk_bf16_f32 v96, v84, v85
    v_add_f32 v86, v86, v250
    v_add_f32 v87, v87, v251
    v_cvt_pk_bf16_f32 v97, v86, v87
    v_add_f32 v88, v88, v252
    v_add_f32 v89, v89, v253
    v_cvt_pk_bf16_f32 v98, v88, v89
    v_add_f32 v90, v90, v254
    v_add_f32 v91, v91, v255
    v_cvt_pk_bf16_f32 v99, v90, v91
    v_permlane16_swap_b32 v96, v98
    s_nop 0
    v_permlane16_swap_b32 v97, v99
    s_mov_b32 s78, 32768
    buffer_store_dwordx4 v[96:99], v152, s[52:55], s78 offen
    s_branch L_FINISH
L_TAIL0:
    v_mfma_f32_16x16x32_bf16 v[48:51], a[144:147], v[188:191], v[48:51]
    s_mov_b32 m0, s91
    s_add_u32 s91, s91, 1024
    buffer_load_dwordx4 v11, s[36:39], s90 offen lds
    s_add_u32 s90, s90, 8192
    v_mfma_f32_16x16x32_bf16 v[56:59], a[148:151], v[188:191], v[56:59]
    s_waitcnt lgkmcnt(0)
    s_barrier
    v_mfma_f32_16x16x32_bf16 v[64:67], a[152:155], v[188:191], v[64:67]
    ds_read_b128 v[232:235], v154 offset:0
    v_mfma_f32_16x16x32_bf16 v[72:75], a[156:159], v[188:191], v[72:75]
    s_waitcnt vmcnt(9)
    ds_read_b128 v[236:239], v154 offset:1024
    v_mfma_f32_16x16x32_bf16 v[52:55], a[144:147], v[192:195], v[52:55]
    s_mov_b32 m0, s91
    s_add_u32 s91, s91, 1024
    buffer_load_dwordx4 v155, s[36:39], s90 offen lds
    s_add_u32 s90, s90, 8192
    v_mfma_f32_16x16x32_bf16 v[60:63], a[148:151], v[192:195], v[60:63]
    ds_read_b128 v[240:243], v154 offset:2048
    v_mfma_f32_16x16x32_bf16 v[68:71], a[152:155], v[192:195], v[68:71]
    ds_read_b128 v[244:247], v154 offset:3072
    v_mfma_f32_16x16x32_bf16 v[76:79], a[156:159], v[192:195], v[76:79]
    s_waitcnt vmcnt(9)
    ds_read_b128 v[248:251], v154 offset:4096
    v_mfma_f32_16x16x32_bf16 v[48:51], a[160:163], v[196:199], v[48:51]
    s_mov_b32 m0, s91
    s_add_u32 s91, s91, 1024
    buffer_load_dwordx4 v11, s[36:39], s90 offen lds
    s_add_u32 s90, s90, 8192
    v_mfma_f32_16x16x32_bf16 v[56:59], a[164:167], v[196:199], v[56:59]
    ds_read_b128 v[252:255], v154 offset:5120
    v_mfma_f32_16x16x32_bf16 v[64:67], a[168:171], v[196:199], v[64:67]
    ds_read_b128 v[84:87], v154 offset:6144
    v_mfma_f32_16x16x32_bf16 v[72:75], a[172:175], v[196:199], v[72:75]
    s_waitcnt vmcnt(9)
    ds_read_b128 v[88:91], v154 offset:7168
    v_mfma_f32_16x16x32_bf16 v[48:51], a[176:179], v[200:203], v[48:51]
    s_mov_b32 m0, s91
    s_add_u32 s91, s91, 13312
    buffer_load_dwordx4 v155, s[36:39], s90 offen lds
    s_add_u32 s90, s90, 106496
    v_mfma_f32_16x16x32_bf16 v[56:59], a[180:183], v[200:203], v[56:59]
    s_waitcnt lgkmcnt(0)
    v_add_f32 v232, v232, v240
    v_mfma_f32_16x16x32_bf16 v[64:67], a[184:187], v[200:203], v[64:67]
    v_add_f32 v84, v84, v248
    v_add_f32 v232, v232, v136
    v_mfma_f32_16x16x32_bf16 v[72:75], a[188:191], v[200:203], v[72:75]
    s_waitcnt vmcnt(9)
    v_add_f32 v233, v233, v241
    v_add_f32 v85, v85, v249
    v_mfma_f32_16x16x32_bf16 v[48:51], a[192:195], v[204:207], v[48:51]
    s_lshl_b32 s82, s3, 10
    s_add_u32 m0, s82, 131072
    s_add_u32 s82, s82, 0
    buffer_load_dwordx4 v1, s[40:43], s82 offen lds
    v_mfma_f32_16x16x32_bf16 v[56:59], a[196:199], v[204:207], v[56:59]
    v_add_f32 v233, v233, v137
    v_add_f32 v234, v234, v242
    v_mfma_f32_16x16x32_bf16 v[64:67], a[200:203], v[204:207], v[64:67]
    v_add_f32 v86, v86, v250
    v_add_f32 v234, v234, v138
    v_mfma_f32_16x16x32_bf16 v[72:75], a[204:207], v[204:207], v[72:75]
    s_waitcnt vmcnt(9)
    v_add_f32 v235, v235, v243
    v_add_f32 v87, v87, v251
    v_mfma_f32_16x16x32_bf16 v[48:51], a[208:211], v[208:211], v[48:51]
    s_mov_b32 m0, s91
    s_add_u32 s91, s91, 1024
    buffer_load_dwordx4 v11, s[36:39], s90 offen lds
    s_add_u32 s90, s90, 8192
    v_mfma_f32_16x16x32_bf16 v[56:59], a[212:215], v[208:211], v[56:59]
    v_add_f32 v235, v235, v139
    v_add_f32 v236, v236, v244
    v_mfma_f32_16x16x32_bf16 v[64:67], a[216:219], v[208:211], v[64:67]
    v_add_f32 v88, v88, v252
    v_add_f32 v236, v236, v140
    v_mfma_f32_16x16x32_bf16 v[72:75], a[220:223], v[208:211], v[72:75]
    s_waitcnt vmcnt(9)
    v_add_f32 v237, v237, v245
    v_add_f32 v89, v89, v253
    v_mfma_f32_16x16x32_bf16 v[52:55], a[160:163], v[212:215], v[52:55]
    s_mov_b32 m0, s91
    s_add_u32 s91, s91, 1024
    buffer_load_dwordx4 v155, s[36:39], s90 offen lds
    s_add_u32 s90, s90, 8192
    v_mfma_f32_16x16x32_bf16 v[60:63], a[164:167], v[212:215], v[60:63]
    v_add_f32 v237, v237, v141
    v_add_f32 v238, v238, v246
    v_mfma_f32_16x16x32_bf16 v[68:71], a[168:171], v[212:215], v[68:71]
    v_add_f32 v90, v90, v254
    v_add_f32 v238, v238, v142
    v_mfma_f32_16x16x32_bf16 v[76:79], a[172:175], v[212:215], v[76:79]
    s_waitcnt vmcnt(9)
    v_add_f32 v239, v239, v247
    v_add_f32 v91, v91, v255
    v_mfma_f32_16x16x32_bf16 v[52:55], a[176:179], v[216:219], v[52:55]
    s_mov_b32 m0, s91
    s_add_u32 s91, s91, 1024
    buffer_load_dwordx4 v11, s[36:39], s90 offen lds
    s_add_u32 s90, s90, 8192
    v_mfma_f32_16x16x32_bf16 v[60:63], a[180:183], v[216:219], v[60:63]
    ds_write_b128 v128, v[48:51] offset:32768
    v_mfma_f32_16x16x32_bf16 v[68:71], a[184:187], v[216:219], v[68:71]
    ds_write_b128 v129, v[56:59] offset:40960
    v_mfma_f32_16x16x32_bf16 v[76:79], a[188:191], v[216:219], v[76:79]
    s_waitcnt vmcnt(9)
    v_add_f32 v239, v239, v143
    v_add_f32 v232, v232, v84
    v_mfma_f32_16x16x32_bf16 v[52:55], a[192:195], v[220:223], v[52:55]
    s_mov_b32 m0, s91
    s_add_u32 s91, s91, 13312
    buffer_load_dwordx4 v155, s[36:39], s90 offen lds
    s_add_u32 s90, s90, 106496
    v_mfma_f32_16x16x32_bf16 v[60:63], a[196:199], v[220:223], v[60:63]
    ds_write_b128 v130, v[64:67] offset:49152
    v_mfma_f32_16x16x32_bf16 v[68:71], a[200:203], v[220:223], v[68:71]
    ds_write_b128 v131, v[72:75] offset:57344
    v_mfma_f32_16x16x32_bf16 v[76:79], a[204:207], v[220:223], v[76:79]
    s_waitcnt vmcnt(9)
    v_add_f32 v233, v233, v85
    v_cvt_pk_bf16_f32 v92, v232, v233
    v_mfma_f32_16x16x32_bf16 v[52:55], a[208:211], v[224:227], v[52:55]
    s_lshl_b32 s82, s3, 10
    s_add_u32 m0, s82, 135168
    s_add_u32 s82, s82, 4096
    buffer_load_dwordx4 v1, s[40:43], s82 offen lds
    v_mfma_f32_16x16x32_bf16 v[60:63], a[212:215], v[224:227], v[60:63]
    v_add_f32 v234, v234, v86
    v_add_f32 v235, v235, v87
    v_mfma_f32_16x16x32_bf16 v[68:71], a[216:219], v[224:227], v[68:71]
    v_cvt_pk_bf16_f32 v93, v234, v235
    v_add_f32 v236, v236, v88
    v_mfma_f32_16x16x32_bf16 v[76:79], a[220:223], v[224:227], v[76:79]
    v_add_f32 v237, v237, v89
    v_cvt_pk_bf16_f32 v94, v236, v237
    v_add_f32 v238, v238, v90
    v_add_f32 v239, v239, v91
    v_cvt_pk_bf16_f32 v95, v238, v239
    s_nop 0
    v_permlane16_swap_b32 v92, v94
    v_permlane16_swap_b32 v93, v95
    s_mov_b32 s78, 0
    buffer_store_dwordx4 v[92:95], v152, s[52:55], s78 offen sc1
    s_nop 5
    s_cmp_eq_u32 s3, 1
    s_cbranch_scc1 L_rlw_51
    s_cmp_eq_u32 s3, 2
    s_cbranch_scc1 L_rlw_52
    s_cmp_eq_u32 s3, 3
    s_cbranch_scc1 L_rlw_53
L_rlw_50:
    ds_write_b128 v1, v[60:63] offset:48128
    ds_write_b128 v1, v[68:71] offset:54272
    ds_write_b128 v1, v[76:79] offset:60416
    v_add_f32 v84, v48, v144
    v_add_f32 v85, v49, v145
    v_add_f32 v86, v50, v146
    v_add_f32 v87, v51, v147
    v_add_f32 v88, v52, v148
    v_add_f32 v89, v53, v149
    v_add_f32 v90, v54, v150
    v_add_f32 v91, v55, v151
    s_branch L_rl_49
L_rlw_51:
    ds_write_b128 v1, v[68:71] offset:56320
    ds_write_b128 v1, v[76:79] offset:62464
    ds_write_b128 v1, v[52:55] offset:35840
    v_add_f32 v84, v56, v144
    v_add_f32 v85, v57, v145
    v_add_f32 v86, v58, v146
    v_add_f32 v87, v59, v147
    v_add_f32 v88, v60, v148
    v_add_f32 v89, v61, v149
    v_add_f32 v90, v62, v150
    v_add_f32 v91, v63, v151
    s_branch L_rl_49
L_rlw_52:
    ds_write_b128 v1, v[76:79] offset:64512
    ds_write_b128 v1, v[52:55] offset:37888
    ds_write_b128 v1, v[60:63] offset:44032
    v_add_f32 v84, v64, v144
    v_add_f32 v85, v65, v145
    v_add_f32 v86, v66, v146
    v_add_f32 v87, v67, v147
    v_add_f32 v88, v68, v148
    v_add_f32 v89, v69, v149
    v_add_f32 v90, v70, v150
    v_add_f32 v91, v71, v151
    s_branch L_rl_49
L_rlw_53:
    ds_write_b128 v1, v[52:55] offset:39936
    ds_write_b128 v1, v[60:63] offset:46080
    ds_write_b128 v1, v[68:71] offset:52224
    v_add_f32 v84, v72, v144
    v_add_f32 v85, v73, v145
    v_add_f32 v86, v74, v146
    v_add_f32 v87, v75, v147
    v_add_f32 v88, v76, v148
    v_add_f32 v89, v77, v149
    v_add_f32 v90, v78, v150
    v_add_f32 v91, v79, v151
L_rl_49:
    s_waitcnt lgkmcnt(0)
    s_barrier
    ds_read_b128 v[232:235], v154 offset:34816
    ds_read_b128 v[236:239], v154 offset:35840
    ds_read_b128 v[240:243], v154 offset:36864
    ds_read_b128 v[244:247], v154 offset:37888
    ds_read_b128 v[248:251], v154 offset:38912
    ds_read_b128 v[252:255], v154 offset:39936
    s_waitcnt lgkmcnt(4)
    v_add_f32 v84, v84, v232
    v_add_f32 v85, v85, v233
    v_add_f32 v86, v86, v234
    v_add_f32 v87, v87, v235
    v_add_f32 v88, v88, v236
    v_add_f32 v89, v89, v237
    v_add_f32 v90, v90, v238
    v_add_f32 v91, v91, v239
    s_waitcnt lgkmcnt(2)
    v_add_f32 v84, v84, v240
    v_add_f32 v85, v85, v241
    v_add_f32 v86, v86, v242
    v_add_f32 v87, v87, v243
    v_add_f32 v88, v88, v244
    v_add_f32 v89, v89, v245
    v_add_f32 v90, v90, v246
    v_add_f32 v91, v91, v247
    s_waitcnt lgkmcnt(0)
    v_add_f32 v84, v84, v248
    v_add_f32 v85, v85, v249
    v_cvt_pk_bf16_f32 v96, v84, v85
    v_add_f32 v86, v86, v250
    v_add_f32 v87, v87, v251
    v_cvt_pk_bf16_f32 v97, v86, v87
    v_add_f32 v88, v88, v252
    v_add_f32 v89, v89, v253
    v_cvt_pk_bf16_f32 v98, v88, v89
    v_add_f32 v90, v90, v254
    v_add_f32 v91, v91, v255
    v_cvt_pk_bf16_f32 v99, v90, v91
    v_permlane16_swap_b32 v96, v98
    s_nop 0
    v_permlane16_swap_b32 v97, v99
    s_mov_b32 s78, 32768
    buffer_store_dwordx4 v[96:99], v152, s[52:55], s78 offen sc1
    s_waitcnt vmcnt(1)
    s_barrier
    s_cmp_lg_u32 s3, 0
    s_cbranch_scc1 L_pub_54
    s_lshl_b32 s82, s70, 7
    s_add_u32 s82, s82, 0x2a8000
    v_mov_b32 v4, 0
    s_mov_b64 exec, 1
    buffer_store_dword v2, v4, s[44:47], s82 offen sc1
    s_mov_b64 exec, -1
L_pub_54:
    s_mov_b32 m0, s91
    s_add_u32 s91, s91, 1024
    buffer_load_dwordx4 v11, s[36:39], s90 offen lds
    s_add_u32 s90, s90, 8192
    s_mov_b32 m0, s91
    s_add_u32 s91, s91, 1024
    buffer_load_dwordx4 v155, s[36:39], s90 offen lds
    s_add_u32 s90, s90, 8192
    s_mov_b32 m0, s91
    s_add_u32 s91, s91, 1024
    buffer_load_dwordx4 v11, s[36:39], s90 offen lds
    s_add_u32 s90, s90, 8192
    s_mov_b32 m0, s91
    s_add_u32 s91, s91, 13312
    buffer_load_dwordx4 v155, s[36:39], s90 offen lds
    s_add_u32 s90, s90, 106496
    s_lshl_b32 s82, s3, 10
    s_add_u32 m0, s82, 139264
    s_add_u32 s82, s82, 8192
    buffer_load_dwordx4 v1, s[40:43], s82 offen lds
    s_mov_b32 m0, s91
    s_add_u32 s91, s91, 1024
    buffer_load_dwordx4 v11, s[36:39], s90 offen lds
    s_add_u32 s90, s90, 8192
    s_mov_b32 m0, s91
    s_add_u32 s91, s91, 1024
    buffer_load_dwordx4 v155, s[36:39], s90 offen lds
    s_add_u32 s90, s90, 8192
    s_mov_b32 m0, s91
    s_add_u32 s91, s91, 1024
    buffer_load_dwordx4 v11, s[36:39], s90 offen lds
    s_add_u32 s90, s90, 8192
    s_mov_b32 m0, s91
    s_add_u32 s91, s91, 13312
    buffer_load_dwordx4 v155, s[36:39], s90 offen lds
    s_add_u32 s90, s90, 106496
    s_lshl_b32 s82, s3, 10
    s_add_u32 m0, s82, 143360
    s_add_u32 s82, s82, 12288
    buffer_load_dwordx4 v1, s[40:43], s82 offen lds
    s_mov_b32 s32, s52
    s_mov_b32 s33, s53
    s_mov_b32 s52, s26
    s_mov_b32 s53, s27
    v_mov_b32 v64, 0x3f803f80
    v_mov_b32 v65, 0x3f803f80
    v_mov_b32 v66, 0x3f803f80
    v_mov_b32 v67, 0x3f803f80
    v_and_b32 v5, 7, v0
    s_lshl_b32 s76, s68, 3
    v_add_u32 v5, s76, v5
    v_lshlrev_b32 v5, 7, v5
    v_add_u32 v123, 0x1298000, v5
    s_lshl_b32 s18, s68, 10
    s_add_u32 s18, s18, 0x2a8000
    s_waitcnt vmcnt(10)
    s_barrier
    s_cmp_lg_u32 s3, 0
    s_cbranch_scc1 L_pub_55
    s_lshl_b32 s82, s70, 7
    s_add_u32 s82, s82, 0x298000
    v_mov_b32 v4, 0
    s_mov_b64 exec, 1
    buffer_store_dword v2, v4, s[44:47], s82 offen sc1
    s_mov_b64 exec, -1
L_pub_55:
    ds_read_b64_tr_b16 a[0:1], v8 offset:0
    ds_read_b64_tr_b16 a[2:3], v8 offset:512
    ds_read_b64_tr_b16 a[64:65], v120 offset:0
    ds_read_b64_tr_b16 a[66:67], v120 offset:128
    ds_read_b64_tr_b16 a[4:5], v9 offset:0
    ds_read_b64_tr_b16 a[6:7], v9 offset:512
    ds_read_b64_tr_b16 a[8:9], v8 offset:8192
    ds_read_b64_tr_b16 a[10:11], v8 offset:8704
    ds_read_b64_tr_b16 a[68:69], v120 offset:2048
    ds_read_b64_tr_b16 a[70:71], v120 offset:2176
    ds_read_b64_tr_b16 a[12:13], v9 offset:8192
    ds_read_b64_tr_b16 a[14:15], v9 offset:8704
    s_waitcnt lgkmcnt(0)
    s_cmp_lg_u32 s3, 0
    s_cbranch_scc1 L_w0_56
    s_buffer_load_dword s56, s[44:47], s18 offset:0 glc
    s_buffer_load_dword s57, s[44:47], s18 offset:128 glc
    s_buffer_load_dword s58, s[44:47], s18 offset:256 glc
    s_buffer_load_dword s59, s[44:47], s18 offset:384 glc
    s_buffer_load_dword s60, s[44:47], s18 offset:512 glc
    s_buffer_load_dword s61, s[44:47], s18 offset:640 glc
    s_buffer_load_dword s62, s[44:47], s18 offset:768 glc
    s_buffer_load_dword s63, s[44:47], s18 offset:896 glc
L_w0_56:
    ds_read_b64_tr_b16 a[16:17], v8 offset:16384
    ds_read_b64_tr_b16 a[18:19], v8 offset:16896
    ds_read_b64_tr_b16 a[72:73], v120 offset:4096
    ds_read_b64_tr_b16 a[74:75], v120 offset:4224
    ds_read_b64_tr_b16 a[20:21], v9 offset:16384
    ds_read_b64_tr_b16 a[22:23], v9 offset:16896
    ds_read_b64_tr_b16 a[24:25], v8 offset:24576
    s_waitcnt lgkmcnt(0)
    ds_read_b64_tr_b16 a[26:27], v8 offset:25088
    ds_read_b64_tr_b16 a[76:77], v120 offset:6144
    ds_read_b64_tr_b16 a[78:79], v120 offset:6272
    ds_read_b64_tr_b16 a[28:29], v9 offset:24576
    ds_read_b64_tr_b16 a[30:31], v9 offset:25088
    s_waitcnt lgkmcnt(0)
    s_cmp_lg_u32 s3, 0
    s_cbranch_scc1 L_w0_57
    s_mov_b32 s82, 200000
    s_branch L_spc_s4e_60
L_sp_s4e_58:
    s_buffer_load_dword s56, s[44:47], s18 offset:0 glc
    s_buffer_load_dword s57, s[44:47], s18 offset:128 glc
    s_buffer_load_dword s58, s[44:47], s18 offset:256 glc
    s_buffer_load_dword s59, s[44:47], s18 offset:384 glc
    s_buffer_load_dword s60, s[44:47], s18 offset:512 glc
    s_buffer_load_dword s61, s[44:47], s18 offset:640 glc
    s_buffer_load_dword s62, s[44:47], s18 offset:768 glc
    s_buffer_load_dword s63, s[44:47], s18 offset:896 glc
    s_sub_u32 s82, s82, 1
    s_cbranch_scc1 L_TIMEOUT
L_spc_s4e_60:
    s_waitcnt lgkmcnt(0)
    s_xor_b32 s56, s56, s7
    s_xor_b32 s57, s57, s7
    s_xor_b32 s58, s58, s7
    s_xor_b32 s59, s59, s7
    s_xor_b32 s60, s60, s7
    s_xor_b32 s61, s61, s7
    s_xor_b32 s62, s62, s7
    s_xor_b32 s63, s63, s7
    s_or_b32 s56, s56, s60
    s_or_b32 s57, s57, s61
    s_or_b32 s58, s58, s62
    s_or_b32 s59, s59, s63
    s_or_b32 s56, s56, s58
    s_or_b32 s57, s57, s59
    s_or_b32 s56, s56, s57
    s_cbranch_scc1 L_sp_s4e_58
L_w0_57:
    s_barrier
    s_add_u32 m0, s99, 0
    s_mov_b32 s95, 0
    buffer_load_dwordx4 v12, s[32:35], s95 offen sc1 lds
    s_add_u32 m0, s99, 1024
    s_mov_b32 s95, 2048
    buffer_load_dwordx4 v12, s[32:35], s95 offen sc1 lds
    s_add_u32 m0, s99, 2048
    s_mov_b32 s95, 4096
    buffer_load_dwordx4 v12, s[32:35], s95 offen sc1 lds
    s_add_u32 m0, s99, 3072
    s_mov_b32 s95, 6144
    buffer_load_dwordx4 v12, s[32:35], s95 offen sc1 lds
    s_add_u32 m0, s99, 8192
    s_mov_b32 s95, 16384
    buffer_load_dwordx4 v12, s[32:35], s95 offen sc1 lds
    s_add_u32 m0, s99, 9216
    s_mov_b32 s95, 18432
    buffer_load_dwordx4 v12, s[32:35], s95 offen sc1 lds
    s_add_u32 m0, s99, 10240
    s_mov_b32 s95, 20480
    buffer_load_dwordx4 v12, s[32:35], s95 offen sc1 lds
    s_add_u32 m0, s99, 11264
    s_mov_b32 s95, 22528
    buffer_load_dwordx4 v12, s[32:35], s95 offen sc1 lds
    s_waitcnt vmcnt(8)
    s_barrier
    ds_read_b64_tr_b16 a[32:33], v8 offset:32768
    ds_read_b64_tr_b16 a[34:35], v8 offset:33280
    ds_read_b64_tr_b16 a[80:81], v120 offset:8192
    ds_read_b64_tr_b16 a[82:83], v120 offset:8320
    ds_read_b64_tr_b16 a[36:37], v9 offset:32768
    ds_read_b64_tr_b16 a[38:39], v9 offset:33280
    ds_read_b64_tr_b16 a[40:41], v8 offset:40960
    ds_read_b64_tr_b16 a[42:43], v8 offset:41472
    ds_read_b64_tr_b16 a[84:85], v120 offset:10240
    ds_read_b64_tr_b16 a[86:87], v120 offset:10368
    ds_read_b64_tr_b16 a[44:45], v9 offset:40960
    ds_read_b64_tr_b16 a[46:47], v9 offset:41472
    ds_read_b64_tr_b16 a[48:49], v8 offset:49152
    ds_read_b64_tr_b16 a[50:51], v8 offset:49664
    s_waitcnt lgkmcnt(12)
    ds_read_b64_tr_b16 a[88:89], v120 offset:12288
    ds_read_b64_tr_b16 a[90:91], v120 offset:12416
    s_waitcnt lgkmcnt(12)
    ds_read_b64_tr_b16 a[52:53], v9 offset:49152
    ds_read_b64_tr_b16 a[54:55], v9 offset:49664
    s_waitcnt lgkmcnt(12)
    ds_read_b64_tr_b16 a[56:57], v8 offset:57344
    ds_read_b64_tr_b16 a[58:59], v8 offset:57856
    s_waitcnt lgkmcnt(12)
    ds_read_b64_tr_b16 a[92:93], v120 offset:14336
    ds_read_b64_tr_b16 a[94:95], v120 offset:14464
    s_waitcnt lgkmcnt(12)
    ds_read_b64_tr_b16 a[60:61], v9 offset:57344
    ds_read_b64_tr_b16 a[62:63], v9 offset:57856
    s_waitcnt lgkmcnt(0)
    s_waitcnt vmcnt(4)
    s_cmp_lg_u32 s3, 0
    s_cbranch_scc1 L_w0_61
    buffer_load_dword v124, v123, s[48:51], 0 offen sc1
L_w0_61:
    s_mov_b32 s6, 1
    s_add_u32 s44, s44, 0x1000000
    s_addc_u32 s45, s45, 0
    s_branch L_QKV_X
L_FINISH:
    s_cmp_lg_u32 s75, 0
    s_cbranch_scc1 L_END
    v_mov_b32 v4, 0
    s_mov_b64 exec, 1
    buffer_store_dword v2, v4, s[48:51], 0 offen
L_END:
    s_endpgm
L_TIMEOUT:
    s_endpgm
L_FB0:
    v_mov_b32 v7, 0xff800000
    s_mov_b32 s81, 0x200000
L_FB0_a:
    buffer_load_dwordx4 v[8:11], v1, s[44:47], s81 offen sc1
    s_add_u32 s81, s81, 1024
    s_waitcnt vmcnt(0)
    v_mfma_f32_32x32x16_bf16 v[160:175], v[8:11], v[64:67], 0
    s_nop 7
    s_nop 7
    v_max3_f32 v7, v160, v161, v7
    v_max3_f32 v7, v162, v163, v7
    v_max3_f32 v7, v164, v165, v7
    v_max3_f32 v7, v166, v167, v7
    v_max3_f32 v7, v168, v169, v7
    v_max3_f32 v7, v170, v171, v7
    v_max3_f32 v7, v172, v173, v7
    v_max3_f32 v7, v174, v175, v7
    s_cmp_lg_u32 s81, 0x210000
    s_cbranch_scc1 L_FB0_a
    v_mov_b32 v6, v7
    s_nop 1
    v_permlane32_swap_b32 v7, v6
    v_max_f32 v7, v7, v6
    v_sub_f32 v240, 0, v7
    v_mov_b32 v48, 0
    v_sub_f32 v241, 0, v7
    v_mov_b32 v49, 0
    v_sub_f32 v242, 0, v7
    v_mov_b32 v50, 0
    v_sub_f32 v243, 0, v7
    v_mov_b32 v51, 0
    v_sub_f32 v244, 0, v7
    v_mov_b32 v52, 0
    v_sub_f32 v245, 0, v7
    v_mov_b32 v53, 0
    v_sub_f32 v246, 0, v7
    v_mov_b32 v54, 0
    v_sub_f32 v247, 0, v7
    v_mov_b32 v55, 0
    v_sub_f32 v248, 0, v7
    v_mov_b32 v56, 0
    v_sub_f32 v249, 0, v7
    v_mov_b32 v57, 0
    v_sub_f32 v250, 0, v7
    v_mov_b32 v58, 0
    v_sub_f32 v251, 0, v7
    v_mov_b32 v59, 0
    v_sub_f32 v252, 0, v7
    v_mov_b32 v60, 0
    v_sub_f32 v253, 0, v7
    v_mov_b32 v61, 0
    v_sub_f32 v254, 0, v7
    v_mov_b32 v62, 0
    v_sub_f32 v255, 0, v7
    v_mov_b32 v63, 0
    v_and_b32 v4, 63, v0
    v_and_b32 v5, 27, v4
    v_cmp_eq_u32 vcc, 16, v5
    v_mov_b32 v6, 0x3f803f80
    s_nop 0
    v_cndmask_b32 v12, 0, v6, vcc
    v_cndmask_b32 v152, 0, v6, vcc
    v_cndmask_b32 v13, 0, v6, vcc
    v_cndmask_b32 v153, 0, v6, vcc
    v_cndmask_b32 v14, 0, v6, vcc
    v_cndmask_b32 v154, 0, v6, vcc
    v_cndmask_b32 v15, 0, v6, vcc
    v_cndmask_b32 v155, 0, v6, vcc
    v_and_b32 v5, 15, v4
    v_lshrrev_b32 v6, 5, v4
    v_lshlrev_b32 v5, 4, v5
    v_lshl_add_u32 v5, v6, 8, v5
    v_add_u32 v5, 0x10000, v5
    s_mov_b32 s81, 0x200000
    s_mov_b32 s86, 0x0000ffff
    s_mov_b32 s87, 0x0000ffff
L_FB0_b:
    buffer_load_dwordx4 v[8:11], v1, s[44:47], s81 offen sc1
    s_mov_b64 exec, s[86:87]
    buffer_load_dwordx4 v[12:15], v5, s[44:47], s81 offen sc1
    buffer_load_dwordx4 v[152:155], v5, s[44:47], s81 offen offset:512 sc1
    s_mov_b64 exec, -1
    s_add_u32 s81, s81, 1024
    s_waitcnt vmcnt(0)
    v_mfma_f32_32x32x16_bf16 v[160:175], v[8:11], v[64:67], v[240:255]
    s_nop 7
    s_nop 7
    v_exp_f32 v160, v160
    v_exp_f32 v161, v161
    v_exp_f32 v162, v162
    v_exp_f32 v163, v163
    v_exp_f32 v164, v164
    v_exp_f32 v165, v165
    v_exp_f32 v166, v166
    v_exp_f32 v167, v167
    v_exp_f32 v168, v168
    v_exp_f32 v169, v169
    v_exp_f32 v170, v170
    v_exp_f32 v171, v171
    v_exp_f32 v172, v172
    v_exp_f32 v173, v173
    v_exp_f32 v174, v174
    v_exp_f32 v175, v175
    s_nop 1
    v_smfmac_f32_32x32x32_bf16 v[48:63], v[12:15], v[160:167], v96
    v_smfmac_f32_32x32x32_bf16 v[48:63], v[152:155], v[168:175], v96
    s_cmp_lg_u32 s81, 0x210000
    s_cbranch_scc1 L_FB0_b
    s_nop 7
    s_nop 7
    s_branch L_FBR0
L_FB1:
    v_mov_b32 v7, 0xff800000
    s_mov_b32 s81, 0x200000
L_FB1_a:
    buffer_load_dwordx4 v[8:11], v1, s[44:47], s81 offen sc1
    s_add_u32 s81, s81, 1024
    s_waitcnt vmcnt(0)
    v_mfma_f32_32x32x16_bf16 v[16:31], v[8:11], v[112:115], 0
    s_nop 7
    s_nop 7
    v_max3_f32 v7, v16, v17, v7
    v_max3_f32 v7, v18, v19, v7
    v_max3_f32 v7, v20, v21, v7
    v_max3_f32 v7, v22, v23, v7
    v_max3_f32 v7, v24, v25, v7
    v_max3_f32 v7, v26, v27, v7
    v_max3_f32 v7, v28, v29, v7
    v_max3_f32 v7, v30, v31, v7
    s_cmp_lg_u32 s81, 0x210000
    s_cbranch_scc1 L_FB1_a
    v_mov_b32 v6, v7
    s_nop 1
    v_permlane32_swap_b32 v7, v6
    v_max_f32 v7, v7, v6
    v_sub_f32 v240, 0, v7
    v_mov_b32 v208, 0
    v_sub_f32 v241, 0, v7
    v_mov_b32 v209, 0
    v_sub_f32 v242, 0, v7
    v_mov_b32 v210, 0
    v_sub_f32 v243, 0, v7
    v_mov_b32 v211, 0
    v_sub_f32 v244, 0, v7
    v_mov_b32 v212, 0
    v_sub_f32 v245, 0, v7
    v_mov_b32 v213, 0
    v_sub_f32 v246, 0, v7
    v_mov_b32 v214, 0
    v_sub_f32 v247, 0, v7
    v_mov_b32 v215, 0
    v_sub_f32 v248, 0, v7
    v_mov_b32 v216, 0
    v_sub_f32 v249, 0, v7
    v_mov_b32 v217, 0
    v_sub_f32 v250, 0, v7
    v_mov_b32 v218, 0
    v_sub_f32 v251, 0, v7
    v_mov_b32 v219, 0
    v_sub_f32 v252, 0, v7
    v_mov_b32 v220, 0
    v_sub_f32 v253, 0, v7
    v_mov_b32 v221, 0
    v_sub_f32 v254, 0, v7
    v_mov_b32 v222, 0
    v_sub_f32 v255, 0, v7
    v_mov_b32 v223, 0
    v_and_b32 v4, 63, v0
    v_and_b32 v5, 27, v4
    v_cmp_eq_u32 vcc, 16, v5
    v_mov_b32 v6, 0x3f803f80
    s_nop 0
    v_cndmask_b32 v12, 0, v6, vcc
    v_cndmask_b32 v152, 0, v6, vcc
    v_cndmask_b32 v13, 0, v6, vcc
    v_cndmask_b32 v153, 0, v6, vcc
    v_cndmask_b32 v14, 0, v6, vcc
    v_cndmask_b32 v154, 0, v6, vcc
    v_cndmask_b32 v15, 0, v6, vcc
    v_cndmask_b32 v155, 0, v6, vcc
    v_and_b32 v5, 15, v4
    v_lshrrev_b32 v6, 5, v4
    v_lshlrev_b32 v5, 4, v5
    v_lshl_add_u32 v5, v6, 8, v5
    v_add_u32 v5, 0x10000, v5
    s_mov_b32 s81, 0x200000
    s_mov_b32 s86, 0x0000ffff
    s_mov_b32 s87, 0x0000ffff
L_FB1_b:
    buffer_load_dwordx4 v[8:11], v1, s[44:47], s81 offen sc1
    s_mov_b64 exec, s[86:87]
    buffer_load_dwordx4 v[12:15], v5, s[44:47], s81 offen sc1
    buffer_load_dwordx4 v[152:155], v5, s[44:47], s81 offen offset:512 sc1
    s_mov_b64 exec, -1
    s_add_u32 s81, s81, 1024
    s_waitcnt vmcnt(0)
    v_mfma_f32_32x32x16_bf16 v[16:31], v[8:11], v[112:115], v[240:255]
    s_nop 7
    s_nop 7
    v_exp_f32 v16, v16
    v_exp_f32 v17, v17
    v_exp_f32 v18, v18
    v_exp_f32 v19, v19
    v_exp_f32 v20, v20
    v_exp_f32 v21, v21
    v_exp_f32 v22, v22
    v_exp_f32 v23, v23
    v_exp_f32 v24, v24
    v_exp_f32 v25, v25
    v_exp_f32 v26, v26
    v_exp_f32 v27, v27
    v_exp_f32 v28, v28
    v_exp_f32 v29, v29
    v_exp_f32 v30, v30
    v_exp_f32 v31, v31
    s_nop 1
    v_smfmac_f32_32x32x32_bf16 v[208:223], v[12:15], v[16:23], v96
    v_smfmac_f32_32x32x32_bf16 v[208:223], v[152:155], v[24:31], v96
    s_cmp_lg_u32 s81, 0x210000
    s_cbranch_scc1 L_FB1_b
    s_nop 7
    s_nop 7
    s_branch L_FBR1
L_CODE_END:
.section .rodata,"a"
.p2align 6
.amdhsa_kernel interleave_layers__grouped_kv_mqa__glu_gated_reglu__prompt_kernel
  .amdhsa_next_free_vgpr 512
  .amdhsa_next_free_sgpr 102
  .amdhsa_accum_offset 256
  .amdhsa_group_segment_fixed_size 0
  .amdhsa_kernarg_size 96
  .amdhsa_user_sgpr_count 2
  .amdhsa_user_sgpr_kernarg_segment_ptr 1
  .amdhsa_system_sgpr_workgroup_id_x 1
.end_amdhsa_kernel
```
